```python
import torch

def _softmax(x, axis=-1):
    return torch.softmax(x, dim=axis)
def _gelu(x):
    return torch.nn.functional.gelu(x, approximate="tanh")
def _silu(x):
    return torch.nn.functional.silu(x)
def _sigmoid(x):
    return torch.sigmoid(x)
def _layernorm(x, axis=-1, eps=1e-5):
    m = x.mean(dim=axis, keepdim=True)
    v = x.var(dim=axis, keepdim=True, unbiased=False)
    return (x - m) / torch.sqrt(v + eps)
def _scatter_add(tgt, idx, src, axis=0):
    return tgt.clone().index_add_(axis, idx, src)
def _segment_sum(src, seg, n):
    out = torch.zeros((n,) + src.shape[1:], dtype=src.dtype)
    return out.index_add_(0, seg, src)
def _pad(x, pw):
    flat = tuple(v for pair in reversed(pw) for v in pair)
    return torch.nn.functional.pad(x, flat)

kernel_name = 'sequential_preLN__grouped_kv_mqa__dense_activation_mish__prompt'

def setup_inputs():

    _w = (lambda a: (lambda t: t.to(torch.bfloat16) if t.is_floating_point() else t)(torch.as_tensor(a)))
    def _A_setup():
        B, S, D, H = 1, 2048, 448, 16
        Dh = D // H
        return {
            "x": _w((lambda *s: torch.randn(*s, dtype=torch.bfloat16) * 0.05)(B, S, D)),
            "wq": _w((lambda *s: torch.randn(*s, dtype=torch.bfloat16) * 0.05)(D, H * Dh)),
            "wk": _w((lambda *s: torch.randn(*s, dtype=torch.bfloat16) * 0.05)(D, Dh)),
            "wv": _w((lambda *s: torch.randn(*s, dtype=torch.bfloat16) * 0.05)(D, Dh)),
            "wo": _w((lambda *s: torch.randn(*s, dtype=torch.bfloat16) * 0.05)(H * Dh, D)),
        }
    _A_in = _A_setup()

    def _B_setup():
        B, S, D, F = 1, 2048, 448, 1792
        return {
            "x": _w((lambda *s: torch.randn(*s, dtype=torch.bfloat16) * 0.05)(B, S, D)),
            "w1": _w((lambda *s: torch.randn(*s, dtype=torch.bfloat16) * 0.8)(D, F) * (D ** -0.5)),
            "b1": _w((lambda *s: torch.randn(*s, dtype=torch.bfloat16) * 0.8)(F)),
            "w2": _w((lambda *s: torch.randn(*s, dtype=torch.bfloat16) * 0.2)(F, D) * (F ** -0.5)),
        }
    _B_in = _B_setup()

    return {
        "A_x": _A_in["x"],
        "A_wq": _A_in["wq"],
        "A_wk": _A_in["wk"],
        "A_wv": _A_in["wv"],
        "A_wo": _A_in["wo"],
        "B_x": _B_in["x"],
        "B_w1": _B_in["w1"],
        "B_b1": _B_in["b1"],
        "B_w2": _B_in["w2"],
    }

def reference(A_x, A_wq, A_wk, A_wv, A_wo, B_x, B_w1, B_b1, B_w2):
    def _A_ref(x, wq, wk, wv, wo):
        B, S, D = x.shape
        H = 16
        Dh = D // H
        q = (lambda x, *d: x.permute(*d))((x @ wq).reshape(B, S, H, Dh), 0, 2, 1, 3)
        k = x @ wk
        v = x @ wv
        scores = torch.einsum("bhqd,bkd->bhqk", q, k) * (Dh ** -0.5)
        p = _softmax(scores, axis=-1)
        o = torch.einsum("bhqk,bkd->bhqd", p, v)
        return (lambda x, *d: x.permute(*d))(o, 0, 2, 1, 3).reshape(B, S, H * Dh) @ wo

    def _B_ref(x, w1, b1, w2):
        h = torch.einsum("bsd,df->bsf", x, w1) + b1
        sp = torch.log1p(torch.exp(-torch.abs(h))) + torch.where(h > 0, h, torch.zeros_like(h))
        act = h * torch.tanh(sp)
        return torch.einsum("bsf,fd->bsd", act, w2)

    x = A_x
    h = x + _A_ref(_layernorm(x, axis=-1), A_wq, A_wk, A_wv, A_wo)
    h2 = h + _B_ref(_layernorm(h, axis=-1), B_w1, B_b1, B_w2)
    return h2
```

```asm
; @launch grid=(256,1,1) block=(512,1,1) lds=160064
.amdgcn_target "amdgcn-amd-amdhsa--gfx950"
.text
.globl sequential_preLN__grouped_kv_mqa__dense_activation_mish__prompt_kernel
.p2align 12
.fill 896, 4, 0xbf800000
.type sequential_preLN__grouped_kv_mqa__dense_activation_mish__prompt_kernel,@function
sequential_preLN__grouped_kv_mqa__dense_activation_mish__prompt_kernel:
  s_cmp_ge_u32 s2, 256
  s_cbranch_scc1 L_pk_end
  s_load_dwordx4 s[4:7], s[0:1], 0
  s_load_dwordx4 s[8:11], s[0:1], 16
  s_load_dwordx2 s[12:13], s[0:1], 32
  s_load_dwordx4 s[40:43], s[0:1], 48
  s_load_dwordx4 s[44:47], s[0:1], 64
  s_load_dwordx2 s[14:15], s[0:1], 88
  v_lshrrev_b32 v2, 6, v0
  v_and_b32 v1, 63, v0
  v_readfirstlane_b32 s3, v2
  s_and_b32 s32, s2, 31
  s_lshr_b32 s33, s2, 5
  v_lshlrev_b32 v7, 4, v1
  v_lshlrev_b32 v6, 7, v1
  s_lshr_b32 s36, s2, 3
  s_getpc_b64 s[20:21]
L_pk_pc:
  s_mov_b32 s22, L_pk_last-L_pk_pc
  s_mov_b32 s23, 0x20000
  s_lshl_b32 s37, s36, 3
  s_add_u32 s37, s37, s3
  s_lshl_b32 s37, s37, 8
  s_mov_b64 exec, 3
  buffer_load_dword v255, v6, s[20:23], s37 offen
  s_mov_b64 exec, -1
  s_mov_b32 s49, 2457600
  v_mov_b32 v236, -1
  v_mov_b32 v237, -1
  v_mov_b32 v238, -1
  v_mov_b32 v239, -1
  v_mov_b32 v208, -1
  v_mov_b32 v209, -1
  v_mov_b32 v210, -1
  v_mov_b32 v211, -1
  v_mov_b32 v212, -1
  v_mov_b32 v213, -1
  v_mov_b32 v214, -1
  v_mov_b32 v215, -1
  v_lshrrev_b32 v3, 3, v1
  v_and_b32 v4, 7, v1
  v_mul_u32_u24 v2, 896, v3
  v_lshl_add_u32 v5, v4, 4, v2
  s_and_b32 s38, s33, 1
  s_lshl_b32 s38, s38, 2
  s_xor_b32 s38, s38, s3
  s_lshl_b32 s35, s32, 3
  s_add_u32 s35, s35, s38
  s_mul_i32 s35, s35, 7168
  s_mov_b32 s18, 1835008
  s_mov_b32 s19, 0x20000
  s_and_b32 s37, s38, 3
  s_lshl_b32 s37, s37, 7
  s_lshr_b32 s38, s38, 2
  s_mul_i32 s38, s38, 29568
  s_add_u32 s38, s38, s37
  s_add_u32 s38, s38, 32768
  v_mul_u32_u24 v116, 528, v4
  v_lshl_add_u32 v116, v3, 4, v116
  v_add_u32 v116, s38, v116
  s_cmp_ge_u32 s3, 4
  s_cbranch_scc1 L_pk_ld
  s_mul_i32 s37, s2, 1664
  s_cmp_eq_u32 s3, 3
  s_cselect_b32 s22, 401408, 0
  s_mov_b32 s23, 0x20000
  s_waitcnt lgkmcnt(0)
  s_mov_b32 s16, s4
  s_mov_b32 s17, s5
  buffer_load_dwordx4 v[8:11], v5, s[16:19], s35 offen offset:0
  buffer_load_dwordx4 v[12:15], v5, s[16:19], s35 offen offset:128
  buffer_load_dwordx4 v[16:19], v5, s[16:19], s35 offen offset:256
  buffer_load_dwordx4 v[20:23], v5, s[16:19], s35 offen offset:384
  buffer_load_dwordx4 v[24:27], v5, s[16:19], s35 offen offset:512
  buffer_load_dwordx4 v[28:31], v5, s[16:19], s35 offen offset:640
  buffer_load_dwordx4 v[32:35], v5, s[16:19], s35 offen offset:768
  s_mov_b32 s20, s12
  s_mov_b32 s21, s13
  s_mov_b64 exec, 0x1fff
  buffer_load_dword v254, v6, s[20:23], s37 offen
  s_mov_b64 exec, -1
  s_branch L_pk_ln
L_pk_ld:
  s_sub_u32 s51, s3, 4
  s_mul_i32 s24, s51, 14336
  s_add_u32 s24, s24, 91904
  v_bfe_u32 v121, v1, 4, 1
  v_lshl_add_u32 v121, v121, 2, v4
  v_and_b32 v121, 7, v121
  v_cmp_eq_u32 vcc, 7, v121
  v_lshl_add_u32 v121, v121, 4, v2
  v_cndmask_b32 v121, v121, -1, vcc
  s_mul_i32 s27, s51, 100352
  s_mul_i32 s34, s33, 112
  s_add_u32 s27, s27, s34
  s_mul_i32 s25, s51, 7168
  s_mov_b32 s22, 25088
  s_mov_b32 s23, 0x20000
  s_cmp_lt_u32 s33, 4
  s_cbranch_scc1 L_pk_ldkv
  s_lshl_b32 s36, s36, 2
  s_add_u32 s36, s36, s3
  s_sub_u32 s36, s36, 68
  s_and_b32 s37, s36, 3
  s_sub_u32 s38, s36, 8
  s_cselect_b32 s37, s37, s38
  s_cselect_b32 s22, s22, 401408
  s_lshl_b32 s37, s37, 13
  s_waitcnt lgkmcnt(0)
  s_cmp_lt_u32 s36, 4
  s_cselect_b32 s20, s8, s10
  s_cselect_b32 s21, s9, s11
  s_cmp_lt_u32 s36, 8
  s_cselect_b32 s20, s20, s6
  s_cselect_b32 s21, s21, s7
  buffer_load_dword v254, v6, s[20:23], s37 offen
  s_mov_b32 s16, s4
  s_mov_b32 s17, s5
  buffer_load_dwordx4 v[8:11], v5, s[16:19], s35 offen offset:0
  buffer_load_dwordx4 v[12:15], v5, s[16:19], s35 offen offset:128
  buffer_load_dwordx4 v[16:19], v5, s[16:19], s35 offen offset:256
  buffer_load_dwordx4 v[20:23], v5, s[16:19], s35 offen offset:384
  buffer_load_dwordx4 v[24:27], v5, s[16:19], s35 offen offset:512
  buffer_load_dwordx4 v[28:31], v5, s[16:19], s35 offen offset:640
  buffer_load_dwordx4 v[32:35], v5, s[16:19], s35 offen offset:768
  s_load_dword s48, s[14:15], s49
  s_barrier
  s_branch L_pk_ldq
L_pk_ldkv:
  s_waitcnt lgkmcnt(0)
  s_load_dword s48, s[14:15], s49
  s_cmp_lt_u32 s33, 2
  s_cselect_b32 s20, s8, s10
  s_cselect_b32 s21, s9, s11
  s_barrier
  s_mov_b32 m0, s25
  s_nop 0
  buffer_load_dwordx4 v7, s[20:23], s25 offen lds
  s_add_u32 s25, s25, 1024
  s_mov_b32 m0, s25
  s_nop 0
  buffer_load_dwordx4 v7, s[20:23], s25 offen lds
  s_add_u32 s25, s25, 1024
  s_mov_b32 m0, s25
  s_nop 0
  buffer_load_dwordx4 v7, s[20:23], s25 offen lds
  s_add_u32 s25, s25, 1024
  s_mov_b32 m0, s25
  s_nop 0
  buffer_load_dwordx4 v7, s[20:23], s25 offen lds
  s_add_u32 s25, s25, 1024
  s_mov_b32 m0, s25
  s_nop 0
  buffer_load_dwordx4 v7, s[20:23], s25 offen lds
  s_add_u32 s25, s25, 1024
  s_mov_b32 m0, s25
  s_nop 0
  buffer_load_dwordx4 v7, s[20:23], s25 offen lds
  s_add_u32 s25, s25, 1024
  s_mov_b32 m0, s25
  s_nop 0
  buffer_load_dwordx4 v7, s[20:23], s25 offen lds
  s_add_u32 s25, s25, 1024
  s_waitcnt vmcnt(0)
  s_barrier
  s_mov_b32 s16, s4
  s_mov_b32 s17, s5
  buffer_load_dwordx4 v[8:11], v5, s[16:19], s35 offen offset:0
  buffer_load_dwordx4 v[12:15], v5, s[16:19], s35 offen offset:128
  buffer_load_dwordx4 v[16:19], v5, s[16:19], s35 offen offset:256
  buffer_load_dwordx4 v[20:23], v5, s[16:19], s35 offen offset:384
  buffer_load_dwordx4 v[24:27], v5, s[16:19], s35 offen offset:512
  buffer_load_dwordx4 v[28:31], v5, s[16:19], s35 offen offset:640
  buffer_load_dwordx4 v[32:35], v5, s[16:19], s35 offen offset:768
L_pk_ldq:
  s_mov_b32 s20, s6
  s_mov_b32 s21, s7
  s_mov_b32 s22, 401408
  s_mov_b32 m0, s24
  s_add_u32 s24, s24, 1024
  buffer_load_dwordx4 v121, s[20:23], s27 offen lds
  s_add_u32 s27, s27, 7168
  s_mov_b32 m0, s24
  s_add_u32 s24, s24, 1024
  buffer_load_dwordx4 v121, s[20:23], s27 offen lds
  s_add_u32 s27, s27, 7168
  s_mov_b32 m0, s24
  s_add_u32 s24, s24, 1024
  buffer_load_dwordx4 v121, s[20:23], s27 offen lds
  s_add_u32 s27, s27, 7168
  s_mov_b32 m0, s24
  s_add_u32 s24, s24, 1024
  buffer_load_dwordx4 v121, s[20:23], s27 offen lds
  s_add_u32 s27, s27, 7168
  s_cmp_lt_u32 s33, 4
  s_cbranch_scc1 L_pk_ldw
  s_mov_b32 m0, s24
  s_add_u32 s24, s24, 1024
  buffer_load_dwordx4 v121, s[20:23], s27 offen lds
  s_add_u32 s27, s27, 7168
  s_mov_b32 m0, s24
  s_add_u32 s24, s24, 1024
  buffer_load_dwordx4 v121, s[20:23], s27 offen lds
  s_add_u32 s27, s27, 7168
  s_mov_b32 m0, s24
  s_add_u32 s24, s24, 1024
  buffer_load_dwordx4 v121, s[20:23], s27 offen lds
  s_add_u32 s27, s27, 7168
  s_mov_b32 m0, s24
  s_add_u32 s24, s24, 1024
  buffer_load_dwordx4 v121, s[20:23], s27 offen lds
  s_add_u32 s27, s27, 7168
  s_mov_b32 m0, s24
  s_add_u32 s24, s24, 1024
  buffer_load_dwordx4 v121, s[20:23], s27 offen lds
  s_add_u32 s27, s27, 7168
  s_mov_b32 m0, s24
  s_add_u32 s24, s24, 1024
  buffer_load_dwordx4 v121, s[20:23], s27 offen lds
  s_add_u32 s27, s27, 7168
  s_mov_b32 m0, s24
  s_add_u32 s24, s24, 1024
  buffer_load_dwordx4 v121, s[20:23], s27 offen lds
  s_add_u32 s27, s27, 7168
  s_mov_b32 m0, s24
  s_add_u32 s24, s24, 1024
  buffer_load_dwordx4 v121, s[20:23], s27 offen lds
  s_add_u32 s27, s27, 7168
  s_mov_b32 m0, s24
  s_add_u32 s24, s24, 1024
  buffer_load_dwordx4 v121, s[20:23], s27 offen lds
  s_add_u32 s27, s27, 7168
  s_mov_b32 m0, s24
  s_add_u32 s24, s24, 1024
  buffer_load_dwordx4 v121, s[20:23], s27 offen lds
  s_add_u32 s27, s27, 7168
  s_add_u32 s51, s3, 3
  s_sub_u32 s34, s3, 4
  s_cselect_b32 s51, s51, s34
  s_cmp_eq_u32 s3, 7
  s_cselect_b32 s51, s3, s51
  s_lshl_b32 s51, s51, 7
  s_add_u32 s51, s51, s2
  s_sub_u32 s51, s51, 128
  v_and_b32 v2, 31, v1
  v_lshrrev_b32 v3, 5, v1
  s_mov_b32 s54, 1605632
  s_mov_b32 s55, 0x20000
  s_mov_b32 s52, s40
  s_mov_b32 s53, s41
  s_mov_b32 s50, 0
  s_cmp_ge_u32 s51, 784
  s_cbranch_scc1 L_pkn_pdone
  s_cmp_ge_u32 s51, 392
  s_cbranch_scc1 L_pkn_pw2
  s_mul_i32 s34, s51, 4682
  s_lshr_b32 s34, s34, 16
  s_mul_i32 s35, s34, 14
  s_sub_u32 s35, s51, s35
  s_mul_i32 s16, s34, 57344
  s_lshl_b32 s37, s35, 8
  s_add_u32 s16, s16, s37
  v_mul_u32_u24 v4, 28672, v3
  v_lshl_add_u32 v4, v2, 3, v4
  v_add_u32 v208, s16, v4
  v_add_u32 v209, 7168, v208
  v_add_u32 v210, 7168, v209
  v_add_u32 v211, 7168, v210
  s_mul_i32 s37, s35, 114688
  s_lshl_b32 s36, s34, 10
  s_add_u32 s37, s37, s36
  s_add_u32 s37, s37, 2949120
  v_add_u32 v236, s37, v7
  v_add_u32 v237, 28672, v236
  v_add_u32 v238, 28672, v237
  v_add_u32 v239, 28672, v238
  s_mov_b32 s50, 1
  s_branch L_pkn_pdone
L_pkn_pw2:
  s_sub_u32 s51, s51, 392
  s_mul_i32 s34, s51, 9363
  s_lshr_b32 s34, s34, 16
  s_mul_i32 s35, s34, 7
  s_sub_u32 s35, s51, s35
  s_lshr_b32 s38, s34, 2
  s_lshl_b32 s38, s38, 7
  s_and_b32 s37, s34, 3
  s_add_u32 s38, s38, s37
  s_mul_i32 s16, s38, 896
  s_lshl_b32 s38, s35, 7
  s_add_u32 s16, s16, s38
  v_mul_u32_u24 v4, 14336, v3
  v_lshl_add_u32 v4, v2, 2, v4
  v_add_u32 v208, s16, v4
  v_add_u32 v209, 7168, v208
  v_add_u32 v210, 21504, v209
  v_add_u32 v211, 7168, v210
  v_add_u32 v212, 21504, v211
  v_add_u32 v213, 7168, v212
  v_add_u32 v214, 21504, v213
  v_add_u32 v215, 7168, v214
  s_mov_b32 s52, s44
  s_mov_b32 s53, s45
  s_mul_i32 s36, s34, 147
  s_lshr_b32 s36, s36, 10
  s_mul_i32 s37, s36, 7
  s_sub_u32 s38, s34, s37
  s_add_u32 s37, s37, s35
  s_mul_i32 s37, s37, 7
  s_add_u32 s37, s37, s38
  s_lshl_b32 s37, s37, 12
  s_add_u32 s37, s37, 4587520
  v_add_u32 v236, s37, v7
  v_add_u32 v237, 1024, v236
  v_add_u32 v238, 1024, v237
  v_add_u32 v239, 1024, v238
  s_mov_b32 s50, 2
L_pkn_pdone:
  s_cmp_eq_u32 s50, 0
  s_cbranch_scc1 L_pkn_idone
  s_cmp_eq_u32 s50, 2
  s_cbranch_scc1 L_pkn_i2
  buffer_load_dwordx2 v[220:221], v208, s[52:55], 0 offen offset:0
  buffer_load_dwordx2 v[222:223], v208, s[52:55], 0 offen offset:3584
  buffer_load_dwordx2 v[224:225], v209, s[52:55], 0 offen offset:0
  buffer_load_dwordx2 v[226:227], v209, s[52:55], 0 offen offset:3584
  buffer_load_dwordx2 v[228:229], v210, s[52:55], 0 offen offset:0
  buffer_load_dwordx2 v[230:231], v210, s[52:55], 0 offen offset:3584
  buffer_load_dwordx2 v[232:233], v211, s[52:55], 0 offen offset:0
  buffer_load_dwordx2 v[234:235], v211, s[52:55], 0 offen offset:3584
  s_branch L_pkn_idone
L_pkn_i2:
  buffer_load_dword v220, v208, s[52:55], 0 offen offset:0
  buffer_load_dword v221, v208, s[52:55], 0 offen offset:3584
  buffer_load_dword v222, v209, s[52:55], 0 offen offset:0
  buffer_load_dword v223, v209, s[52:55], 0 offen offset:3584
  buffer_load_dword v224, v210, s[52:55], 0 offen offset:0
  buffer_load_dword v225, v210, s[52:55], 0 offen offset:3584
  buffer_load_dword v226, v211, s[52:55], 0 offen offset:0
  buffer_load_dword v227, v211, s[52:55], 0 offen offset:3584
  buffer_load_dword v228, v212, s[52:55], 0 offen offset:0
  buffer_load_dword v229, v212, s[52:55], 0 offen offset:3584
  buffer_load_dword v230, v213, s[52:55], 0 offen offset:0
  buffer_load_dword v231, v213, s[52:55], 0 offen offset:3584
  buffer_load_dword v232, v214, s[52:55], 0 offen offset:0
  buffer_load_dword v233, v214, s[52:55], 0 offen offset:3584
  buffer_load_dword v234, v215, s[52:55], 0 offen offset:0
  buffer_load_dword v235, v215, s[52:55], 0 offen offset:3584
L_pkn_idone:
  s_waitcnt vmcnt(30)
  s_cmp_eq_u32 s50, 2
  s_cbranch_scc1 L_pk_ldx
  s_waitcnt vmcnt(22)
  s_cmp_eq_u32 s50, 1
  s_cbranch_scc1 L_pk_ldx
  s_waitcnt vmcnt(14)
L_pk_ldx:
  s_branch L_pk_ldn
L_pk_ldw:
  s_waitcnt vmcnt(4)
L_pk_ldn:
  s_mov_b32 s34, 0x3f803f80
  v_dot2_f32_bf16 v96, v8, s34, 0
  v_dot2_f32_bf16 v98, v8, v8, 0
  v_dot2_f32_bf16 v97, v9, s34, 0
  v_dot2_f32_bf16 v99, v9, v9, 0
  v_dot2_f32_bf16 v96, v10, s34, v96
  v_dot2_f32_bf16 v98, v10, v10, v98
  v_dot2_f32_bf16 v97, v11, s34, v97
  v_dot2_f32_bf16 v99, v11, v11, v99
  v_dot2_f32_bf16 v96, v12, s34, v96
  v_dot2_f32_bf16 v98, v12, v12, v98
  v_dot2_f32_bf16 v97, v13, s34, v97
  v_dot2_f32_bf16 v99, v13, v13, v99
  v_dot2_f32_bf16 v96, v14, s34, v96
  v_dot2_f32_bf16 v98, v14, v14, v98
  v_dot2_f32_bf16 v97, v15, s34, v97
  v_dot2_f32_bf16 v99, v15, v15, v99
  v_dot2_f32_bf16 v96, v16, s34, v96
  v_dot2_f32_bf16 v98, v16, v16, v98
  v_dot2_f32_bf16 v97, v17, s34, v97
  v_dot2_f32_bf16 v99, v17, v17, v99
  v_dot2_f32_bf16 v96, v18, s34, v96
  v_dot2_f32_bf16 v98, v18, v18, v98
  v_dot2_f32_bf16 v97, v19, s34, v97
  v_dot2_f32_bf16 v99, v19, v19, v99
  v_dot2_f32_bf16 v96, v20, s34, v96
  v_dot2_f32_bf16 v98, v20, v20, v98
  v_dot2_f32_bf16 v97, v21, s34, v97
  v_dot2_f32_bf16 v99, v21, v21, v99
  v_dot2_f32_bf16 v96, v22, s34, v96
  v_dot2_f32_bf16 v98, v22, v22, v98
  v_dot2_f32_bf16 v97, v23, s34, v97
  v_dot2_f32_bf16 v99, v23, v23, v99
  v_dot2_f32_bf16 v96, v24, s34, v96
  v_dot2_f32_bf16 v98, v24, v24, v98
  v_dot2_f32_bf16 v97, v25, s34, v97
  v_dot2_f32_bf16 v99, v25, v25, v99
  v_dot2_f32_bf16 v96, v26, s34, v96
  v_dot2_f32_bf16 v98, v26, v26, v98
  v_dot2_f32_bf16 v97, v27, s34, v97
  v_dot2_f32_bf16 v99, v27, v27, v99
  v_dot2_f32_bf16 v96, v28, s34, v96
  v_dot2_f32_bf16 v98, v28, v28, v98
  v_dot2_f32_bf16 v97, v29, s34, v97
  v_dot2_f32_bf16 v99, v29, v29, v99
  v_dot2_f32_bf16 v96, v30, s34, v96
  v_dot2_f32_bf16 v98, v30, v30, v98
  v_dot2_f32_bf16 v97, v31, s34, v97
  v_dot2_f32_bf16 v99, v31, v31, v99
  v_dot2_f32_bf16 v96, v32, s34, v96
  v_dot2_f32_bf16 v98, v32, v32, v98
  v_dot2_f32_bf16 v97, v33, s34, v97
  v_dot2_f32_bf16 v99, v33, v33, v99
  v_dot2_f32_bf16 v96, v34, s34, v96
  v_dot2_f32_bf16 v98, v34, v34, v98
  v_dot2_f32_bf16 v97, v35, s34, v97
  v_dot2_f32_bf16 v99, v35, v35, v99
  s_nop 2
  v_add_f32 v96, v96, v97
  v_add_f32 v98, v98, v99
  s_nop 0
  v_add_f32_dpp v96, v96, v96 quad_perm:[1,0,3,2] row_mask:0xf bank_mask:0xf
  v_add_f32_dpp v98, v98, v98 quad_perm:[1,0,3,2] row_mask:0xf bank_mask:0xf
  s_nop 0
  v_add_f32_dpp v96, v96, v96 quad_perm:[2,3,0,1] row_mask:0xf bank_mask:0xf
  v_add_f32_dpp v98, v98, v98 quad_perm:[2,3,0,1] row_mask:0xf bank_mask:0xf
  s_nop 0
  v_add_f32_dpp v96, v96, v96 row_half_mirror row_mask:0xf bank_mask:0xf
  v_add_f32_dpp v98, v98, v98 row_half_mirror row_mask:0xf bank_mask:0xf
  v_mul_f32 v96, 0xbb124925, v96
  v_mul_f32 v98, 0x3b124925, v98
  v_fma_f32 v98, -v96, v96, v98
  v_max_f32 v98, 0, v98
  v_add_f32 v98, 0x3727c5ac, v98
  v_rsq_f32 v100, v98
  v_lshlrev_b32 v64, 16, v8
  v_and_b32 v65, 0xffff0000, v8
  v_mul_f32 v100, 0x3f05abd1, v100
  v_lshlrev_b32 v66, 16, v9
  v_and_b32 v67, 0xffff0000, v9
  v_mul_f32 v102, v96, v100
  v_pk_fma_f32 v[64:65], v[64:65], v[100:101], v[102:103] op_sel_hi:[1,0,0]
  v_lshlrev_b32 v68, 16, v10
  v_and_b32 v69, 0xffff0000, v10
  v_cvt_pk_bf16_f32 v8, v64, v65
  v_pk_fma_f32 v[66:67], v[66:67], v[100:101], v[102:103] op_sel_hi:[1,0,0]
  v_lshlrev_b32 v70, 16, v11
  v_and_b32 v71, 0xffff0000, v11
  v_cvt_pk_bf16_f32 v9, v66, v67
  v_pk_fma_f32 v[68:69], v[68:69], v[100:101], v[102:103] op_sel_hi:[1,0,0]
  v_lshlrev_b32 v64, 16, v12
  v_and_b32 v65, 0xffff0000, v12
  v_cvt_pk_bf16_f32 v10, v68, v69
  v_pk_fma_f32 v[70:71], v[70:71], v[100:101], v[102:103] op_sel_hi:[1,0,0]
  v_lshlrev_b32 v66, 16, v13
  v_and_b32 v67, 0xffff0000, v13
  v_cvt_pk_bf16_f32 v11, v70, v71
  v_pk_fma_f32 v[64:65], v[64:65], v[100:101], v[102:103] op_sel_hi:[1,0,0]
  v_lshlrev_b32 v68, 16, v14
  v_and_b32 v69, 0xffff0000, v14
  v_cvt_pk_bf16_f32 v12, v64, v65
  v_pk_fma_f32 v[66:67], v[66:67], v[100:101], v[102:103] op_sel_hi:[1,0,0]
  v_lshlrev_b32 v70, 16, v15
  v_and_b32 v71, 0xffff0000, v15
  v_cvt_pk_bf16_f32 v13, v66, v67
  v_pk_fma_f32 v[68:69], v[68:69], v[100:101], v[102:103] op_sel_hi:[1,0,0]
  v_lshlrev_b32 v64, 16, v16
  v_and_b32 v65, 0xffff0000, v16
  v_cvt_pk_bf16_f32 v14, v68, v69
  v_pk_fma_f32 v[70:71], v[70:71], v[100:101], v[102:103] op_sel_hi:[1,0,0]
  v_lshlrev_b32 v66, 16, v17
  v_and_b32 v67, 0xffff0000, v17
  v_cvt_pk_bf16_f32 v15, v70, v71
  v_pk_fma_f32 v[64:65], v[64:65], v[100:101], v[102:103] op_sel_hi:[1,0,0]
  v_lshlrev_b32 v68, 16, v18
  v_and_b32 v69, 0xffff0000, v18
  v_cvt_pk_bf16_f32 v16, v64, v65
  v_pk_fma_f32 v[66:67], v[66:67], v[100:101], v[102:103] op_sel_hi:[1,0,0]
  v_lshlrev_b32 v70, 16, v19
  v_and_b32 v71, 0xffff0000, v19
  v_cvt_pk_bf16_f32 v17, v66, v67
  v_pk_fma_f32 v[68:69], v[68:69], v[100:101], v[102:103] op_sel_hi:[1,0,0]
  v_lshlrev_b32 v64, 16, v20
  v_and_b32 v65, 0xffff0000, v20
  v_cvt_pk_bf16_f32 v18, v68, v69
  v_pk_fma_f32 v[70:71], v[70:71], v[100:101], v[102:103] op_sel_hi:[1,0,0]
  v_lshlrev_b32 v66, 16, v21
  v_and_b32 v67, 0xffff0000, v21
  v_cvt_pk_bf16_f32 v19, v70, v71
  v_pk_fma_f32 v[64:65], v[64:65], v[100:101], v[102:103] op_sel_hi:[1,0,0]
  v_lshlrev_b32 v68, 16, v22
  v_and_b32 v69, 0xffff0000, v22
  v_cvt_pk_bf16_f32 v20, v64, v65
  v_pk_fma_f32 v[66:67], v[66:67], v[100:101], v[102:103] op_sel_hi:[1,0,0]
  v_lshlrev_b32 v70, 16, v23
  v_and_b32 v71, 0xffff0000, v23
  v_cvt_pk_bf16_f32 v21, v66, v67
  v_pk_fma_f32 v[68:69], v[68:69], v[100:101], v[102:103] op_sel_hi:[1,0,0]
  v_lshlrev_b32 v64, 16, v24
  v_and_b32 v65, 0xffff0000, v24
  v_cvt_pk_bf16_f32 v22, v68, v69
  v_pk_fma_f32 v[70:71], v[70:71], v[100:101], v[102:103] op_sel_hi:[1,0,0]
  v_lshlrev_b32 v66, 16, v25
  v_and_b32 v67, 0xffff0000, v25
  v_cvt_pk_bf16_f32 v23, v70, v71
  v_pk_fma_f32 v[64:65], v[64:65], v[100:101], v[102:103] op_sel_hi:[1,0,0]
  v_lshlrev_b32 v68, 16, v26
  v_and_b32 v69, 0xffff0000, v26
  v_cvt_pk_bf16_f32 v24, v64, v65
  v_pk_fma_f32 v[66:67], v[66:67], v[100:101], v[102:103] op_sel_hi:[1,0,0]
  v_lshlrev_b32 v70, 16, v27
  v_and_b32 v71, 0xffff0000, v27
  v_cvt_pk_bf16_f32 v25, v66, v67
  v_pk_fma_f32 v[68:69], v[68:69], v[100:101], v[102:103] op_sel_hi:[1,0,0]
  v_lshlrev_b32 v64, 16, v28
  v_and_b32 v65, 0xffff0000, v28
  v_cvt_pk_bf16_f32 v26, v68, v69
  v_pk_fma_f32 v[70:71], v[70:71], v[100:101], v[102:103] op_sel_hi:[1,0,0]
  v_lshlrev_b32 v66, 16, v29
  v_and_b32 v67, 0xffff0000, v29
  v_cvt_pk_bf16_f32 v27, v70, v71
  v_pk_fma_f32 v[64:65], v[64:65], v[100:101], v[102:103] op_sel_hi:[1,0,0]
  v_lshlrev_b32 v68, 16, v30
  v_and_b32 v69, 0xffff0000, v30
  v_cvt_pk_bf16_f32 v28, v64, v65
  v_pk_fma_f32 v[66:67], v[66:67], v[100:101], v[102:103] op_sel_hi:[1,0,0]
  v_lshlrev_b32 v70, 16, v31
  v_and_b32 v71, 0xffff0000, v31
  v_cvt_pk_bf16_f32 v29, v66, v67
  v_pk_fma_f32 v[68:69], v[68:69], v[100:101], v[102:103] op_sel_hi:[1,0,0]
  v_lshlrev_b32 v64, 16, v32
  v_and_b32 v65, 0xffff0000, v32
  v_cvt_pk_bf16_f32 v30, v68, v69
  v_pk_fma_f32 v[70:71], v[70:71], v[100:101], v[102:103] op_sel_hi:[1,0,0]
  v_lshlrev_b32 v66, 16, v33
  v_and_b32 v67, 0xffff0000, v33
  v_cvt_pk_bf16_f32 v31, v70, v71
  v_pk_fma_f32 v[64:65], v[64:65], v[100:101], v[102:103] op_sel_hi:[1,0,0]
  v_lshlrev_b32 v68, 16, v34
  v_and_b32 v69, 0xffff0000, v34
  v_cvt_pk_bf16_f32 v32, v64, v65
  v_pk_fma_f32 v[66:67], v[66:67], v[100:101], v[102:103] op_sel_hi:[1,0,0]
  v_lshlrev_b32 v70, 16, v35
  v_and_b32 v71, 0xffff0000, v35
  v_cvt_pk_bf16_f32 v33, v66, v67
  v_pk_fma_f32 v[68:69], v[68:69], v[100:101], v[102:103] op_sel_hi:[1,0,0]
  v_cvt_pk_bf16_f32 v34, v68, v69
  v_pk_fma_f32 v[70:71], v[70:71], v[100:101], v[102:103] op_sel_hi:[1,0,0]
  v_cvt_pk_bf16_f32 v35, v70, v71
  ds_write_b128 v116, v[8:11] offset:0
  ds_write_b128 v116, v[12:15] offset:4224
  ds_write_b128 v116, v[16:19] offset:8448
  ds_write_b128 v116, v[20:23] offset:12672
  ds_write_b128 v116, v[24:27] offset:16896
  ds_write_b128 v116, v[28:31] offset:21120
  ds_write_b128 v116, v[32:35] offset:25344
  s_cmp_ge_u32 s33, 4
  s_cbranch_scc1 L_pk_ldp
  s_mov_b32 m0, s24
  s_add_u32 s24, s24, 1024
  buffer_load_dwordx4 v121, s[20:23], s27 offen lds
  s_add_u32 s27, s27, 7168
  s_mov_b32 m0, s24
  s_add_u32 s24, s24, 1024
  buffer_load_dwordx4 v121, s[20:23], s27 offen lds
  s_add_u32 s27, s27, 7168
  s_mov_b32 m0, s24
  s_add_u32 s24, s24, 1024
  buffer_load_dwordx4 v121, s[20:23], s27 offen lds
  s_add_u32 s27, s27, 7168
  s_mov_b32 m0, s24
  s_add_u32 s24, s24, 1024
  buffer_load_dwordx4 v121, s[20:23], s27 offen lds
  s_add_u32 s27, s27, 7168
  s_mov_b32 m0, s24
  s_add_u32 s24, s24, 1024
  buffer_load_dwordx4 v121, s[20:23], s27 offen lds
  s_add_u32 s27, s27, 7168
  s_mov_b32 m0, s24
  s_add_u32 s24, s24, 1024
  buffer_load_dwordx4 v121, s[20:23], s27 offen lds
  s_add_u32 s27, s27, 7168
  s_mov_b32 m0, s24
  s_add_u32 s24, s24, 1024
  buffer_load_dwordx4 v121, s[20:23], s27 offen lds
  s_add_u32 s27, s27, 7168
  s_mov_b32 m0, s24
  s_add_u32 s24, s24, 1024
  buffer_load_dwordx4 v121, s[20:23], s27 offen lds
  s_add_u32 s27, s27, 7168
  s_mov_b32 m0, s24
  s_add_u32 s24, s24, 1024
  buffer_load_dwordx4 v121, s[20:23], s27 offen lds
  s_add_u32 s27, s27, 7168
  s_mov_b32 m0, s24
  s_add_u32 s24, s24, 1024
  buffer_load_dwordx4 v121, s[20:23], s27 offen lds
  s_add_u32 s27, s27, 7168
  s_mov_b32 s50, 0
L_pk_ldp:
  s_mov_b32 s28, s14
  s_mov_b32 s29, s15
  s_mov_b32 s30, 29360128
  s_nop 0
L_wm_P1:
  s_cbranch_execz L_wm_L_pk_role1
  s_mov_b32 s31, 0x20000
  s_mov_b32 s16, s4
  s_mov_b32 s17, s5
  s_mov_b32 s18, 1835008
  s_mov_b32 s19, 0x20000
  s_mov_b32 s24, s46
  s_mov_b32 s25, s47
  s_mov_b32 s26, 1835008
  s_mov_b32 s27, 0x20000
  s_mov_b32 s4, s42
  s_mov_b32 s5, s43
  s_mov_b32 s6, 3584
  s_mov_b32 s7, 0x20000
  v_lshlrev_b32 v104, 4, v1
  s_and_b32 s20, s3, 3
  s_lshr_b32 s21, s3, 2
  s_lshl_b32 s34, s21, 14
  v_add_u32 v105, s34, v104
  v_add_u32 v106, 0x10000, v105
  s_lshl_b32 s12, s21, 17
  s_add_u32 s12, s12, 2097152
  s_bfe_u32 s34, s2, 0x30003
  s_lshl_b32 s34, s34, 2
  s_add_u32 s34, s34, s20
  s_lshl_b32 s34, s34, 12
  s_add_u32 s40, s12, s34
  s_lshl_b32 s41, s3, 12
  s_lshl_b32 s43, s32, 3
  s_add_u32 s42, s43, s3
  s_lshl_b32 s42, s42, 14
  s_add_u32 s42, s42, 23068672
  s_add_u32 s44, s43, s3
  s_mul_i32 s44, s44, 7168
  s_add_u32 s43, s43, s33
  s_mul_i32 s13, s33, 112
  s_add_u32 s44, s44, s13
  s_lshl_b32 s22, s33, 3
  s_add_u32 s22, s22, s20
  s_mul_i32 s22, s22, 7168
  s_add_u32 s22, s22, 6553600
  s_mul_i32 s45, s33, 7
  s_add_u32 s45, s45, s3
  s_mul_i32 s23, s43, 57344
  s_mul_i32 s34, s20, 896
  s_add_u32 s51, s23, s34
  s_add_u32 s51, s51, 8388608
  s_mul_i32 s34, s21, 3584
  s_add_u32 s23, s51, s34
  v_and_b32 v2, 7, v1
  v_lshrrev_b32 v3, 3, v1
  v_mul_u32_u24 v0, 896, v2
  v_lshl_add_u32 v0, v3, 4, v0
  v_cmp_gt_u32 vcc, 56, v1
  v_mov_b32 v5, 0x40000000
  v_cndmask_b32 v5, v5, v104, vcc
  v_mov_b32 v107, 0
  s_lshl_b32 s34, s20, 11
  s_add_u32 s34, s34, 149248
  v_add_u32 v110, s34, v104
  v_lshrrev_b32 v2, 4, v1
  v_and_b32 v3, 15, v1
  v_lshrrev_b32 v4, 2, v3
  v_and_b32 v3, 3, v3
  v_lshrrev_b32 v119, 1, v2
  v_lshl_add_u32 v4, v119, 3, v4
  v_and_b32 v2, 1, v2
  v_lshlrev_b32 v2, 5, v2
  v_lshl_add_u32 v2, v3, 3, v2
  v_and_b32 v120, 31, v1
  v_lshrrev_b32 v3, 5, v1
  v_mul_u32_u24 v118, 528, v3
  v_lshl_add_u32 v118, v120, 4, v118
  v_add_u32 v118, 32768, v118
  v_cmp_lt_u32 vcc, 31, v1
  s_bfe_u32 s36, s3, 0x10001
  s_and_b32 s37, s3, 1
  s_mul_i32 s38, s36, 29568
  v_add_u32 v118, s38, v118
  s_mul_i32 s38, s37, 56
  v_add_u32 v2, s38, v2
  v_lshlrev_b32 v119, 5, v4
  v_and_b32 v119, 64, v119
  v_xor_b32 v2, v2, v119
  v_lshl_add_u32 v117, v4, 7, v2
  v_add_u32 v117, 91904, v117
  s_and_b32 s38, s3, 3
  s_lshl_b32 s38, s38, 11
  s_add_u32 s38, s38, 149248
  v_lshl_add_u32 v119, v1, 4, s38
  s_waitcnt lgkmcnt(0)
  s_mul_i32 s48, s48, 0x9E3779B1
  s_add_u32 s48, s48, 0x7F4A7C15
  s_getreg_b32 s49, hwreg(HW_REG_XCC_ID, 0, 4)
  s_not_b32 s34, s48
  v_mov_b32 v2, 159756
  v_mov_b32 v3, s34
  ds_write_b32 v2, v3
  s_waitcnt lgkmcnt(0)
  s_waitcnt vmcnt(16)
  s_cmp_eq_u32 s50, 2
  s_cbranch_scc1 L_pk_ldy
  s_waitcnt vmcnt(8)
  s_cmp_eq_u32 s50, 1
  s_cbranch_scc1 L_pk_ldy
  s_waitcnt vmcnt(0)
L_pk_ldy:
  s_barrier
  s_lshl_b32 s34, s3, 3
  s_add_u32 s34, s34, s33
  s_cmp_lt_u32 s34, 36
  s_cbranch_scc1 L_pk_q
  s_branch L_pk_s1
L_pk_ln:
  s_mov_b32 s50, 0
  s_load_dword s48, s[14:15], s49
  s_mov_b32 s28, s14
  s_mov_b32 s29, s15
  s_mov_b32 s30, 29360128
  s_mov_b32 s31, 0x20000
  s_barrier
  s_mov_b32 s52, s14
  s_mov_b32 s53, s15
  s_mov_b32 s54, 0
  s_mov_b32 s55, 0x20000
  s_cmp_lt_u32 s33, 4
  s_cbranch_scc1 L_pk_lnd
  s_add_u32 s51, s3, 3
  s_sub_u32 s34, s3, 4
  s_cselect_b32 s51, s51, s34
  s_cmp_eq_u32 s3, 7
  s_cselect_b32 s51, s3, s51
  s_lshl_b32 s51, s51, 7
  s_add_u32 s51, s51, s2
  s_sub_u32 s51, s51, 128
  v_and_b32 v2, 31, v1
  v_lshrrev_b32 v3, 5, v1
  s_mov_b32 s54, 1605632
  s_mov_b32 s55, 0x20000
  s_mov_b32 s52, s40
  s_mov_b32 s53, s41
  s_mov_b32 s50, 0
  s_cmp_ge_u32 s51, 784
  s_cbranch_scc1 L_pkq_pwo
  s_cmp_ge_u32 s51, 392
  s_cbranch_scc1 L_pkq_pw2
  s_mul_i32 s34, s51, 4682
  s_lshr_b32 s34, s34, 16
  s_mul_i32 s35, s34, 14
  s_sub_u32 s35, s51, s35
  s_mul_i32 s16, s34, 57344
  s_lshl_b32 s37, s35, 8
  s_add_u32 s16, s16, s37
  v_mul_u32_u24 v4, 28672, v3
  v_lshl_add_u32 v4, v2, 3, v4
  v_add_u32 v208, s16, v4
  v_add_u32 v209, 7168, v208
  v_add_u32 v210, 7168, v209
  v_add_u32 v211, 7168, v210
  s_mul_i32 s37, s35, 114688
  s_lshl_b32 s36, s34, 10
  s_add_u32 s37, s37, s36
  s_add_u32 s37, s37, 2949120
  v_add_u32 v236, s37, v7
  v_add_u32 v237, 28672, v236
  v_add_u32 v238, 28672, v237
  v_add_u32 v239, 28672, v238
  s_mov_b32 s50, 1
  s_branch L_pkq_pdone
L_pkq_pw2:
  s_sub_u32 s51, s51, 392
  s_mul_i32 s34, s51, 9363
  s_lshr_b32 s34, s34, 16
  s_mul_i32 s35, s34, 7
  s_sub_u32 s35, s51, s35
  s_lshr_b32 s38, s34, 2
  s_lshl_b32 s38, s38, 7
  s_and_b32 s37, s34, 3
  s_add_u32 s38, s38, s37
  s_mul_i32 s16, s38, 896
  s_lshl_b32 s38, s35, 7
  s_add_u32 s16, s16, s38
  v_mul_u32_u24 v4, 14336, v3
  v_lshl_add_u32 v4, v2, 2, v4
  v_add_u32 v208, s16, v4
  v_add_u32 v209, 7168, v208
  v_add_u32 v210, 21504, v209
  v_add_u32 v211, 7168, v210
  v_add_u32 v212, 21504, v211
  v_add_u32 v213, 7168, v212
  v_add_u32 v214, 21504, v213
  v_add_u32 v215, 7168, v214
  s_mov_b32 s52, s44
  s_mov_b32 s53, s45
  s_mul_i32 s36, s34, 147
  s_lshr_b32 s36, s36, 10
  s_mul_i32 s37, s36, 7
  s_sub_u32 s38, s34, s37
  s_add_u32 s37, s37, s35
  s_mul_i32 s37, s37, 7
  s_add_u32 s37, s37, s38
  s_lshl_b32 s37, s37, 12
  s_add_u32 s37, s37, 4587520
  v_add_u32 v236, s37, v7
  v_add_u32 v237, 1024, v236
  v_add_u32 v238, 1024, v237
  v_add_u32 v239, 1024, v238
  s_mov_b32 s50, 2
  s_branch L_pkq_pdone
L_pkq_pwo:
  s_sub_u32 s51, s51, 784
  s_mul_i32 s34, s51, 4682
  s_lshr_b32 s34, s34, 16
  s_lshl_b32 s35, s51, 12
  s_add_u32 s35, s35, 6553600
  v_add_u32 v236, s35, v7
  v_add_u32 v237, 1024, v236
  v_add_u32 v238, 1024, v237
  v_add_u32 v239, 1024, v238
  s_mul_i32 s35, s34, 14
  s_sub_u32 s35, s51, s35
  s_lshl_b32 s35, s35, 2
  s_mul_i32 s34, s34, 112
  v_bfe_u32 v2, v1, 4, 1
  v_and_b32 v4, 7, v1
  v_lshl_add_u32 v2, v2, 2, v4
  v_and_b32 v2, 7, v2
  v_cmp_eq_u32 vcc, 7, v2
  v_bfe_u32 v4, v1, 3, 2
  v_mul_u32_u24 v4, 896, v4
  v_lshl_add_u32 v2, v2, 4, v4
  v_add_u32 v2, s34, v2
  s_mov_b32 s52, 538706944
  s_mov_b32 s53, 1322000
  s_mul_i32 s36, s35, 9363
  s_lshr_b32 s36, s36, 16
  s_mul_i32 s37, s36, 7
  s_sub_u32 s37, s35, s37
  s_cmp_eq_u32 s37, 6
  s_cselect_b32 s38, 28, 8
  s_mul_i32 s38, s38, 896
  s_lshl_b32 s37, s37, 3
  s_lshr_b64 s[54:55], s[52:53], s37
  s_and_b32 s37, s54, 0xff
  s_mul_i32 s36, s36, 56
  s_add_u32 s36, s36, s37
  s_mul_i32 s36, s36, 896
  v_mul_u32_u24 v4, s38, v3
  v_add3_u32 v208, v2, v4, s36
  v_cndmask_b32 v208, v208, -1, vcc
  s_add_u32 s35, s35, 1
  s_mul_i32 s36, s35, 9363
  s_lshr_b32 s36, s36, 16
  s_mul_i32 s37, s36, 7
  s_sub_u32 s37, s35, s37
  s_cmp_eq_u32 s37, 6
  s_cselect_b32 s38, 28, 8
  s_mul_i32 s38, s38, 896
  s_lshl_b32 s37, s37, 3
  s_lshr_b64 s[54:55], s[52:53], s37
  s_and_b32 s37, s54, 0xff
  s_mul_i32 s36, s36, 56
  s_add_u32 s36, s36, s37
  s_mul_i32 s36, s36, 896
  v_mul_u32_u24 v4, s38, v3
  v_add3_u32 v209, v2, v4, s36
  v_cndmask_b32 v209, v209, -1, vcc
  s_add_u32 s35, s35, 1
  s_mul_i32 s36, s35, 9363
  s_lshr_b32 s36, s36, 16
  s_mul_i32 s37, s36, 7
  s_sub_u32 s37, s35, s37
  s_cmp_eq_u32 s37, 6
  s_cselect_b32 s38, 28, 8
  s_mul_i32 s38, s38, 896
  s_lshl_b32 s37, s37, 3
  s_lshr_b64 s[54:55], s[52:53], s37
  s_and_b32 s37, s54, 0xff
  s_mul_i32 s36, s36, 56
  s_add_u32 s36, s36, s37
  s_mul_i32 s36, s36, 896
  v_mul_u32_u24 v4, s38, v3
  v_add3_u32 v210, v2, v4, s36
  v_cndmask_b32 v210, v210, -1, vcc
  s_add_u32 s35, s35, 1
  s_mul_i32 s36, s35, 9363
  s_lshr_b32 s36, s36, 16
  s_mul_i32 s37, s36, 7
  s_sub_u32 s37, s35, s37
  s_cmp_eq_u32 s37, 6
  s_cselect_b32 s38, 28, 8
  s_mul_i32 s38, s38, 896
  s_lshl_b32 s37, s37, 3
  s_lshr_b64 s[54:55], s[52:53], s37
  s_and_b32 s37, s54, 0xff
  s_mul_i32 s36, s36, 56
  s_add_u32 s36, s36, s37
  s_mul_i32 s36, s36, 896
  v_mul_u32_u24 v4, s38, v3
  v_add3_u32 v211, v2, v4, s36
  v_cndmask_b32 v211, v211, -1, vcc
  s_add_u32 s35, s35, 1
  s_mov_b32 s52, s12
  s_mov_b32 s53, s13
  s_mov_b32 s54, 401408
  s_mov_b32 s55, 0x20000
  s_mov_b32 s50, 3
L_pkq_pdone:
L_pk_lnd:
  s_mov_b32 s16, s4
  s_mov_b32 s17, s5
  s_mov_b32 s18, 1835008
  s_mov_b32 s19, 0x20000
  s_mov_b32 s24, s46
  s_mov_b32 s25, s47
  s_mov_b32 s26, 1835008
  s_mov_b32 s27, 0x20000
  s_mov_b32 s4, s42
  s_mov_b32 s5, s43
  s_mov_b32 s6, 3584
  s_mov_b32 s7, 0x20000
  v_lshlrev_b32 v104, 4, v1
  s_and_b32 s20, s3, 3
  s_lshr_b32 s21, s3, 2
  s_lshl_b32 s34, s21, 14
  v_add_u32 v105, s34, v104
  v_add_u32 v106, 0x10000, v105
  s_lshl_b32 s12, s21, 17
  s_add_u32 s12, s12, 2097152
  s_bfe_u32 s34, s2, 0x30003
  s_lshl_b32 s34, s34, 2
  s_add_u32 s34, s34, s20
  s_lshl_b32 s34, s34, 12
  s_add_u32 s40, s12, s34
  s_lshl_b32 s41, s3, 12
  s_lshl_b32 s43, s32, 3
  s_add_u32 s42, s43, s3
  s_lshl_b32 s42, s42, 14
  s_add_u32 s42, s42, 23068672
  s_add_u32 s44, s43, s3
  s_mul_i32 s44, s44, 7168
  s_add_u32 s43, s43, s33
  s_mul_i32 s13, s33, 112
  s_add_u32 s44, s44, s13
  s_lshl_b32 s22, s33, 3
  s_add_u32 s22, s22, s20
  s_mul_i32 s22, s22, 7168
  s_add_u32 s22, s22, 6553600
  s_mul_i32 s45, s33, 7
  s_add_u32 s45, s45, s3
  s_mul_i32 s23, s43, 57344
  s_mul_i32 s34, s20, 896
  s_add_u32 s51, s23, s34
  s_add_u32 s51, s51, 8388608
  s_mul_i32 s34, s21, 3584
  s_add_u32 s23, s51, s34
  v_and_b32 v2, 7, v1
  v_lshrrev_b32 v3, 3, v1
  v_mul_u32_u24 v0, 896, v2
  v_lshl_add_u32 v0, v3, 4, v0
  v_cmp_gt_u32 vcc, 56, v1
  v_mov_b32 v5, 0x40000000
  v_cndmask_b32 v5, v5, v104, vcc
  v_mov_b32 v107, 0
  s_lshl_b32 s34, s20, 11
  s_add_u32 s34, s34, 149248
  v_add_u32 v110, s34, v104
  v_lshrrev_b32 v2, 4, v1
  v_and_b32 v3, 15, v1
  v_lshrrev_b32 v4, 2, v3
  v_and_b32 v3, 3, v3
  v_lshrrev_b32 v119, 1, v2
  v_lshl_add_u32 v4, v119, 3, v4
  v_and_b32 v2, 1, v2
  v_lshlrev_b32 v2, 5, v2
  v_lshl_add_u32 v2, v3, 3, v2
  v_and_b32 v120, 31, v1
  v_lshrrev_b32 v3, 5, v1
  v_mul_u32_u24 v118, 528, v3
  v_lshl_add_u32 v118, v120, 4, v118
  v_add_u32 v118, 32768, v118
  v_cmp_lt_u32 vcc, 31, v1
  s_bfe_u32 s36, s3, 0x10001
  s_and_b32 s37, s3, 1
  s_lshl_b32 s38, s3, 2
  s_or_b32 s38, s38, s33
  s_cmp_lt_u32 s38, 4
  s_cbranch_scc1 L_pk_akv
  s_mul_i32 s38, s36, 29568
  v_add_u32 v118, s38, v118
  s_mul_i32 s38, s37, 56
  v_add_u32 v2, s38, v2
  v_lshlrev_b32 v119, 5, v4
  v_and_b32 v119, 64, v119
  v_xor_b32 v2, v2, v119
  v_lshl_add_u32 v117, v4, 7, v2
  v_add_u32 v117, 91904, v117
  s_and_b32 s38, s3, 3
  s_lshl_b32 s38, s38, 11
  s_add_u32 s38, s38, 149248
  v_lshl_add_u32 v119, v1, 4, s38
  s_branch L_pk_adone
L_pk_akv:
  s_and_b32 s37, s33, 1
  s_mul_i32 s38, s37, 29568
  v_add_u32 v118, s38, v118
  v_mul_u32_u24 v117, 56, v4
  v_add_u32 v117, v117, v2
  s_lshl_b32 s39, s32, 1
  s_add_u32 s39, s39, s37
  s_lshl_b32 s39, s39, 12
  s_add_u32 s39, s39, 2097152
  v_lshlrev_b32 v119, 4, v1
L_pk_adone:
  v_mov_b32 v4, 0
  s_lshl_b32 s34, s3, 2
  s_or_b32 s34, s34, s33
  s_cmp_lt_u32 s34, 2
  s_cbranch_scc1 L_pk_k
  s_cmp_lt_u32 s34, 4
  s_cbranch_scc1 L_pk_v
  s_cmp_lg_u32 s3, 3
  s_cbranch_scc1 L_pk_lnx
  s_lshl_b32 s51, s32, 4
  s_add_u32 s51, s51, s33
  s_lshl_b32 s51, s51, 3
  s_add_u32 s51, s51, 1884160
  s_waitcnt lgkmcnt(0)
  s_mul_i32 s34, s48, 0x9E3779B1
  s_add_u32 s34, s34, 0x7F4A7C15
  s_getreg_b32 s35, hwreg(HW_REG_XCC_ID, 0, 4)
  v_mov_b32 v2, s34
  v_mov_b32 v3, s35
  s_mov_b64 exec, 1
  buffer_store_dwordx2 v[2:3], v4, s[28:31], s51 offen sc1
  s_mov_b64 exec, -1
  s_waitcnt vmcnt(2)
  s_branch L_pk_lny
L_pk_lnx:
  s_waitcnt vmcnt(1)
L_pk_lny:
  s_mov_b32 s34, 0x3f803f80
  v_dot2_f32_bf16 v96, v8, s34, 0
  v_dot2_f32_bf16 v98, v8, v8, 0
  v_dot2_f32_bf16 v97, v9, s34, 0
  v_dot2_f32_bf16 v99, v9, v9, 0
  v_dot2_f32_bf16 v96, v10, s34, v96
  v_dot2_f32_bf16 v98, v10, v10, v98
  v_dot2_f32_bf16 v97, v11, s34, v97
  v_dot2_f32_bf16 v99, v11, v11, v99
  v_dot2_f32_bf16 v96, v12, s34, v96
  v_dot2_f32_bf16 v98, v12, v12, v98
  v_dot2_f32_bf16 v97, v13, s34, v97
  v_dot2_f32_bf16 v99, v13, v13, v99
  v_dot2_f32_bf16 v96, v14, s34, v96
  v_dot2_f32_bf16 v98, v14, v14, v98
  v_dot2_f32_bf16 v97, v15, s34, v97
  v_dot2_f32_bf16 v99, v15, v15, v99
  v_dot2_f32_bf16 v96, v16, s34, v96
  v_dot2_f32_bf16 v98, v16, v16, v98
  v_dot2_f32_bf16 v97, v17, s34, v97
  v_dot2_f32_bf16 v99, v17, v17, v99
  v_dot2_f32_bf16 v96, v18, s34, v96
  v_dot2_f32_bf16 v98, v18, v18, v98
  v_dot2_f32_bf16 v97, v19, s34, v97
  v_dot2_f32_bf16 v99, v19, v19, v99
  v_dot2_f32_bf16 v96, v20, s34, v96
  v_dot2_f32_bf16 v98, v20, v20, v98
  v_dot2_f32_bf16 v97, v21, s34, v97
  v_dot2_f32_bf16 v99, v21, v21, v99
  v_dot2_f32_bf16 v96, v22, s34, v96
  v_dot2_f32_bf16 v98, v22, v22, v98
  v_dot2_f32_bf16 v97, v23, s34, v97
  v_dot2_f32_bf16 v99, v23, v23, v99
  v_dot2_f32_bf16 v96, v24, s34, v96
  v_dot2_f32_bf16 v98, v24, v24, v98
  v_dot2_f32_bf16 v97, v25, s34, v97
  v_dot2_f32_bf16 v99, v25, v25, v99
  v_dot2_f32_bf16 v96, v26, s34, v96
  v_dot2_f32_bf16 v98, v26, v26, v98
  v_dot2_f32_bf16 v97, v27, s34, v97
  v_dot2_f32_bf16 v99, v27, v27, v99
  v_dot2_f32_bf16 v96, v28, s34, v96
  v_dot2_f32_bf16 v98, v28, v28, v98
  v_dot2_f32_bf16 v97, v29, s34, v97
  v_dot2_f32_bf16 v99, v29, v29, v99
  v_dot2_f32_bf16 v96, v30, s34, v96
  v_dot2_f32_bf16 v98, v30, v30, v98
  v_dot2_f32_bf16 v97, v31, s34, v97
  v_dot2_f32_bf16 v99, v31, v31, v99
  v_dot2_f32_bf16 v96, v32, s34, v96
  v_dot2_f32_bf16 v98, v32, v32, v98
  v_dot2_f32_bf16 v97, v33, s34, v97
  v_dot2_f32_bf16 v99, v33, v33, v99
  v_dot2_f32_bf16 v96, v34, s34, v96
  v_dot2_f32_bf16 v98, v34, v34, v98
  v_dot2_f32_bf16 v97, v35, s34, v97
  v_dot2_f32_bf16 v99, v35, v35, v99
  s_nop 2
  v_add_f32 v96, v96, v97
  v_add_f32 v98, v98, v99
  s_nop 0
  v_add_f32_dpp v96, v96, v96 quad_perm:[1,0,3,2] row_mask:0xf bank_mask:0xf
  v_add_f32_dpp v98, v98, v98 quad_perm:[1,0,3,2] row_mask:0xf bank_mask:0xf
  s_nop 0
  v_add_f32_dpp v96, v96, v96 quad_perm:[2,3,0,1] row_mask:0xf bank_mask:0xf
  v_add_f32_dpp v98, v98, v98 quad_perm:[2,3,0,1] row_mask:0xf bank_mask:0xf
  s_nop 0
  v_add_f32_dpp v96, v96, v96 row_half_mirror row_mask:0xf bank_mask:0xf
  v_add_f32_dpp v98, v98, v98 row_half_mirror row_mask:0xf bank_mask:0xf
  v_mul_f32 v96, 0xbb124925, v96
  v_mul_f32 v98, 0x3b124925, v98
  v_fma_f32 v98, -v96, v96, v98
  v_max_f32 v98, 0, v98
  v_add_f32 v98, 0x3727c5ac, v98
  v_rsq_f32 v100, v98
  v_lshlrev_b32 v64, 16, v8
  v_and_b32 v65, 0xffff0000, v8
  v_mul_f32 v100, 0x3f05abd1, v100
  v_lshlrev_b32 v66, 16, v9
  v_and_b32 v67, 0xffff0000, v9
  v_mul_f32 v102, v96, v100
  v_pk_fma_f32 v[64:65], v[64:65], v[100:101], v[102:103] op_sel_hi:[1,0,0]
  v_lshlrev_b32 v68, 16, v10
  v_and_b32 v69, 0xffff0000, v10
  v_cvt_pk_bf16_f32 v8, v64, v65
  v_pk_fma_f32 v[66:67], v[66:67], v[100:101], v[102:103] op_sel_hi:[1,0,0]
  v_lshlrev_b32 v70, 16, v11
  v_and_b32 v71, 0xffff0000, v11
  v_cvt_pk_bf16_f32 v9, v66, v67
  v_pk_fma_f32 v[68:69], v[68:69], v[100:101], v[102:103] op_sel_hi:[1,0,0]
  v_lshlrev_b32 v64, 16, v12
  v_and_b32 v65, 0xffff0000, v12
  v_cvt_pk_bf16_f32 v10, v68, v69
  v_pk_fma_f32 v[70:71], v[70:71], v[100:101], v[102:103] op_sel_hi:[1,0,0]
  v_lshlrev_b32 v66, 16, v13
  v_and_b32 v67, 0xffff0000, v13
  v_cvt_pk_bf16_f32 v11, v70, v71
  v_pk_fma_f32 v[64:65], v[64:65], v[100:101], v[102:103] op_sel_hi:[1,0,0]
  v_lshlrev_b32 v68, 16, v14
  v_and_b32 v69, 0xffff0000, v14
  v_cvt_pk_bf16_f32 v12, v64, v65
  v_pk_fma_f32 v[66:67], v[66:67], v[100:101], v[102:103] op_sel_hi:[1,0,0]
  v_lshlrev_b32 v70, 16, v15
  v_and_b32 v71, 0xffff0000, v15
  v_cvt_pk_bf16_f32 v13, v66, v67
  v_pk_fma_f32 v[68:69], v[68:69], v[100:101], v[102:103] op_sel_hi:[1,0,0]
  v_lshlrev_b32 v64, 16, v16
  v_and_b32 v65, 0xffff0000, v16
  v_cvt_pk_bf16_f32 v14, v68, v69
  v_pk_fma_f32 v[70:71], v[70:71], v[100:101], v[102:103] op_sel_hi:[1,0,0]
  v_lshlrev_b32 v66, 16, v17
  v_and_b32 v67, 0xffff0000, v17
  v_cvt_pk_bf16_f32 v15, v70, v71
  v_pk_fma_f32 v[64:65], v[64:65], v[100:101], v[102:103] op_sel_hi:[1,0,0]
  v_lshlrev_b32 v68, 16, v18
  v_and_b32 v69, 0xffff0000, v18
  v_cvt_pk_bf16_f32 v16, v64, v65
  v_pk_fma_f32 v[66:67], v[66:67], v[100:101], v[102:103] op_sel_hi:[1,0,0]
  v_lshlrev_b32 v70, 16, v19
  v_and_b32 v71, 0xffff0000, v19
  v_cvt_pk_bf16_f32 v17, v66, v67
  v_pk_fma_f32 v[68:69], v[68:69], v[100:101], v[102:103] op_sel_hi:[1,0,0]
  v_lshlrev_b32 v64, 16, v20
  v_and_b32 v65, 0xffff0000, v20
  v_cvt_pk_bf16_f32 v18, v68, v69
  v_pk_fma_f32 v[70:71], v[70:71], v[100:101], v[102:103] op_sel_hi:[1,0,0]
  v_lshlrev_b32 v66, 16, v21
  v_and_b32 v67, 0xffff0000, v21
  v_cvt_pk_bf16_f32 v19, v70, v71
  v_pk_fma_f32 v[64:65], v[64:65], v[100:101], v[102:103] op_sel_hi:[1,0,0]
  v_lshlrev_b32 v68, 16, v22
  v_and_b32 v69, 0xffff0000, v22
  v_cvt_pk_bf16_f32 v20, v64, v65
  v_pk_fma_f32 v[66:67], v[66:67], v[100:101], v[102:103] op_sel_hi:[1,0,0]
  v_lshlrev_b32 v70, 16, v23
  v_and_b32 v71, 0xffff0000, v23
  v_cvt_pk_bf16_f32 v21, v66, v67
  v_pk_fma_f32 v[68:69], v[68:69], v[100:101], v[102:103] op_sel_hi:[1,0,0]
  v_lshlrev_b32 v64, 16, v24
  v_and_b32 v65, 0xffff0000, v24
  v_cvt_pk_bf16_f32 v22, v68, v69
  v_pk_fma_f32 v[70:71], v[70:71], v[100:101], v[102:103] op_sel_hi:[1,0,0]
  v_lshlrev_b32 v66, 16, v25
  v_and_b32 v67, 0xffff0000, v25
  v_cvt_pk_bf16_f32 v23, v70, v71
  v_pk_fma_f32 v[64:65], v[64:65], v[100:101], v[102:103] op_sel_hi:[1,0,0]
  v_lshlrev_b32 v68, 16, v26
  v_and_b32 v69, 0xffff0000, v26
  v_cvt_pk_bf16_f32 v24, v64, v65
  v_pk_fma_f32 v[66:67], v[66:67], v[100:101], v[102:103] op_sel_hi:[1,0,0]
  v_lshlrev_b32 v70, 16, v27
  v_and_b32 v71, 0xffff0000, v27
  v_cvt_pk_bf16_f32 v25, v66, v67
  v_pk_fma_f32 v[68:69], v[68:69], v[100:101], v[102:103] op_sel_hi:[1,0,0]
  v_lshlrev_b32 v64, 16, v28
  v_and_b32 v65, 0xffff0000, v28
  v_cvt_pk_bf16_f32 v26, v68, v69
  v_pk_fma_f32 v[70:71], v[70:71], v[100:101], v[102:103] op_sel_hi:[1,0,0]
  v_lshlrev_b32 v66, 16, v29
  v_and_b32 v67, 0xffff0000, v29
  v_cvt_pk_bf16_f32 v27, v70, v71
  v_pk_fma_f32 v[64:65], v[64:65], v[100:101], v[102:103] op_sel_hi:[1,0,0]
  v_lshlrev_b32 v68, 16, v30
  v_and_b32 v69, 0xffff0000, v30
  v_cvt_pk_bf16_f32 v28, v64, v65
  v_pk_fma_f32 v[66:67], v[66:67], v[100:101], v[102:103] op_sel_hi:[1,0,0]
  v_lshlrev_b32 v70, 16, v31
  v_and_b32 v71, 0xffff0000, v31
  v_cvt_pk_bf16_f32 v29, v66, v67
  v_pk_fma_f32 v[68:69], v[68:69], v[100:101], v[102:103] op_sel_hi:[1,0,0]
  v_lshlrev_b32 v64, 16, v32
  v_and_b32 v65, 0xffff0000, v32
  v_cvt_pk_bf16_f32 v30, v68, v69
  v_pk_fma_f32 v[70:71], v[70:71], v[100:101], v[102:103] op_sel_hi:[1,0,0]
  v_lshlrev_b32 v66, 16, v33
  v_and_b32 v67, 0xffff0000, v33
  v_cvt_pk_bf16_f32 v31, v70, v71
  v_pk_fma_f32 v[64:65], v[64:65], v[100:101], v[102:103] op_sel_hi:[1,0,0]
  v_lshlrev_b32 v68, 16, v34
  v_and_b32 v69, 0xffff0000, v34
  v_cvt_pk_bf16_f32 v32, v64, v65
  v_pk_fma_f32 v[66:67], v[66:67], v[100:101], v[102:103] op_sel_hi:[1,0,0]
  v_lshlrev_b32 v70, 16, v35
  v_and_b32 v71, 0xffff0000, v35
  v_cvt_pk_bf16_f32 v33, v66, v67
  v_pk_fma_f32 v[68:69], v[68:69], v[100:101], v[102:103] op_sel_hi:[1,0,0]
  v_cvt_pk_bf16_f32 v34, v68, v69
  v_pk_fma_f32 v[70:71], v[70:71], v[100:101], v[102:103] op_sel_hi:[1,0,0]
  v_cvt_pk_bf16_f32 v35, v70, v71
  ds_write_b128 v116, v[8:11] offset:0
  ds_write_b128 v116, v[12:15] offset:4224
  ds_write_b128 v116, v[16:19] offset:8448
  ds_write_b128 v116, v[20:23] offset:12672
  ds_write_b128 v116, v[24:27] offset:16896
  ds_write_b128 v116, v[28:31] offset:21120
  ds_write_b128 v116, v[32:35] offset:25344
  s_waitcnt lgkmcnt(0)
  s_mul_i32 s48, s48, 0x9E3779B1
  s_add_u32 s48, s48, 0x7F4A7C15
  s_getreg_b32 s49, hwreg(HW_REG_XCC_ID, 0, 4)
  s_cmp_lt_u32 s33, 4
  s_cbranch_scc1 L_pk_lnk
  s_cmp_eq_u32 s50, 0
  s_cbranch_scc1 L_pkq_idone
  s_cmp_lg_u32 s50, 3
  s_cbranch_scc1 L_pkq_i1
  buffer_load_dwordx4 v[240:243], v208, s[52:55], 0 offen
  buffer_load_dwordx4 v[244:247], v209, s[52:55], 0 offen
  buffer_load_dwordx4 v[248:251], v210, s[52:55], 0 offen
  buffer_load_dwordx4 v[252:255], v211, s[52:55], 0 offen
  s_branch L_pkq_idone
L_pkq_i1:
  s_cmp_eq_u32 s50, 2
  s_cbranch_scc1 L_pkq_i2
  buffer_load_dwordx2 v[220:221], v208, s[52:55], 0 offen offset:0
  buffer_load_dwordx2 v[222:223], v208, s[52:55], 0 offen offset:3584
  buffer_load_dwordx2 v[224:225], v209, s[52:55], 0 offen offset:0
  buffer_load_dwordx2 v[226:227], v209, s[52:55], 0 offen offset:3584
  buffer_load_dwordx2 v[228:229], v210, s[52:55], 0 offen offset:0
  buffer_load_dwordx2 v[230:231], v210, s[52:55], 0 offen offset:3584
  buffer_load_dwordx2 v[232:233], v211, s[52:55], 0 offen offset:0
  buffer_load_dwordx2 v[234:235], v211, s[52:55], 0 offen offset:3584
  s_branch L_pkq_idone
L_pkq_i2:
  buffer_load_dword v220, v208, s[52:55], 0 offen offset:0
  buffer_load_dword v221, v208, s[52:55], 0 offen offset:3584
  buffer_load_dword v222, v209, s[52:55], 0 offen offset:0
  buffer_load_dword v223, v209, s[52:55], 0 offen offset:3584
  buffer_load_dword v224, v210, s[52:55], 0 offen offset:0
  buffer_load_dword v225, v210, s[52:55], 0 offen offset:3584
  buffer_load_dword v226, v211, s[52:55], 0 offen offset:0
  buffer_load_dword v227, v211, s[52:55], 0 offen offset:3584
  buffer_load_dword v228, v212, s[52:55], 0 offen offset:0
  buffer_load_dword v229, v212, s[52:55], 0 offen offset:3584
  buffer_load_dword v230, v213, s[52:55], 0 offen offset:0
  buffer_load_dword v231, v213, s[52:55], 0 offen offset:3584
  buffer_load_dword v232, v214, s[52:55], 0 offen offset:0
  buffer_load_dword v233, v214, s[52:55], 0 offen offset:3584
  buffer_load_dword v234, v215, s[52:55], 0 offen offset:0
  buffer_load_dword v235, v215, s[52:55], 0 offen offset:3584
L_pkq_idone:
  s_branch L_pk_lnq
L_pk_lnk:
  s_barrier
L_pk_lnq:
  s_mov_b64 exec, 0
  s_cmp_eq_u32 s3, 1
  s_cbranch_scc1 L_wm_P3
  s_cmp_eq_u32 s3, 2
  s_cbranch_scc1 L_wm_P1
  s_cmp_eq_u32 s3, 3
  s_cbranch_scc1 L_wm_P2
L_wm_back0:
  s_mov_b64 exec, -1
L_pk_lnw:
  s_barrier
L_pk_q:
  ds_read_b64_tr_b16 v[40:41], v117 offset:0
L_wm_P2:
  s_cbranch_execz L_wm_P6
  ds_read_b64_tr_b16 v[42:43], v117 offset:512
  ds_read_b128 v[44:47], v118 offset:0
  ds_read_b64_tr_b16 v[48:49], v117 offset:2048
  ds_read_b64_tr_b16 v[50:51], v117 offset:2560
  ds_read_b128 v[52:55], v118 offset:1056
  ds_read_b64_tr_b16 v[56:57], v117 offset:4096
  ds_read_b64_tr_b16 v[58:59], v117 offset:4608
  ds_read_b128 v[60:63], v118 offset:2112
  ds_read_b64_tr_b16 v[64:65], v117 offset:6144
  ds_read_b64_tr_b16 v[66:67], v117 offset:6656
  ds_read_b128 v[68:71], v118 offset:3168
  ds_read_b64_tr_b16 v[72:73], v117 offset:8192
  ds_read_b64_tr_b16 v[74:75], v117 offset:8704
  ds_read_b128 v[76:79], v118 offset:4224
  s_waitcnt lgkmcnt(12)
  v_mfma_f32_32x32x16_bf16 v[8:23], v[40:43], v[44:47], 0
  ds_read_b64_tr_b16 v[40:41], v117 offset:10240
  ds_read_b64_tr_b16 v[42:43], v117 offset:10752
  ds_read_b128 v[44:47], v118 offset:5280
  s_waitcnt lgkmcnt(12)
  v_mfma_f32_32x32x16_bf16 v[8:23], v[48:51], v[52:55], v[8:23]
  ds_read_b64_tr_b16 v[48:49], v117 offset:12288
  ds_read_b64_tr_b16 v[50:51], v117 offset:12800
  ds_read_b128 v[52:55], v118 offset:6336
  s_waitcnt lgkmcnt(12)
  v_mfma_f32_32x32x16_bf16 v[8:23], v[56:59], v[60:63], v[8:23]
  ds_read_b64_tr_b16 v[56:57], v117 offset:14336
  ds_read_b64_tr_b16 v[58:59], v117 offset:14848
  ds_read_b128 v[60:63], v118 offset:7392
  s_waitcnt lgkmcnt(12)
  v_mfma_f32_32x32x16_bf16 v[8:23], v[64:67], v[68:71], v[8:23]
  ds_read_b64_tr_b16 v[64:65], v117 offset:16384
  ds_read_b64_tr_b16 v[66:67], v117 offset:16896
  ds_read_b128 v[68:71], v118 offset:8448
  s_waitcnt lgkmcnt(12)
  v_mfma_f32_32x32x16_bf16 v[8:23], v[72:75], v[76:79], v[8:23]
  ds_read_b64_tr_b16 v[72:73], v117 offset:18432
  ds_read_b64_tr_b16 v[74:75], v117 offset:18944
  ds_read_b128 v[76:79], v118 offset:9504
  s_waitcnt lgkmcnt(12)
  v_mfma_f32_32x32x16_bf16 v[8:23], v[40:43], v[44:47], v[8:23]
  ds_read_b64_tr_b16 v[40:41], v117 offset:20480
  ds_read_b64_tr_b16 v[42:43], v117 offset:20992
  ds_read_b128 v[44:47], v118 offset:10560
  s_waitcnt lgkmcnt(12)
  v_mfma_f32_32x32x16_bf16 v[8:23], v[48:51], v[52:55], v[8:23]
  ds_read_b64_tr_b16 v[48:49], v117 offset:22528
  ds_read_b64_tr_b16 v[50:51], v117 offset:23040
  ds_read_b128 v[52:55], v118 offset:11616
  s_waitcnt lgkmcnt(12)
  v_mfma_f32_32x32x16_bf16 v[8:23], v[56:59], v[60:63], v[8:23]
  ds_read_b64_tr_b16 v[56:57], v117 offset:24576
  ds_read_b64_tr_b16 v[58:59], v117 offset:25088
  ds_read_b128 v[60:63], v118 offset:12672
  s_waitcnt lgkmcnt(12)
  v_mfma_f32_32x32x16_bf16 v[8:23], v[64:67], v[68:71], v[8:23]
  ds_read_b64_tr_b16 v[64:65], v117 offset:26624
  ds_read_b64_tr_b16 v[66:67], v117 offset:27136
  ds_read_b128 v[68:71], v118 offset:13728
  s_waitcnt lgkmcnt(12)
  v_mfma_f32_32x32x16_bf16 v[8:23], v[72:75], v[76:79], v[8:23]
  ds_read_b64_tr_b16 v[72:73], v117 offset:28672
  ds_read_b64_tr_b16 v[74:75], v117 offset:29184
  ds_read_b128 v[76:79], v118 offset:14784
  s_waitcnt lgkmcnt(12)
  v_mfma_f32_32x32x16_bf16 v[8:23], v[40:43], v[44:47], v[8:23]
  ds_read_b64_tr_b16 v[40:41], v117 offset:30720
  ds_read_b64_tr_b16 v[42:43], v117 offset:31232
  ds_read_b128 v[44:47], v118 offset:15840
  s_waitcnt lgkmcnt(12)
  v_mfma_f32_32x32x16_bf16 v[8:23], v[48:51], v[52:55], v[8:23]
  ds_read_b64_tr_b16 v[48:49], v117 offset:32768
  ds_read_b64_tr_b16 v[50:51], v117 offset:33280
  ds_read_b128 v[52:55], v118 offset:16896
  s_waitcnt lgkmcnt(12)
  v_mfma_f32_32x32x16_bf16 v[8:23], v[56:59], v[60:63], v[8:23]
  ds_read_b64_tr_b16 v[56:57], v117 offset:34816
  ds_read_b64_tr_b16 v[58:59], v117 offset:35328
  ds_read_b128 v[60:63], v118 offset:17952
  s_waitcnt lgkmcnt(12)
  v_mfma_f32_32x32x16_bf16 v[8:23], v[64:67], v[68:71], v[8:23]
  ds_read_b64_tr_b16 v[64:65], v117 offset:36864
  ds_read_b64_tr_b16 v[66:67], v117 offset:37376
  ds_read_b128 v[68:71], v118 offset:19008
  s_waitcnt lgkmcnt(12)
  v_mfma_f32_32x32x16_bf16 v[8:23], v[72:75], v[76:79], v[8:23]
  ds_read_b64_tr_b16 v[72:73], v117 offset:38912
  ds_read_b64_tr_b16 v[74:75], v117 offset:39424
  ds_read_b128 v[76:79], v118 offset:20064
  s_waitcnt lgkmcnt(12)
  v_mfma_f32_32x32x16_bf16 v[8:23], v[40:43], v[44:47], v[8:23]
  ds_read_b64_tr_b16 v[40:41], v117 offset:40960
  ds_read_b64_tr_b16 v[42:43], v117 offset:41472
  ds_read_b128 v[44:47], v118 offset:21120
  s_waitcnt lgkmcnt(12)
  v_mfma_f32_32x32x16_bf16 v[8:23], v[48:51], v[52:55], v[8:23]
  ds_read_b64_tr_b16 v[48:49], v117 offset:43008
  ds_read_b64_tr_b16 v[50:51], v117 offset:43520
  ds_read_b128 v[52:55], v118 offset:22176
  s_waitcnt lgkmcnt(12)
  v_mfma_f32_32x32x16_bf16 v[8:23], v[56:59], v[60:63], v[8:23]
  ds_read_b64_tr_b16 v[56:57], v117 offset:45056
  ds_read_b64_tr_b16 v[58:59], v117 offset:45568
  ds_read_b128 v[60:63], v118 offset:23232
  s_waitcnt lgkmcnt(12)
  v_mfma_f32_32x32x16_bf16 v[8:23], v[64:67], v[68:71], v[8:23]
  ds_read_b64_tr_b16 v[64:65], v117 offset:47104
  ds_read_b64_tr_b16 v[66:67], v117 offset:47616
  ds_read_b128 v[68:71], v118 offset:24288
  s_waitcnt lgkmcnt(12)
  v_mfma_f32_32x32x16_bf16 v[8:23], v[72:75], v[76:79], v[8:23]
  ds_read_b64_tr_b16 v[72:73], v117 offset:49152
  ds_read_b64_tr_b16 v[74:75], v117 offset:49664
  ds_read_b128 v[76:79], v118 offset:25344
  s_waitcnt lgkmcnt(12)
  v_mfma_f32_32x32x16_bf16 v[8:23], v[40:43], v[44:47], v[8:23]
  ds_read_b64_tr_b16 v[40:41], v117 offset:51200
  ds_read_b64_tr_b16 v[42:43], v117 offset:51712
  ds_read_b128 v[44:47], v118 offset:26400
  s_waitcnt lgkmcnt(12)
  v_mfma_f32_32x32x16_bf16 v[8:23], v[48:51], v[52:55], v[8:23]
  ds_read_b64_tr_b16 v[48:49], v117 offset:53248
  ds_read_b64_tr_b16 v[50:51], v117 offset:53760
  ds_read_b128 v[52:55], v118 offset:27456
  s_waitcnt lgkmcnt(12)
  v_mfma_f32_32x32x16_bf16 v[8:23], v[56:59], v[60:63], v[8:23]
  ds_read_b64_tr_b16 v[56:57], v117 offset:55296
  ds_read_b64_tr_b16 v[58:59], v117 offset:55808
  ds_read_b128 v[60:63], v118 offset:28512
  s_waitcnt lgkmcnt(12)
  v_mfma_f32_32x32x16_bf16 v[8:23], v[64:67], v[68:71], v[8:23]
  s_waitcnt lgkmcnt(9)
  v_mfma_f32_32x32x16_bf16 v[8:23], v[72:75], v[76:79], v[8:23]
  s_waitcnt lgkmcnt(6)
  v_mfma_f32_32x32x16_bf16 v[8:23], v[40:43], v[44:47], v[8:23]
  s_waitcnt lgkmcnt(3)
  v_mfma_f32_32x32x16_bf16 v[8:23], v[48:51], v[52:55], v[8:23]
  s_waitcnt lgkmcnt(0)
  v_mfma_f32_32x32x16_bf16 v[8:23], v[56:59], v[60:63], v[8:23]
  s_nop 11
  v_cvt_pk_bf16_f32 v40, v8, v9
  v_cvt_pk_bf16_f32 v41, v10, v11
  v_cvt_pk_bf16_f32 v42, v12, v13
  v_cvt_pk_bf16_f32 v43, v14, v15
  v_cvt_pk_bf16_f32 v44, v16, v17
  v_cvt_pk_bf16_f32 v45, v18, v19
  v_cvt_pk_bf16_f32 v46, v20, v21
  v_cvt_pk_bf16_f32 v47, v22, v23
  ds_write_b128 v119, v[40:43]
  ds_write_b128 v119, v[44:47] offset:1024
  s_cmp_eq_u32 s50, 0
  s_cbranch_scc1 L_pkq_fdone
  s_mov_b32 s36, 0x05040100
  s_mov_b32 s37, 0x07060302
  s_waitcnt vmcnt(0)
  s_cmp_gt_u32 s50, 2
  s_cbranch_scc1 L_pkq_fdone
  s_cmp_eq_u32 s50, 2
  s_cbranch_scc1 L_pkq_f2
  v_perm_b32 v240, v222, v220, s36
  v_perm_b32 v241, v226, v224, s36
  v_perm_b32 v242, v230, v228, s36
  v_perm_b32 v243, v234, v232, s36
  v_perm_b32 v244, v222, v220, s37
  v_perm_b32 v245, v226, v224, s37
  v_perm_b32 v246, v230, v228, s37
  v_perm_b32 v247, v234, v232, s37
  v_perm_b32 v248, v223, v221, s36
  v_perm_b32 v249, v227, v225, s36
  v_perm_b32 v250, v231, v229, s36
  v_perm_b32 v251, v235, v233, s36
  v_perm_b32 v252, v223, v221, s37
  v_perm_b32 v253, v227, v225, s37
  v_perm_b32 v254, v231, v229, s37
  v_perm_b32 v255, v235, v233, s37
  s_branch L_pkq_fdone
L_pkq_f2:
  v_perm_b32 v240, v221, v220, s36
  v_perm_b32 v241, v223, v222, s36
  v_perm_b32 v242, v225, v224, s36
  v_perm_b32 v243, v227, v226, s36
  v_perm_b32 v244, v221, v220, s37
  v_perm_b32 v245, v223, v222, s37
  v_perm_b32 v246, v225, v224, s37
  v_perm_b32 v247, v227, v226, s37
  v_perm_b32 v248, v229, v228, s36
  v_perm_b32 v249, v231, v230, s36
  v_perm_b32 v250, v233, v232, s36
  v_perm_b32 v251, v235, v234, s36
  v_perm_b32 v252, v229, v228, s37
  v_perm_b32 v253, v231, v230, s37
  v_perm_b32 v254, v233, v232, s37
  v_perm_b32 v255, v235, v234, s37
L_pkq_fdone:
  s_branch L_pk_s1done
L_pk_k:
  s_waitcnt vmcnt(1)
  s_mov_b32 s34, 0x3f803f80
  v_dot2_f32_bf16 v96, v8, s34, 0
  v_dot2_f32_bf16 v98, v8, v8, 0
  v_dot2_f32_bf16 v97, v9, s34, 0
  v_dot2_f32_bf16 v99, v9, v9, 0
  v_dot2_f32_bf16 v96, v10, s34, v96
  v_dot2_f32_bf16 v98, v10, v10, v98
  v_dot2_f32_bf16 v97, v11, s34, v97
  v_dot2_f32_bf16 v99, v11, v11, v99
  v_dot2_f32_bf16 v96, v12, s34, v96
  v_dot2_f32_bf16 v98, v12, v12, v98
  v_dot2_f32_bf16 v97, v13, s34, v97
  v_dot2_f32_bf16 v99, v13, v13, v99
  v_dot2_f32_bf16 v96, v14, s34, v96
  v_dot2_f32_bf16 v98, v14, v14, v98
  v_dot2_f32_bf16 v97, v15, s34, v97
  v_dot2_f32_bf16 v99, v15, v15, v99
  v_dot2_f32_bf16 v96, v16, s34, v96
  v_dot2_f32_bf16 v98, v16, v16, v98
  v_dot2_f32_bf16 v97, v17, s34, v97
  v_dot2_f32_bf16 v99, v17, v17, v99
  v_dot2_f32_bf16 v96, v18, s34, v96
  v_dot2_f32_bf16 v98, v18, v18, v98
  v_dot2_f32_bf16 v97, v19, s34, v97
  v_dot2_f32_bf16 v99, v19, v19, v99
  v_dot2_f32_bf16 v96, v20, s34, v96
  v_dot2_f32_bf16 v98, v20, v20, v98
  v_dot2_f32_bf16 v97, v21, s34, v97
  v_dot2_f32_bf16 v99, v21, v21, v99
  v_dot2_f32_bf16 v96, v22, s34, v96
  v_dot2_f32_bf16 v98, v22, v22, v98
  v_dot2_f32_bf16 v97, v23, s34, v97
  v_dot2_f32_bf16 v99, v23, v23, v99
  v_dot2_f32_bf16 v96, v24, s34, v96
  v_dot2_f32_bf16 v98, v24, v24, v98
  v_dot2_f32_bf16 v97, v25, s34, v97
  v_dot2_f32_bf16 v99, v25, v25, v99
  v_dot2_f32_bf16 v96, v26, s34, v96
  v_dot2_f32_bf16 v98, v26, v26, v98
  v_dot2_f32_bf16 v97, v27, s34, v97
  v_dot2_f32_bf16 v99, v27, v27, v99
  v_dot2_f32_bf16 v96, v28, s34, v96
  v_dot2_f32_bf16 v98, v28, v28, v98
  v_dot2_f32_bf16 v97, v29, s34, v97
  v_dot2_f32_bf16 v99, v29, v29, v99
  v_dot2_f32_bf16 v96, v30, s34, v96
  v_dot2_f32_bf16 v98, v30, v30, v98
  v_dot2_f32_bf16 v97, v31, s34, v97
  v_dot2_f32_bf16 v99, v31, v31, v99
  v_dot2_f32_bf16 v96, v32, s34, v96
  v_dot2_f32_bf16 v98, v32, v32, v98
  v_dot2_f32_bf16 v97, v33, s34, v97
  v_dot2_f32_bf16 v99, v33, v33, v99
  v_dot2_f32_bf16 v96, v34, s34, v96
  v_dot2_f32_bf16 v98, v34, v34, v98
  v_dot2_f32_bf16 v97, v35, s34, v97
  v_dot2_f32_bf16 v99, v35, v35, v99
  s_nop 2
  v_add_f32 v96, v96, v97
  v_add_f32 v98, v98, v99
  s_nop 0
  v_add_f32_dpp v96, v96, v96 quad_perm:[1,0,3,2] row_mask:0xf bank_mask:0xf
  v_add_f32_dpp v98, v98, v98 quad_perm:[1,0,3,2] row_mask:0xf bank_mask:0xf
  s_nop 0
  v_add_f32_dpp v96, v96, v96 quad_perm:[2,3,0,1] row_mask:0xf bank_mask:0xf
  v_add_f32_dpp v98, v98, v98 quad_perm:[2,3,0,1] row_mask:0xf bank_mask:0xf
  s_nop 0
  v_add_f32_dpp v96, v96, v96 row_half_mirror row_mask:0xf bank_mask:0xf
  v_add_f32_dpp v98, v98, v98 row_half_mirror row_mask:0xf bank_mask:0xf
  v_mul_f32 v96, 0xbb124925, v96
  v_mul_f32 v98, 0x3b124925, v98
  v_fma_f32 v98, -v96, v96, v98
  v_max_f32 v98, 0, v98
  v_add_f32 v98, 0x3727c5ac, v98
  v_rsq_f32 v100, v98
  v_lshlrev_b32 v64, 16, v8
  v_and_b32 v65, 0xffff0000, v8
  v_mul_f32 v100, 0x3f05abd1, v100
  v_lshlrev_b32 v66, 16, v9
  v_and_b32 v67, 0xffff0000, v9
  v_mul_f32 v102, v96, v100
  v_pk_fma_f32 v[64:65], v[64:65], v[100:101], v[102:103] op_sel_hi:[1,0,0]
  v_lshlrev_b32 v68, 16, v10
  v_and_b32 v69, 0xffff0000, v10
  v_cvt_pk_bf16_f32 v8, v64, v65
  v_pk_fma_f32 v[66:67], v[66:67], v[100:101], v[102:103] op_sel_hi:[1,0,0]
  v_lshlrev_b32 v70, 16, v11
  v_and_b32 v71, 0xffff0000, v11
  v_cvt_pk_bf16_f32 v9, v66, v67
  v_pk_fma_f32 v[68:69], v[68:69], v[100:101], v[102:103] op_sel_hi:[1,0,0]
  v_lshlrev_b32 v64, 16, v12
  v_and_b32 v65, 0xffff0000, v12
  v_cvt_pk_bf16_f32 v10, v68, v69
  v_pk_fma_f32 v[70:71], v[70:71], v[100:101], v[102:103] op_sel_hi:[1,0,0]
  v_lshlrev_b32 v66, 16, v13
  v_and_b32 v67, 0xffff0000, v13
  v_cvt_pk_bf16_f32 v11, v70, v71
  v_pk_fma_f32 v[64:65], v[64:65], v[100:101], v[102:103] op_sel_hi:[1,0,0]
  v_lshlrev_b32 v68, 16, v14
  v_and_b32 v69, 0xffff0000, v14
  v_cvt_pk_bf16_f32 v12, v64, v65
  v_pk_fma_f32 v[66:67], v[66:67], v[100:101], v[102:103] op_sel_hi:[1,0,0]
  v_lshlrev_b32 v70, 16, v15
  v_and_b32 v71, 0xffff0000, v15
  v_cvt_pk_bf16_f32 v13, v66, v67
  v_pk_fma_f32 v[68:69], v[68:69], v[100:101], v[102:103] op_sel_hi:[1,0,0]
  v_lshlrev_b32 v64, 16, v16
  v_and_b32 v65, 0xffff0000, v16
  v_cvt_pk_bf16_f32 v14, v68, v69
  v_pk_fma_f32 v[70:71], v[70:71], v[100:101], v[102:103] op_sel_hi:[1,0,0]
  v_lshlrev_b32 v66, 16, v17
  v_and_b32 v67, 0xffff0000, v17
  v_cvt_pk_bf16_f32 v15, v70, v71
  v_pk_fma_f32 v[64:65], v[64:65], v[100:101], v[102:103] op_sel_hi:[1,0,0]
  v_lshlrev_b32 v68, 16, v18
  v_and_b32 v69, 0xffff0000, v18
  v_cvt_pk_bf16_f32 v16, v64, v65
  v_pk_fma_f32 v[66:67], v[66:67], v[100:101], v[102:103] op_sel_hi:[1,0,0]
  v_lshlrev_b32 v70, 16, v19
  v_and_b32 v71, 0xffff0000, v19
  v_cvt_pk_bf16_f32 v17, v66, v67
  v_pk_fma_f32 v[68:69], v[68:69], v[100:101], v[102:103] op_sel_hi:[1,0,0]
  v_lshlrev_b32 v64, 16, v20
  v_and_b32 v65, 0xffff0000, v20
  v_cvt_pk_bf16_f32 v18, v68, v69
  v_pk_fma_f32 v[70:71], v[70:71], v[100:101], v[102:103] op_sel_hi:[1,0,0]
  v_lshlrev_b32 v66, 16, v21
  v_and_b32 v67, 0xffff0000, v21
  v_cvt_pk_bf16_f32 v19, v70, v71
  v_pk_fma_f32 v[64:65], v[64:65], v[100:101], v[102:103] op_sel_hi:[1,0,0]
  v_lshlrev_b32 v68, 16, v22
  v_and_b32 v69, 0xffff0000, v22
  v_cvt_pk_bf16_f32 v20, v64, v65
  v_pk_fma_f32 v[66:67], v[66:67], v[100:101], v[102:103] op_sel_hi:[1,0,0]
  v_lshlrev_b32 v70, 16, v23
  v_and_b32 v71, 0xffff0000, v23
  v_cvt_pk_bf16_f32 v21, v66, v67
  v_pk_fma_f32 v[68:69], v[68:69], v[100:101], v[102:103] op_sel_hi:[1,0,0]
  v_lshlrev_b32 v64, 16, v24
  v_and_b32 v65, 0xffff0000, v24
  v_cvt_pk_bf16_f32 v22, v68, v69
  v_pk_fma_f32 v[70:71], v[70:71], v[100:101], v[102:103] op_sel_hi:[1,0,0]
  v_lshlrev_b32 v66, 16, v25
  v_and_b32 v67, 0xffff0000, v25
  v_cvt_pk_bf16_f32 v23, v70, v71
  v_pk_fma_f32 v[64:65], v[64:65], v[100:101], v[102:103] op_sel_hi:[1,0,0]
  v_lshlrev_b32 v68, 16, v26
  v_and_b32 v69, 0xffff0000, v26
  v_cvt_pk_bf16_f32 v24, v64, v65
  v_pk_fma_f32 v[66:67], v[66:67], v[100:101], v[102:103] op_sel_hi:[1,0,0]
  v_lshlrev_b32 v70, 16, v27
  v_and_b32 v71, 0xffff0000, v27
  v_cvt_pk_bf16_f32 v25, v66, v67
  v_pk_fma_f32 v[68:69], v[68:69], v[100:101], v[102:103] op_sel_hi:[1,0,0]
  v_lshlrev_b32 v64, 16, v28
  v_and_b32 v65, 0xffff0000, v28
  v_cvt_pk_bf16_f32 v26, v68, v69
  v_pk_fma_f32 v[70:71], v[70:71], v[100:101], v[102:103] op_sel_hi:[1,0,0]
  v_lshlrev_b32 v66, 16, v29
  v_and_b32 v67, 0xffff0000, v29
  v_cvt_pk_bf16_f32 v27, v70, v71
  v_pk_fma_f32 v[64:65], v[64:65], v[100:101], v[102:103] op_sel_hi:[1,0,0]
  v_lshlrev_b32 v68, 16, v30
  v_and_b32 v69, 0xffff0000, v30
  v_cvt_pk_bf16_f32 v28, v64, v65
  v_pk_fma_f32 v[66:67], v[66:67], v[100:101], v[102:103] op_sel_hi:[1,0,0]
  v_lshlrev_b32 v70, 16, v31
  v_and_b32 v71, 0xffff0000, v31
  v_cvt_pk_bf16_f32 v29, v66, v67
  v_pk_fma_f32 v[68:69], v[68:69], v[100:101], v[102:103] op_sel_hi:[1,0,0]
  v_lshlrev_b32 v64, 16, v32
  v_and_b32 v65, 0xffff0000, v32
  v_cvt_pk_bf16_f32 v30, v68, v69
  v_pk_fma_f32 v[70:71], v[70:71], v[100:101], v[102:103] op_sel_hi:[1,0,0]
  v_lshlrev_b32 v66, 16, v33
  v_and_b32 v67, 0xffff0000, v33
  v_cvt_pk_bf16_f32 v31, v70, v71
  v_pk_fma_f32 v[64:65], v[64:65], v[100:101], v[102:103] op_sel_hi:[1,0,0]
  v_lshlrev_b32 v68, 16, v34
  v_and_b32 v69, 0xffff0000, v34
  v_cvt_pk_bf16_f32 v32, v64, v65
  v_pk_fma_f32 v[66:67], v[66:67], v[100:101], v[102:103] op_sel_hi:[1,0,0]
  v_lshlrev_b32 v70, 16, v35
  v_and_b32 v71, 0xffff0000, v35
  v_cvt_pk_bf16_f32 v33, v66, v67
  v_pk_fma_f32 v[68:69], v[68:69], v[100:101], v[102:103] op_sel_hi:[1,0,0]
  v_cvt_pk_bf16_f32 v34, v68, v69
  v_pk_fma_f32 v[70:71], v[70:71], v[100:101], v[102:103] op_sel_hi:[1,0,0]
  v_cvt_pk_bf16_f32 v35, v70, v71
  ds_write_b128 v116, v[8:11] offset:0
  ds_write_b128 v116, v[12:15] offset:4224
  ds_write_b128 v116, v[16:19] offset:8448
  ds_write_b128 v116, v[20:23] offset:12672
  ds_write_b128 v116, v[24:27] offset:16896
  ds_write_b128 v116, v[28:31] offset:21120
  ds_write_b128 v116, v[32:35] offset:25344
  s_lshr_b32 s51, s33, 1
  s_lshl_b32 s51, s51, 5
  s_add_u32 s51, s51, s32
  s_lshl_b32 s51, s51, 1
  s_and_b32 s35, s33, 1
  s_add_u32 s51, s51, s35
  s_lshl_b32 s51, s51, 3
  s_add_u32 s51, s51, 1867776
  s_waitcnt lgkmcnt(0)
  s_mul_i32 s48, s48, 0x9E3779B1
  s_add_u32 s48, s48, 0x7F4A7C15
  s_getreg_b32 s49, hwreg(HW_REG_XCC_ID, 0, 4)
  s_setprio 3
  s_barrier
  ds_read_b64_tr_b16 v[40:41], v117 offset:0
  ds_read_b64_tr_b16 v[42:43], v117 offset:224
  ds_read_b128 v[44:47], v118 offset:0
  ds_read_b64_tr_b16 v[48:49], v117 offset:896
  ds_read_b64_tr_b16 v[50:51], v117 offset:1120
  ds_read_b128 v[52:55], v118 offset:1056
  ds_read_b64_tr_b16 v[56:57], v117 offset:1792
  ds_read_b64_tr_b16 v[58:59], v117 offset:2016
  ds_read_b128 v[60:63], v118 offset:2112
  ds_read_b64_tr_b16 v[64:65], v117 offset:2688
  ds_read_b64_tr_b16 v[66:67], v117 offset:2912
  ds_read_b128 v[68:71], v118 offset:3168
  ds_read_b64_tr_b16 v[72:73], v117 offset:3584
  ds_read_b64_tr_b16 v[74:75], v117 offset:3808
  ds_read_b128 v[76:79], v118 offset:4224
  s_waitcnt lgkmcnt(12)
  v_mfma_f32_32x32x16_bf16 v[8:23], v[40:43], v[44:47], 0
  ds_read_b64_tr_b16 v[40:41], v117 offset:4480
  ds_read_b64_tr_b16 v[42:43], v117 offset:4704
  ds_read_b128 v[44:47], v118 offset:5280
  s_waitcnt lgkmcnt(12)
  v_mfma_f32_32x32x16_bf16 v[8:23], v[48:51], v[52:55], v[8:23]
  ds_read_b64_tr_b16 v[48:49], v117 offset:5376
  ds_read_b64_tr_b16 v[50:51], v117 offset:5600
  ds_read_b128 v[52:55], v118 offset:6336
  s_waitcnt lgkmcnt(12)
  v_mfma_f32_32x32x16_bf16 v[8:23], v[56:59], v[60:63], v[8:23]
  ds_read_b64_tr_b16 v[56:57], v117 offset:6272
  ds_read_b64_tr_b16 v[58:59], v117 offset:6496
  ds_read_b128 v[60:63], v118 offset:7392
  s_waitcnt lgkmcnt(12)
  v_mfma_f32_32x32x16_bf16 v[8:23], v[64:67], v[68:71], v[8:23]
  ds_read_b64_tr_b16 v[64:65], v117 offset:7168
  ds_read_b64_tr_b16 v[66:67], v117 offset:7392
  ds_read_b128 v[68:71], v118 offset:8448
  s_waitcnt lgkmcnt(12)
  v_mfma_f32_32x32x16_bf16 v[8:23], v[72:75], v[76:79], v[8:23]
  ds_read_b64_tr_b16 v[72:73], v117 offset:8064
  ds_read_b64_tr_b16 v[74:75], v117 offset:8288
  ds_read_b128 v[76:79], v118 offset:9504
  s_waitcnt lgkmcnt(12)
  v_mfma_f32_32x32x16_bf16 v[8:23], v[40:43], v[44:47], v[8:23]
  ds_read_b64_tr_b16 v[40:41], v117 offset:8960
  ds_read_b64_tr_b16 v[42:43], v117 offset:9184
  ds_read_b128 v[44:47], v118 offset:10560
  s_waitcnt lgkmcnt(12)
  v_mfma_f32_32x32x16_bf16 v[8:23], v[48:51], v[52:55], v[8:23]
  ds_read_b64_tr_b16 v[48:49], v117 offset:9856
  ds_read_b64_tr_b16 v[50:51], v117 offset:10080
  ds_read_b128 v[52:55], v118 offset:11616
  s_waitcnt lgkmcnt(12)
  v_mfma_f32_32x32x16_bf16 v[8:23], v[56:59], v[60:63], v[8:23]
  ds_read_b64_tr_b16 v[56:57], v117 offset:10752
  ds_read_b64_tr_b16 v[58:59], v117 offset:10976
  ds_read_b128 v[60:63], v118 offset:12672
  s_waitcnt lgkmcnt(12)
  v_mfma_f32_32x32x16_bf16 v[8:23], v[64:67], v[68:71], v[8:23]
  ds_read_b64_tr_b16 v[64:65], v117 offset:11648
  ds_read_b64_tr_b16 v[66:67], v117 offset:11872
  ds_read_b128 v[68:71], v118 offset:13728
  s_waitcnt lgkmcnt(12)
  v_mfma_f32_32x32x16_bf16 v[8:23], v[72:75], v[76:79], v[8:23]
  ds_read_b64_tr_b16 v[72:73], v117 offset:12544
  ds_read_b64_tr_b16 v[74:75], v117 offset:12768
  ds_read_b128 v[76:79], v118 offset:14784
  s_waitcnt lgkmcnt(12)
  v_mfma_f32_32x32x16_bf16 v[8:23], v[40:43], v[44:47], v[8:23]
  ds_read_b64_tr_b16 v[40:41], v117 offset:13440
  ds_read_b64_tr_b16 v[42:43], v117 offset:13664
  ds_read_b128 v[44:47], v118 offset:15840
  s_waitcnt lgkmcnt(12)
  v_mfma_f32_32x32x16_bf16 v[8:23], v[48:51], v[52:55], v[8:23]
  ds_read_b64_tr_b16 v[48:49], v117 offset:14336
  ds_read_b64_tr_b16 v[50:51], v117 offset:14560
  ds_read_b128 v[52:55], v118 offset:16896
  s_waitcnt lgkmcnt(12)
  v_mfma_f32_32x32x16_bf16 v[8:23], v[56:59], v[60:63], v[8:23]
  ds_read_b64_tr_b16 v[56:57], v117 offset:15232
  ds_read_b64_tr_b16 v[58:59], v117 offset:15456
  ds_read_b128 v[60:63], v118 offset:17952
  s_waitcnt lgkmcnt(12)
  v_mfma_f32_32x32x16_bf16 v[8:23], v[64:67], v[68:71], v[8:23]
  ds_read_b64_tr_b16 v[64:65], v117 offset:16128
  ds_read_b64_tr_b16 v[66:67], v117 offset:16352
  ds_read_b128 v[68:71], v118 offset:19008
  s_waitcnt lgkmcnt(12)
  v_mfma_f32_32x32x16_bf16 v[8:23], v[72:75], v[76:79], v[8:23]
  ds_read_b64_tr_b16 v[72:73], v117 offset:17024
  ds_read_b64_tr_b16 v[74:75], v117 offset:17248
  ds_read_b128 v[76:79], v118 offset:20064
  s_waitcnt lgkmcnt(12)
  v_mfma_f32_32x32x16_bf16 v[8:23], v[40:43], v[44:47], v[8:23]
  ds_read_b64_tr_b16 v[40:41], v117 offset:17920
  ds_read_b64_tr_b16 v[42:43], v117 offset:18144
  ds_read_b128 v[44:47], v118 offset:21120
  s_waitcnt lgkmcnt(12)
  v_mfma_f32_32x32x16_bf16 v[8:23], v[48:51], v[52:55], v[8:23]
  ds_read_b64_tr_b16 v[48:49], v117 offset:18816
  ds_read_b64_tr_b16 v[50:51], v117 offset:19040
  ds_read_b128 v[52:55], v118 offset:22176
  s_waitcnt lgkmcnt(12)
  v_mfma_f32_32x32x16_bf16 v[8:23], v[56:59], v[60:63], v[8:23]
  ds_read_b64_tr_b16 v[56:57], v117 offset:19712
  ds_read_b64_tr_b16 v[58:59], v117 offset:19936
  ds_read_b128 v[60:63], v118 offset:23232
  s_waitcnt lgkmcnt(12)
  v_mfma_f32_32x32x16_bf16 v[8:23], v[64:67], v[68:71], v[8:23]
  ds_read_b64_tr_b16 v[64:65], v117 offset:20608
  ds_read_b64_tr_b16 v[66:67], v117 offset:20832
  ds_read_b128 v[68:71], v118 offset:24288
  s_waitcnt lgkmcnt(12)
  v_mfma_f32_32x32x16_bf16 v[8:23], v[72:75], v[76:79], v[8:23]
  ds_read_b64_tr_b16 v[72:73], v117 offset:21504
  ds_read_b64_tr_b16 v[74:75], v117 offset:21728
  ds_read_b128 v[76:79], v118 offset:25344
  s_waitcnt lgkmcnt(12)
  v_mfma_f32_32x32x16_bf16 v[8:23], v[40:43], v[44:47], v[8:23]
  ds_read_b64_tr_b16 v[40:41], v117 offset:22400
  ds_read_b64_tr_b16 v[42:43], v117 offset:22624
  ds_read_b128 v[44:47], v118 offset:26400
  s_waitcnt lgkmcnt(12)
  v_mfma_f32_32x32x16_bf16 v[8:23], v[48:51], v[52:55], v[8:23]
  ds_read_b64_tr_b16 v[48:49], v117 offset:23296
  ds_read_b64_tr_b16 v[50:51], v117 offset:23520
  ds_read_b128 v[52:55], v118 offset:27456
  s_waitcnt lgkmcnt(12)
  v_mfma_f32_32x32x16_bf16 v[8:23], v[56:59], v[60:63], v[8:23]
  ds_read_b64_tr_b16 v[56:57], v117 offset:24192
  ds_read_b64_tr_b16 v[58:59], v117 offset:24416
  ds_read_b128 v[60:63], v118 offset:28512
  s_waitcnt lgkmcnt(12)
  v_mfma_f32_32x32x16_bf16 v[8:23], v[64:67], v[68:71], v[8:23]
  s_waitcnt lgkmcnt(9)
  v_mfma_f32_32x32x16_bf16 v[8:23], v[72:75], v[76:79], v[8:23]
  s_waitcnt lgkmcnt(6)
  v_mfma_f32_32x32x16_bf16 v[8:23], v[40:43], v[44:47], v[8:23]
  s_waitcnt lgkmcnt(3)
  v_mfma_f32_32x32x16_bf16 v[8:23], v[48:51], v[52:55], v[8:23]
  s_waitcnt lgkmcnt(0)
  v_mfma_f32_32x32x16_bf16 v[8:23], v[56:59], v[60:63], v[8:23]
  s_nop 11
  v_cndmask_b32 v21, v21, 0, vcc
  v_cndmask_b32 v22, v22, 0, vcc
  v_cndmask_b32 v23, v23, 0, vcc
  v_cndmask_b32 v48, v20, 1.0, vcc
  v_cndmask_b32 v20, v20, 0, vcc
  v_cvt_pk_bf16_f32 v40, v8, v9
  v_cvt_pk_bf16_f32 v41, v10, v11
  v_cvt_pk_bf16_f32 v42, v12, v13
  v_cvt_pk_bf16_f32 v43, v14, v15
  buffer_store_dwordx4 v[40:43], v119, s[28:31], s39 offen offset:0 sc1
  v_cvt_pk_bf16_f32 v44, v16, v17
  v_cvt_pk_bf16_f32 v45, v18, v19
  v_cvt_pk_bf16_f32 v46, v48, v21
  v_cvt_pk_bf16_f32 v47, v22, v23
  buffer_store_dwordx4 v[44:47], v119, s[28:31], s39 offen offset:1024 sc1
  v_pk_mul_f32 v[96:97], v[8:9], v[8:9]
  v_pk_fma_f32 v[96:97], v[10:11], v[10:11], v[96:97]
  v_pk_fma_f32 v[96:97], v[12:13], v[12:13], v[96:97]
  v_pk_fma_f32 v[96:97], v[14:15], v[14:15], v[96:97]
  v_pk_fma_f32 v[96:97], v[16:17], v[16:17], v[96:97]
  v_pk_fma_f32 v[96:97], v[18:19], v[18:19], v[96:97]
  v_pk_fma_f32 v[96:97], v[20:21], v[20:21], v[96:97]
  v_pk_fma_f32 v[96:97], v[22:23], v[22:23], v[96:97]
  v_add_f32 v96, v96, v97
  v_mov_b32 v97, v96
  s_nop 1
L_wm_P3:
  s_cbranch_execz L_wm_P4
  v_permlane32_swap_b32 v96, v97
  s_nop 1
  v_add_f32 v96, v96, v97
  s_nop 1
  v_max_f32_dpp v96, v96, v96 quad_perm:[1,0,3,2] row_mask:0xf bank_mask:0xf
  s_nop 1
  v_max_f32_dpp v96, v96, v96 quad_perm:[2,3,0,1] row_mask:0xf bank_mask:0xf
  s_nop 1
  v_max_f32_dpp v96, v96, v96 row_half_mirror row_mask:0xf bank_mask:0xf
  s_nop 1
  v_max_f32_dpp v96, v96, v96 row_mirror row_mask:0xf bank_mask:0xf
  s_nop 1
  v_readlane_b32 s36, v96, 0
  v_readlane_b32 s38, v96, 16
  s_max_u32 s49, s36, s38
  s_branch L_pk_kvflag
L_pk_v:
  v_cmp_eq_u32 vcc, 28, v120
  v_mov_b32 v112, 0x3f803f80
  s_nop 0
  v_cndmask_b32 v112, 0, v112, vcc
  v_cmp_gt_u32 vcc, 28, v120
  s_waitcnt vmcnt(1)
  s_mov_b32 s34, 0x3f803f80
  v_dot2_f32_bf16 v96, v8, s34, 0
  v_dot2_f32_bf16 v98, v8, v8, 0
  v_dot2_f32_bf16 v97, v9, s34, 0
  v_dot2_f32_bf16 v99, v9, v9, 0
  v_dot2_f32_bf16 v96, v10, s34, v96
  v_dot2_f32_bf16 v98, v10, v10, v98
  v_dot2_f32_bf16 v97, v11, s34, v97
  v_dot2_f32_bf16 v99, v11, v11, v99
  v_dot2_f32_bf16 v96, v12, s34, v96
  v_dot2_f32_bf16 v98, v12, v12, v98
  v_dot2_f32_bf16 v97, v13, s34, v97
  v_dot2_f32_bf16 v99, v13, v13, v99
  v_dot2_f32_bf16 v96, v14, s34, v96
  v_dot2_f32_bf16 v98, v14, v14, v98
  v_dot2_f32_bf16 v97, v15, s34, v97
  v_dot2_f32_bf16 v99, v15, v15, v99
  v_dot2_f32_bf16 v96, v16, s34, v96
  v_dot2_f32_bf16 v98, v16, v16, v98
  v_dot2_f32_bf16 v97, v17, s34, v97
  v_dot2_f32_bf16 v99, v17, v17, v99
  v_dot2_f32_bf16 v96, v18, s34, v96
  v_dot2_f32_bf16 v98, v18, v18, v98
  v_dot2_f32_bf16 v97, v19, s34, v97
  v_dot2_f32_bf16 v99, v19, v19, v99
  v_dot2_f32_bf16 v96, v20, s34, v96
  v_dot2_f32_bf16 v98, v20, v20, v98
  v_dot2_f32_bf16 v97, v21, s34, v97
  v_dot2_f32_bf16 v99, v21, v21, v99
  v_dot2_f32_bf16 v96, v22, s34, v96
  v_dot2_f32_bf16 v98, v22, v22, v98
  v_dot2_f32_bf16 v97, v23, s34, v97
  v_dot2_f32_bf16 v99, v23, v23, v99
  v_dot2_f32_bf16 v96, v24, s34, v96
  v_dot2_f32_bf16 v98, v24, v24, v98
  v_dot2_f32_bf16 v97, v25, s34, v97
  v_dot2_f32_bf16 v99, v25, v25, v99
  v_dot2_f32_bf16 v96, v26, s34, v96
  v_dot2_f32_bf16 v98, v26, v26, v98
  v_dot2_f32_bf16 v97, v27, s34, v97
  v_dot2_f32_bf16 v99, v27, v27, v99
  v_dot2_f32_bf16 v96, v28, s34, v96
  v_dot2_f32_bf16 v98, v28, v28, v98
  v_dot2_f32_bf16 v97, v29, s34, v97
  v_dot2_f32_bf16 v99, v29, v29, v99
  v_dot2_f32_bf16 v96, v30, s34, v96
  v_dot2_f32_bf16 v98, v30, v30, v98
  v_dot2_f32_bf16 v97, v31, s34, v97
  v_dot2_f32_bf16 v99, v31, v31, v99
  v_dot2_f32_bf16 v96, v32, s34, v96
  v_dot2_f32_bf16 v98, v32, v32, v98
  v_dot2_f32_bf16 v97, v33, s34, v97
  v_dot2_f32_bf16 v99, v33, v33, v99
  v_dot2_f32_bf16 v96, v34, s34, v96
  v_dot2_f32_bf16 v98, v34, v34, v98
  v_dot2_f32_bf16 v97, v35, s34, v97
  v_dot2_f32_bf16 v99, v35, v35, v99
  s_nop 2
  v_add_f32 v96, v96, v97
  v_add_f32 v98, v98, v99
  s_nop 0
  v_add_f32_dpp v96, v96, v96 quad_perm:[1,0,3,2] row_mask:0xf bank_mask:0xf
  v_add_f32_dpp v98, v98, v98 quad_perm:[1,0,3,2] row_mask:0xf bank_mask:0xf
  s_nop 0
  v_add_f32_dpp v96, v96, v96 quad_perm:[2,3,0,1] row_mask:0xf bank_mask:0xf
  v_add_f32_dpp v98, v98, v98 quad_perm:[2,3,0,1] row_mask:0xf bank_mask:0xf
  s_nop 0
  v_add_f32_dpp v96, v96, v96 row_half_mirror row_mask:0xf bank_mask:0xf
  v_add_f32_dpp v98, v98, v98 row_half_mirror row_mask:0xf bank_mask:0xf
  v_mul_f32 v96, 0xbb124925, v96
  v_mul_f32 v98, 0x3b124925, v98
  v_fma_f32 v98, -v96, v96, v98
  v_max_f32 v98, 0, v98
  v_add_f32 v98, 0x3727c5ac, v98
  v_rsq_f32 v100, v98
  v_lshlrev_b32 v64, 16, v8
  v_and_b32 v65, 0xffff0000, v8
  v_mul_f32 v100, 0x3f05abd1, v100
  v_lshlrev_b32 v66, 16, v9
  v_and_b32 v67, 0xffff0000, v9
  v_mul_f32 v102, v96, v100
  v_pk_fma_f32 v[64:65], v[64:65], v[100:101], v[102:103] op_sel_hi:[1,0,0]
  v_lshlrev_b32 v68, 16, v10
  v_and_b32 v69, 0xffff0000, v10
  v_cvt_pk_bf16_f32 v8, v64, v65
  v_pk_fma_f32 v[66:67], v[66:67], v[100:101], v[102:103] op_sel_hi:[1,0,0]
  v_lshlrev_b32 v70, 16, v11
  v_and_b32 v71, 0xffff0000, v11
  v_cvt_pk_bf16_f32 v9, v66, v67
  v_pk_fma_f32 v[68:69], v[68:69], v[100:101], v[102:103] op_sel_hi:[1,0,0]
  v_lshlrev_b32 v64, 16, v12
  v_and_b32 v65, 0xffff0000, v12
  v_cvt_pk_bf16_f32 v10, v68, v69
  v_pk_fma_f32 v[70:71], v[70:71], v[100:101], v[102:103] op_sel_hi:[1,0,0]
  v_lshlrev_b32 v66, 16, v13
  v_and_b32 v67, 0xffff0000, v13
  v_cvt_pk_bf16_f32 v11, v70, v71
  v_pk_fma_f32 v[64:65], v[64:65], v[100:101], v[102:103] op_sel_hi:[1,0,0]
  v_lshlrev_b32 v68, 16, v14
  v_and_b32 v69, 0xffff0000, v14
  v_cvt_pk_bf16_f32 v12, v64, v65
  v_pk_fma_f32 v[66:67], v[66:67], v[100:101], v[102:103] op_sel_hi:[1,0,0]
  v_lshlrev_b32 v70, 16, v15
  v_and_b32 v71, 0xffff0000, v15
  v_cvt_pk_bf16_f32 v13, v66, v67
  v_pk_fma_f32 v[68:69], v[68:69], v[100:101], v[102:103] op_sel_hi:[1,0,0]
  v_lshlrev_b32 v64, 16, v16
  v_and_b32 v65, 0xffff0000, v16
  v_cvt_pk_bf16_f32 v14, v68, v69
  v_pk_fma_f32 v[70:71], v[70:71], v[100:101], v[102:103] op_sel_hi:[1,0,0]
  v_lshlrev_b32 v66, 16, v17
  v_and_b32 v67, 0xffff0000, v17
  v_cvt_pk_bf16_f32 v15, v70, v71
  v_pk_fma_f32 v[64:65], v[64:65], v[100:101], v[102:103] op_sel_hi:[1,0,0]
  v_lshlrev_b32 v68, 16, v18
  v_and_b32 v69, 0xffff0000, v18
  v_cvt_pk_bf16_f32 v16, v64, v65
  v_pk_fma_f32 v[66:67], v[66:67], v[100:101], v[102:103] op_sel_hi:[1,0,0]
  v_lshlrev_b32 v70, 16, v19
  v_and_b32 v71, 0xffff0000, v19
  v_cvt_pk_bf16_f32 v17, v66, v67
  v_pk_fma_f32 v[68:69], v[68:69], v[100:101], v[102:103] op_sel_hi:[1,0,0]
  v_lshlrev_b32 v64, 16, v20
  v_and_b32 v65, 0xffff0000, v20
  v_cvt_pk_bf16_f32 v18, v68, v69
  v_pk_fma_f32 v[70:71], v[70:71], v[100:101], v[102:103] op_sel_hi:[1,0,0]
  v_lshlrev_b32 v66, 16, v21
  v_and_b32 v67, 0xffff0000, v21
  v_cvt_pk_bf16_f32 v19, v70, v71
  v_pk_fma_f32 v[64:65], v[64:65], v[100:101], v[102:103] op_sel_hi:[1,0,0]
  v_lshlrev_b32 v68, 16, v22
  v_and_b32 v69, 0xffff0000, v22
  v_cvt_pk_bf16_f32 v20, v64, v65
  v_pk_fma_f32 v[66:67], v[66:67], v[100:101], v[102:103] op_sel_hi:[1,0,0]
  v_lshlrev_b32 v70, 16, v23
  v_and_b32 v71, 0xffff0000, v23
  v_cvt_pk_bf16_f32 v21, v66, v67
  v_pk_fma_f32 v[68:69], v[68:69], v[100:101], v[102:103] op_sel_hi:[1,0,0]
  v_lshlrev_b32 v64, 16, v24
  v_and_b32 v65, 0xffff0000, v24
  v_cvt_pk_bf16_f32 v22, v68, v69
  v_pk_fma_f32 v[70:71], v[70:71], v[100:101], v[102:103] op_sel_hi:[1,0,0]
  v_lshlrev_b32 v66, 16, v25
  v_and_b32 v67, 0xffff0000, v25
  v_cvt_pk_bf16_f32 v23, v70, v71
  v_pk_fma_f32 v[64:65], v[64:65], v[100:101], v[102:103] op_sel_hi:[1,0,0]
  v_lshlrev_b32 v68, 16, v26
  v_and_b32 v69, 0xffff0000, v26
  v_cvt_pk_bf16_f32 v24, v64, v65
  v_pk_fma_f32 v[66:67], v[66:67], v[100:101], v[102:103] op_sel_hi:[1,0,0]
  v_lshlrev_b32 v70, 16, v27
  v_and_b32 v71, 0xffff0000, v27
  v_cvt_pk_bf16_f32 v25, v66, v67
  v_pk_fma_f32 v[68:69], v[68:69], v[100:101], v[102:103] op_sel_hi:[1,0,0]
  v_lshlrev_b32 v64, 16, v28
  v_and_b32 v65, 0xffff0000, v28
  v_cvt_pk_bf16_f32 v26, v68, v69
  v_pk_fma_f32 v[70:71], v[70:71], v[100:101], v[102:103] op_sel_hi:[1,0,0]
  v_lshlrev_b32 v66, 16, v29
  v_and_b32 v67, 0xffff0000, v29
  v_cvt_pk_bf16_f32 v27, v70, v71
  v_pk_fma_f32 v[64:65], v[64:65], v[100:101], v[102:103] op_sel_hi:[1,0,0]
  v_lshlrev_b32 v68, 16, v30
  v_and_b32 v69, 0xffff0000, v30
  v_cvt_pk_bf16_f32 v28, v64, v65
  v_pk_fma_f32 v[66:67], v[66:67], v[100:101], v[102:103] op_sel_hi:[1,0,0]
  v_lshlrev_b32 v70, 16, v31
  v_and_b32 v71, 0xffff0000, v31
  v_cvt_pk_bf16_f32 v29, v66, v67
  v_pk_fma_f32 v[68:69], v[68:69], v[100:101], v[102:103] op_sel_hi:[1,0,0]
  v_lshlrev_b32 v64, 16, v32
  v_and_b32 v65, 0xffff0000, v32
  v_cvt_pk_bf16_f32 v30, v68, v69
  v_pk_fma_f32 v[70:71], v[70:71], v[100:101], v[102:103] op_sel_hi:[1,0,0]
  v_lshlrev_b32 v66, 16, v33
  v_and_b32 v67, 0xffff0000, v33
  v_cvt_pk_bf16_f32 v31, v70, v71
  v_pk_fma_f32 v[64:65], v[64:65], v[100:101], v[102:103] op_sel_hi:[1,0,0]
  v_lshlrev_b32 v68, 16, v34
  v_and_b32 v69, 0xffff0000, v34
  v_cvt_pk_bf16_f32 v32, v64, v65
  v_pk_fma_f32 v[66:67], v[66:67], v[100:101], v[102:103] op_sel_hi:[1,0,0]
  v_lshlrev_b32 v70, 16, v35
  v_and_b32 v71, 0xffff0000, v35
  v_cvt_pk_bf16_f32 v33, v66, v67
  v_pk_fma_f32 v[68:69], v[68:69], v[100:101], v[102:103] op_sel_hi:[1,0,0]
  v_cvt_pk_bf16_f32 v34, v68, v69
  v_pk_fma_f32 v[70:71], v[70:71], v[100:101], v[102:103] op_sel_hi:[1,0,0]
  v_cvt_pk_bf16_f32 v35, v70, v71
  ds_write_b128 v116, v[8:11] offset:0
  ds_write_b128 v116, v[12:15] offset:4224
  ds_write_b128 v116, v[16:19] offset:8448
  ds_write_b128 v116, v[20:23] offset:12672
  ds_write_b128 v116, v[24:27] offset:16896
  ds_write_b128 v116, v[28:31] offset:21120
  ds_write_b128 v116, v[32:35] offset:25344
  s_lshr_b32 s51, s33, 1
  s_lshl_b32 s51, s51, 5
  s_add_u32 s51, s51, s32
  s_lshl_b32 s51, s51, 1
  s_and_b32 s35, s33, 1
  s_add_u32 s51, s51, s35
  s_lshl_b32 s51, s51, 3
  s_add_u32 s51, s51, 1867776
  s_waitcnt lgkmcnt(0)
  s_mul_i32 s48, s48, 0x9E3779B1
  s_add_u32 s48, s48, 0x7F4A7C15
  s_getreg_b32 s49, hwreg(HW_REG_XCC_ID, 0, 4)
  s_setprio 3
  s_barrier
  ds_read_b64_tr_b16 v[40:41], v117 offset:0
  ds_read_b64_tr_b16 v[42:43], v117 offset:224
  ds_read_b128 v[44:47], v118 offset:0
  ds_read_b64_tr_b16 v[48:49], v117 offset:896
  ds_read_b64_tr_b16 v[50:51], v117 offset:1120
  ds_read_b128 v[52:55], v118 offset:1056
  ds_read_b64_tr_b16 v[56:57], v117 offset:1792
  ds_read_b64_tr_b16 v[58:59], v117 offset:2016
  ds_read_b128 v[60:63], v118 offset:2112
  ds_read_b64_tr_b16 v[64:65], v117 offset:2688
  ds_read_b64_tr_b16 v[66:67], v117 offset:2912
  ds_read_b128 v[68:71], v118 offset:3168
  ds_read_b64_tr_b16 v[72:73], v117 offset:3584
  ds_read_b64_tr_b16 v[74:75], v117 offset:3808
  ds_read_b128 v[76:79], v118 offset:4224
  s_waitcnt lgkmcnt(12)
  v_mfma_f32_32x32x16_bf16 v[8:23], v[44:47], v[40:43], 0
  ds_read_b64_tr_b16 v[40:41], v117 offset:4480
  ds_read_b64_tr_b16 v[42:43], v117 offset:4704
  ds_read_b128 v[44:47], v118 offset:5280
  s_waitcnt lgkmcnt(12)
  v_mfma_f32_32x32x16_bf16 v[8:23], v[52:55], v[48:51], v[8:23]
  ds_read_b64_tr_b16 v[48:49], v117 offset:5376
  ds_read_b64_tr_b16 v[50:51], v117 offset:5600
  ds_read_b128 v[52:55], v118 offset:6336
  s_waitcnt lgkmcnt(12)
  v_mfma_f32_32x32x16_bf16 v[8:23], v[60:63], v[56:59], v[8:23]
  ds_read_b64_tr_b16 v[56:57], v117 offset:6272
  ds_read_b64_tr_b16 v[58:59], v117 offset:6496
  ds_read_b128 v[60:63], v118 offset:7392
  s_waitcnt lgkmcnt(12)
  v_mfma_f32_32x32x16_bf16 v[8:23], v[68:71], v[64:67], v[8:23]
  ds_read_b64_tr_b16 v[64:65], v117 offset:7168
  ds_read_b64_tr_b16 v[66:67], v117 offset:7392
  ds_read_b128 v[68:71], v118 offset:8448
  s_waitcnt lgkmcnt(12)
  v_mfma_f32_32x32x16_bf16 v[8:23], v[76:79], v[72:75], v[8:23]
  ds_read_b64_tr_b16 v[72:73], v117 offset:8064
  ds_read_b64_tr_b16 v[74:75], v117 offset:8288
  ds_read_b128 v[76:79], v118 offset:9504
  s_waitcnt lgkmcnt(12)
  v_mfma_f32_32x32x16_bf16 v[8:23], v[44:47], v[40:43], v[8:23]
  ds_read_b64_tr_b16 v[40:41], v117 offset:8960
  ds_read_b64_tr_b16 v[42:43], v117 offset:9184
  ds_read_b128 v[44:47], v118 offset:10560
  s_waitcnt lgkmcnt(12)
  v_mfma_f32_32x32x16_bf16 v[8:23], v[52:55], v[48:51], v[8:23]
  ds_read_b64_tr_b16 v[48:49], v117 offset:9856
  ds_read_b64_tr_b16 v[50:51], v117 offset:10080
  ds_read_b128 v[52:55], v118 offset:11616
  s_waitcnt lgkmcnt(12)
  v_mfma_f32_32x32x16_bf16 v[8:23], v[60:63], v[56:59], v[8:23]
  ds_read_b64_tr_b16 v[56:57], v117 offset:10752
  ds_read_b64_tr_b16 v[58:59], v117 offset:10976
  ds_read_b128 v[60:63], v118 offset:12672
  s_waitcnt lgkmcnt(12)
  v_mfma_f32_32x32x16_bf16 v[8:23], v[68:71], v[64:67], v[8:23]
  ds_read_b64_tr_b16 v[64:65], v117 offset:11648
  ds_read_b64_tr_b16 v[66:67], v117 offset:11872
  ds_read_b128 v[68:71], v118 offset:13728
  s_waitcnt lgkmcnt(12)
  v_mfma_f32_32x32x16_bf16 v[8:23], v[76:79], v[72:75], v[8:23]
  ds_read_b64_tr_b16 v[72:73], v117 offset:12544
  ds_read_b64_tr_b16 v[74:75], v117 offset:12768
  ds_read_b128 v[76:79], v118 offset:14784
  s_waitcnt lgkmcnt(12)
  v_mfma_f32_32x32x16_bf16 v[8:23], v[44:47], v[40:43], v[8:23]
  ds_read_b64_tr_b16 v[40:41], v117 offset:13440
  ds_read_b64_tr_b16 v[42:43], v117 offset:13664
  ds_read_b128 v[44:47], v118 offset:15840
  s_waitcnt lgkmcnt(12)
  v_mfma_f32_32x32x16_bf16 v[8:23], v[52:55], v[48:51], v[8:23]
  ds_read_b64_tr_b16 v[48:49], v117 offset:14336
  ds_read_b64_tr_b16 v[50:51], v117 offset:14560
  ds_read_b128 v[52:55], v118 offset:16896
  s_waitcnt lgkmcnt(12)
  v_mfma_f32_32x32x16_bf16 v[8:23], v[60:63], v[56:59], v[8:23]
  ds_read_b64_tr_b16 v[56:57], v117 offset:15232
  ds_read_b64_tr_b16 v[58:59], v117 offset:15456
  ds_read_b128 v[60:63], v118 offset:17952
  s_waitcnt lgkmcnt(12)
  v_mfma_f32_32x32x16_bf16 v[8:23], v[68:71], v[64:67], v[8:23]
  ds_read_b64_tr_b16 v[64:65], v117 offset:16128
  ds_read_b64_tr_b16 v[66:67], v117 offset:16352
  ds_read_b128 v[68:71], v118 offset:19008
  s_waitcnt lgkmcnt(12)
  v_mfma_f32_32x32x16_bf16 v[8:23], v[76:79], v[72:75], v[8:23]
  ds_read_b64_tr_b16 v[72:73], v117 offset:17024
  ds_read_b64_tr_b16 v[74:75], v117 offset:17248
  ds_read_b128 v[76:79], v118 offset:20064
  s_waitcnt lgkmcnt(12)
  v_mfma_f32_32x32x16_bf16 v[8:23], v[44:47], v[40:43], v[8:23]
  ds_read_b64_tr_b16 v[40:41], v117 offset:17920
  ds_read_b64_tr_b16 v[42:43], v117 offset:18144
  ds_read_b128 v[44:47], v118 offset:21120
  s_waitcnt lgkmcnt(12)
  v_mfma_f32_32x32x16_bf16 v[8:23], v[52:55], v[48:51], v[8:23]
  ds_read_b64_tr_b16 v[48:49], v117 offset:18816
  ds_read_b64_tr_b16 v[50:51], v117 offset:19040
  ds_read_b128 v[52:55], v118 offset:22176
  s_waitcnt lgkmcnt(12)
  v_mfma_f32_32x32x16_bf16 v[8:23], v[60:63], v[56:59], v[8:23]
  ds_read_b64_tr_b16 v[56:57], v117 offset:19712
  ds_read_b64_tr_b16 v[58:59], v117 offset:19936
  ds_read_b128 v[60:63], v118 offset:23232
  s_waitcnt lgkmcnt(12)
  v_mfma_f32_32x32x16_bf16 v[8:23], v[68:71], v[64:67], v[8:23]
  ds_read_b64_tr_b16 v[64:65], v117 offset:20608
  ds_read_b64_tr_b16 v[66:67], v117 offset:20832
  ds_read_b128 v[68:71], v118 offset:24288
  s_waitcnt lgkmcnt(12)
  v_mfma_f32_32x32x16_bf16 v[8:23], v[76:79], v[72:75], v[8:23]
  ds_read_b64_tr_b16 v[72:73], v117 offset:21504
  ds_read_b64_tr_b16 v[74:75], v117 offset:21728
  ds_read_b128 v[76:79], v118 offset:25344
  s_waitcnt lgkmcnt(12)
  v_mfma_f32_32x32x16_bf16 v[8:23], v[44:47], v[40:43], v[8:23]
  ds_read_b64_tr_b16 v[40:41], v117 offset:22400
  ds_read_b64_tr_b16 v[42:43], v117 offset:22624
  ds_read_b128 v[44:47], v118 offset:26400
  s_waitcnt lgkmcnt(12)
  v_mfma_f32_32x32x16_bf16 v[8:23], v[52:55], v[48:51], v[8:23]
  ds_read_b64_tr_b16 v[48:49], v117 offset:23296
  ds_read_b64_tr_b16 v[50:51], v117 offset:23520
  ds_read_b128 v[52:55], v118 offset:27456
  s_waitcnt lgkmcnt(12)
  v_mfma_f32_32x32x16_bf16 v[8:23], v[60:63], v[56:59], v[8:23]
  ds_read_b64_tr_b16 v[56:57], v117 offset:24192
  ds_read_b64_tr_b16 v[58:59], v117 offset:24416
  ds_read_b128 v[60:63], v118 offset:28512
  s_waitcnt lgkmcnt(12)
  v_mfma_f32_32x32x16_bf16 v[8:23], v[68:71], v[64:67], v[8:23]
  s_waitcnt lgkmcnt(9)
  v_mfma_f32_32x32x16_bf16 v[8:23], v[76:79], v[72:75], v[8:23]
  s_waitcnt lgkmcnt(6)
  v_mfma_f32_32x32x16_bf16 v[8:23], v[44:47], v[40:43], v[8:23]
  s_waitcnt lgkmcnt(3)
  v_mfma_f32_32x32x16_bf16 v[8:23], v[52:55], v[48:51], v[8:23]
  s_waitcnt lgkmcnt(0)
  v_mfma_f32_32x32x16_bf16 v[8:23], v[60:63], v[56:59], v[8:23]
  s_nop 11
  v_cvt_pk_bf16_f32 v40, v8, v9
  v_cvt_pk_bf16_f32 v41, v10, v11
  v_cvt_pk_bf16_f32 v42, v12, v13
  v_cvt_pk_bf16_f32 v43, v14, v15
  v_cndmask_b32 v40, v112, v40, vcc
  v_cndmask_b32 v41, v112, v41, vcc
  v_cndmask_b32 v42, v112, v42, vcc
  v_cndmask_b32 v43, v112, v43, vcc
  buffer_store_dwordx4 v[40:43], v119, s[28:31], s39 offen offset:2048 sc1
  v_cvt_pk_bf16_f32 v44, v16, v17
  v_cvt_pk_bf16_f32 v45, v18, v19
  v_cvt_pk_bf16_f32 v46, v20, v21
  v_cvt_pk_bf16_f32 v47, v22, v23
  v_cndmask_b32 v44, v112, v44, vcc
  v_cndmask_b32 v45, v112, v45, vcc
  v_cndmask_b32 v46, v112, v46, vcc
  v_cndmask_b32 v47, v112, v47, vcc
  buffer_store_dwordx4 v[44:47], v119, s[28:31], s39 offen offset:3072 sc1
L_pk_kvflag:
  v_mov_b32 v2, s48
  v_mov_b32 v3, s49
  v_lshlrev_b32 v4, 10, v1
  s_mov_b64 exec, 255
  s_waitcnt vmcnt(0)
  buffer_store_dwordx2 v[2:3], v4, s[28:31], s51 offen sc1
  s_mov_b64 exec, -1
  s_setprio 0
  s_barrier
L_pk_s1:
  s_and_b32 s39, s40, 0x1ffff
  s_add_u32 s39, s39, 2097152
  s_add_u32 s35, s39, 0x20000
  v_mov_b32 v32, 159752
  s_mov_b32 s38, 1048576
  s_cmp_eq_u32 s3, 7
  s_cbranch_scc1 L_pk_s1w7
  s_cmp_eq_u32 s50, 0
  s_cbranch_scc1 L_pks_fdone
  s_mov_b32 s36, 0x05040100
  s_mov_b32 s37, 0x07060302
  s_waitcnt vmcnt(0)
  s_cmp_gt_u32 s50, 2
  s_cbranch_scc1 L_pks_fdone
  s_cmp_eq_u32 s50, 2
  s_cbranch_scc1 L_pks_f2
  v_perm_b32 v240, v222, v220, s36
  v_perm_b32 v241, v226, v224, s36
  v_perm_b32 v242, v230, v228, s36
  v_perm_b32 v243, v234, v232, s36
  v_perm_b32 v244, v222, v220, s37
  v_perm_b32 v245, v226, v224, s37
  v_perm_b32 v246, v230, v228, s37
  v_perm_b32 v247, v234, v232, s37
  v_perm_b32 v248, v223, v221, s36
  v_perm_b32 v249, v227, v225, s36
  v_perm_b32 v250, v231, v229, s36
  v_perm_b32 v251, v235, v233, s36
  v_perm_b32 v252, v223, v221, s37
  v_perm_b32 v253, v227, v225, s37
  v_perm_b32 v254, v231, v229, s37
  v_perm_b32 v255, v235, v233, s37
  s_branch L_pks_fdone
L_pks_f2:
  v_perm_b32 v240, v221, v220, s36
  v_perm_b32 v241, v223, v222, s36
  v_perm_b32 v242, v225, v224, s36
  v_perm_b32 v243, v227, v226, s36
  v_perm_b32 v244, v221, v220, s37
  v_perm_b32 v245, v223, v222, s37
  v_perm_b32 v246, v225, v224, s37
  v_perm_b32 v247, v227, v226, s37
  v_perm_b32 v248, v229, v228, s36
  v_perm_b32 v249, v231, v230, s36
  v_perm_b32 v250, v233, v232, s36
  v_perm_b32 v251, v235, v234, s36
  v_perm_b32 v252, v229, v228, s37
  v_perm_b32 v253, v231, v230, s37
  v_perm_b32 v254, v233, v232, s37
  v_perm_b32 v255, v235, v234, s37
L_pks_fdone:
L_pk_s1go:
  s_sleep 1
  ds_read_b64 v[40:41], v32
  s_waitcnt lgkmcnt(0)
  v_cmp_eq_u32 vcc, s48, v41
  s_cbranch_vccz L_pk_s1go
  s_lshl_b32 s34, s20, 12
  s_add_u32 m0, s34, 0
  s_nop 0
  buffer_load_dwordx4 v104, s[28:31], s39 offen offset:0 sc1 lds
  buffer_load_dwordx4 v104, s[28:31], s39 offen offset:1024 sc1 lds
  buffer_load_dwordx4 v104, s[28:31], s39 offen offset:2048 sc1 lds
  buffer_load_dwordx4 v104, s[28:31], s39 offen offset:3072 sc1 lds
  s_add_u32 m0, s34, 16384
  s_nop 0
  buffer_load_dwordx4 v104, s[28:31], s35 offen offset:0 sc1 lds
  buffer_load_dwordx4 v104, s[28:31], s35 offen offset:1024 sc1 lds
  buffer_load_dwordx4 v104, s[28:31], s35 offen offset:2048 sc1 lds
  buffer_load_dwordx4 v104, s[28:31], s35 offen offset:3072 sc1 lds
  s_branch L_pk_s1done
L_pk_s1w7:
  v_lshlrev_b32 v42, 4, v1
  v_lshlrev_b32 v43, 3, v1
  s_lshl_b32 s37, s32, 7
  s_add_u32 s37, s37, 1884160
  s_and_b32 s36, s2, 7
  s_lshl_b32 s36, s36, 10
  s_add_u32 s36, s36, 1867776
  v_mov_b32 v48, s48
  v_mov_b32 v41, s48
  s_getreg_b32 s34, hwreg(HW_REG_XCC_ID, 0, 4)
  s_sleep 5
  buffer_load_dwordx4 v[44:47], v42, s[28:31], s36 offen sc1
  s_mov_b64 exec, 0xff
  buffer_load_dwordx2 v[48:49], v43, s[28:31], s37 offen sc1
  s_mov_b64 exec, -1
L_pk_s1poll:
  s_sub_u32 s38, s38, 1
  s_cbranch_scc1 L_pk_s1out0
  s_waitcnt vmcnt(0)
  v_xor_b32 v40, s48, v44
  v_xor_b32 v33, s48, v46
  v_xor_b32 v34, s48, v48
  v_or3_b32 v40, v40, v33, v34
  v_cmp_ne_u32 vcc, 0, v40
  s_cbranch_vccz L_pk_s1out0
  s_sleep 2
  buffer_load_dwordx4 v[44:47], v42, s[28:31], s36 offen sc1
  s_mov_b64 exec, 0xff
  buffer_load_dwordx2 v[48:49], v43, s[28:31], s37 offen sc1
  s_mov_b64 exec, -1
  s_branch L_pk_s1poll
L_pk_s1out0:
  v_cmp_ne_u32 vcc, s34, v49
  v_max_f32 v35, v45, v47
L_pk_s1out:
  s_and_b32 s34, vcc_lo, 0xff
  v_mov_b32 v40, s34
  ds_write_b64 v32, v[40:41]
  s_lshl_b32 s34, s20, 12
  s_add_u32 m0, s34, 0
  s_nop 0
  buffer_load_dwordx4 v104, s[28:31], s39 offen offset:0 sc1 lds
  buffer_load_dwordx4 v104, s[28:31], s39 offen offset:1024 sc1 lds
  buffer_load_dwordx4 v104, s[28:31], s39 offen offset:2048 sc1 lds
  buffer_load_dwordx4 v104, s[28:31], s39 offen offset:3072 sc1 lds
  s_add_u32 m0, s34, 16384
  s_nop 0
  buffer_load_dwordx4 v104, s[28:31], s35 offen offset:0 sc1 lds
  buffer_load_dwordx4 v104, s[28:31], s35 offen offset:1024 sc1 lds
  buffer_load_dwordx4 v104, s[28:31], s35 offen offset:2048 sc1 lds
  buffer_load_dwordx4 v104, s[28:31], s35 offen offset:3072 sc1 lds
  s_nop 1
  v_max_f32_dpp v35, v35, v35 quad_perm:[1,0,3,2] row_mask:0xf bank_mask:0xf
  s_nop 1
  v_max_f32_dpp v35, v35, v35 quad_perm:[2,3,0,1] row_mask:0xf bank_mask:0xf
  s_nop 1
  v_max_f32_dpp v35, v35, v35 row_half_mirror row_mask:0xf bank_mask:0xf
  s_nop 1
  v_max_f32_dpp v35, v35, v35 row_mirror row_mask:0xf bank_mask:0xf
  v_mov_b32 v36, v35
  s_nop 1
  v_permlane16_swap_b32 v35, v36
  s_nop 1
  v_max_f32 v35, v35, v36
  v_mov_b32 v36, v35
  s_nop 1
  v_permlane32_swap_b32 v35, v36
  s_nop 1
  v_max_f32 v35, v35, v36
  v_sqrt_f32 v35, v35
  s_nop 0
  v_mul_f32 v35, 0xbf828f5c, v35
  ds_write_b32 v32, v35 offset:8
L_pk_s1perm:
L_pk_s1done:
  s_add_u32 s40, s40, 16384
  s_and_b32 s40, s40, 0x1ffff
  s_or_b32 s40, s40, s12
  s_mov_b32 s52, s14
  s_mov_b32 s53, s15
  s_mov_b32 s54, 29360128
  s_mov_b32 s55, 0x20000
  s_cmp_eq_u32 s3, 7
  s_cselect_b32 s54, 0, s54
  v_cmp_lt_u32 vcc, 31, v1
  s_mov_b32 s46, s45
  s_mul_i32 s47, s45, 28672
  s_add_u32 s45, s47, 2949120
  s_add_u32 s47, s47, 4587520
  s_mul_i32 s13, s20, 7168
  s_mov_b32 s38, 0xc2400000
  s_add_u32 m0, s41, 32768
  v_mov_b32 v2, 159752
  s_waitcnt lgkmcnt(0)
  s_barrier
  ds_read_b128 v[8:11], v110
  ds_read_b128 v[12:15], v110 offset:1024
  ds_read_b32 v108, v2 offset:8
  ds_read_b32 v2, v2
  buffer_load_dwordx4 v104, s[28:31], s40 offen offset:0 sc1 lds
  buffer_load_dwordx4 v104, s[28:31], s40 offen offset:1024 sc1 lds
  s_waitcnt lgkmcnt(3)
  v_dot2_f32_bf16 v64, v8, v8, 0
  v_dot2_f32_bf16 v65, v9, v9, 0
  v_dot2_f32_bf16 v64, v10, v10, v64
  v_dot2_f32_bf16 v65, v11, v11, v65
  s_waitcnt lgkmcnt(2)
  v_cndmask_b32 v14, v14, 0, vcc
  v_cndmask_b32 v15, v15, 0, vcc
  v_dot2_f32_bf16 v64, v12, v12, v64
  v_dot2_f32_bf16 v65, v13, v13, v65
  v_dot2_f32_bf16 v64, v14, v14, v64
  v_dot2_f32_bf16 v65, v15, v15, v65
  s_nop 2
  v_add_f32 v109, v64, v65
  v_mov_b32 v64, v109
  s_waitcnt lgkmcnt(0)
  v_readfirstlane_b32 s49, v2
  v_permlane32_swap_b32 v109, v64
  s_nop 1
  v_add_f32 v109, v109, v64
  v_sqrt_f32 v109, v109
  s_nop 0
  v_mul_f32 v108, v108, v109
  v_cmp_nge_f32 s[36:37], v108, s38
  v_lshrrev_b32 v108, 16, v108
  s_nop 2
  s_cmp_lg_u32 s37, 0
  s_cbranch_scc1 L_pk_slow
  v_cndmask_b32 v14, v14, v108, vcc
  s_cmp_ge_u32 s3, 4
  s_cbranch_scc1 L_pk_role1
  s_waitcnt vmcnt(2)
  s_barrier
  ds_read_b128 v[72:75], v105 offset:0
  ds_read_b128 v[76:79], v105 offset:1024
  ds_read_b128 v[80:83], v105 offset:4096
  ds_read_b128 v[84:87], v105 offset:5120
  ds_read_b128 v[88:91], v105 offset:2048
  ds_read_b128 v[92:95], v105 offset:3072
  buffer_load_dwordx4 v104, s[28:31], s40 offen offset:2048 sc1 lds
  buffer_load_dwordx4 v104, s[28:31], s40 offen offset:3072 sc1 lds
  s_add_u32 s40, s40, 16384
  s_and_b32 s40, s40, 0x1ffff
  s_or_b32 s40, s40, s12
  s_add_u32 s39, s40, 0x20000
  s_waitcnt lgkmcnt(4)
  v_mfma_f32_32x32x16_bf16 v[32:47], v[72:75], v[8:11], 0
  v_mfma_f32_32x32x16_bf16 v[32:47], v[76:79], v[12:15], v[32:47]
  v_and_b32 v2, 31, v1
  s_lshr_b32 s34, s46, 2
L_wm_P4:
  s_cbranch_execz L_wm_P5
  s_lshl_b32 s34, s34, 8
  s_and_b32 s35, s46, 3
  s_lshl_b32 s35, s35, 1
  s_add_u32 s34, s34, s35
  v_lshl_add_u32 v234, v2, 3, s34
  s_lshl_b32 s35, s32, 1
  s_lshr_b32 s36, s3, 1
  s_add_u32 s35, s35, s36
  s_mul_i32 s35, s35, 28672
  s_mul_i32 s36, s33, 112
  s_add_u32 s35, s35, s36
  s_and_b32 s36, s3, 1
  s_lshl_b32 s36, s36, 6
  s_add_u32 s35, s35, s36
  v_and_b32 v2, 15, v1
  v_mul_u32_u24 v2, 896, v2
  v_bfe_u32 v3, v1, 4, 1
  v_lshl_add_u32 v2, v3, 5, v2
  v_lshrrev_b32 v3, 5, v1
  v_lshl_add_u32 v2, v3, 4, v2
  v_add_u32 v232, s35, v2
  v_add_u32 v233, 14336, v232
  s_setprio 1
  s_waitcnt lgkmcnt(2)
  v_mfma_f32_32x32x16_bf16 v[48:63], v[80:83], v[8:11], 0
  ds_read_b128 v[72:75], v105 offset:8192
  ds_read_b128 v[76:79], v105 offset:9216
  v_exp_f32 v32, v32
  v_exp_f32 v33, v33
  v_exp_f32 v34, v34
  buffer_store_dwordx4 v[240:243], v236, s[28:31], 0 offen sc1
  v_exp_f32 v35, v35
  v_exp_f32 v36, v36
  ds_read_b128 v[96:99], v105 offset:6144
  ds_read_b128 v[100:103], v105 offset:7168
  v_cvt_pk_bf16_f32 v64, v32, v33
  v_exp_f32 v37, v37
  v_cvt_pk_bf16_f32 v65, v34, v35
  v_exp_f32 v38, v38
  v_exp_f32 v39, v39
  v_cvt_pk_bf16_f32 v66, v36, v37
  s_add_u32 m0, s41, 65536
  v_mfma_f32_32x32x16_bf16 v[48:63], v[84:87], v[12:15], v[48:63]
  buffer_load_dwordx4 v104, s[28:31], s40 offen offset:0 sc1 lds
  v_exp_f32 v40, v40
  v_cvt_pk_bf16_f32 v67, v38, v39
  v_exp_f32 v41, v41
  s_add_u32 m0, s41, 81920
  v_exp_f32 v42, v42
  buffer_load_dwordx4 v104, s[28:31], s39 offen offset:0 sc1 lds
  v_exp_f32 v43, v43
  v_exp_f32 v44, v44
  s_waitcnt lgkmcnt(4)
  v_mfma_f32_32x32x16_bf16 v[16:31], v[88:91], v[64:67], 0
  v_cvt_pk_bf16_f32 v68, v40, v41
  v_exp_f32 v45, v45
  v_cvt_pk_bf16_f32 v69, v42, v43
  v_exp_f32 v46, v46
  v_exp_f32 v47, v47
  v_cvt_pk_bf16_f32 v70, v44, v45
  v_cvt_pk_bf16_f32 v71, v46, v47
  s_setprio 0
  s_waitcnt lgkmcnt(2)
  v_mfma_f32_32x32x16_bf16 v[32:47], v[72:75], v[8:11], 0
  ds_read_b128 v[80:83], v105 offset:12288
  ds_read_b128 v[84:87], v105 offset:13312
  v_exp_f32 v48, v48
  v_exp_f32 v49, v49
  v_exp_f32 v50, v50
  buffer_store_dwordx4 v[244:247], v237, s[28:31], 0 offen sc1
  v_exp_f32 v51, v51
  v_exp_f32 v52, v52
  v_mfma_f32_32x32x16_bf16 v[16:31], v[92:95], v[68:71], v[16:31]
  ds_read_b128 v[88:91], v105 offset:10240
  ds_read_b128 v[92:95], v105 offset:11264
  v_cvt_pk_bf16_f32 v64, v48, v49
  v_exp_f32 v53, v53
  v_cvt_pk_bf16_f32 v65, v50, v51
  v_exp_f32 v54, v54
  v_exp_f32 v55, v55
  v_cvt_pk_bf16_f32 v66, v52, v53
  s_add_u32 m0, s41, 65536
  v_mfma_f32_32x32x16_bf16 v[32:47], v[76:79], v[12:15], v[32:47]
  buffer_load_dwordx4 v104, s[28:31], s40 offen offset:1024 sc1 lds
  v_exp_f32 v56, v56
  v_cvt_pk_bf16_f32 v67, v54, v55
  v_exp_f32 v57, v57
  s_add_u32 m0, s41, 81920
  v_exp_f32 v58, v58
  buffer_load_dwordx4 v104, s[28:31], s39 offen offset:1024 sc1 lds
  v_exp_f32 v59, v59
  v_exp_f32 v60, v60
  s_waitcnt lgkmcnt(4)
  v_mfma_f32_32x32x16_bf16 v[16:31], v[96:99], v[64:67], v[16:31]
  v_cvt_pk_bf16_f32 v68, v56, v57
  v_exp_f32 v61, v61
  v_cvt_pk_bf16_f32 v69, v58, v59
  v_exp_f32 v62, v62
  v_exp_f32 v63, v63
  v_cvt_pk_bf16_f32 v70, v60, v61
  v_cvt_pk_bf16_f32 v71, v62, v63
  s_waitcnt vmcnt(6)
  s_barrier
  s_setprio 3
  s_waitcnt lgkmcnt(2)
  v_mfma_f32_32x32x16_bf16 v[48:63], v[80:83], v[8:11], 0
  ds_read_b128 v[72:75], v105 offset:32768
  ds_read_b128 v[76:79], v105 offset:33792
  v_exp_f32 v32, v32
  v_exp_f32 v33, v33
  v_exp_f32 v34, v34
  buffer_store_dwordx4 v[248:251], v238, s[28:31], 0 offen sc1
  v_exp_f32 v35, v35
  v_exp_f32 v36, v36
  v_mfma_f32_32x32x16_bf16 v[16:31], v[100:103], v[68:71], v[16:31]
  ds_read_b128 v[96:99], v105 offset:14336
  ds_read_b128 v[100:103], v105 offset:15360
  v_cvt_pk_bf16_f32 v64, v32, v33
  v_exp_f32 v37, v37
  v_cvt_pk_bf16_f32 v65, v34, v35
  v_exp_f32 v38, v38
  v_exp_f32 v39, v39
  v_cvt_pk_bf16_f32 v66, v36, v37
  s_add_u32 m0, s41, 65536
  v_mfma_f32_32x32x16_bf16 v[48:63], v[84:87], v[12:15], v[48:63]
  buffer_load_dwordx4 v104, s[28:31], s40 offen offset:2048 sc1 lds
  v_exp_f32 v40, v40
  v_cvt_pk_bf16_f32 v67, v38, v39
  v_exp_f32 v41, v41
  s_add_u32 m0, s41, 81920
  v_exp_f32 v42, v42
  buffer_load_dwordx4 v104, s[28:31], s39 offen offset:2048 sc1 lds
  v_exp_f32 v43, v43
  v_exp_f32 v44, v44
  s_waitcnt lgkmcnt(4)
  v_mfma_f32_32x32x16_bf16 v[16:31], v[88:91], v[64:67], v[16:31]
  v_cvt_pk_bf16_f32 v68, v40, v41
  v_exp_f32 v45, v45
  v_cvt_pk_bf16_f32 v69, v42, v43
  v_exp_f32 v46, v46
  v_exp_f32 v47, v47
  v_cvt_pk_bf16_f32 v70, v44, v45
  v_cvt_pk_bf16_f32 v71, v46, v47
  s_setprio 2
  s_waitcnt lgkmcnt(2)
  v_mfma_f32_32x32x16_bf16 v[32:47], v[72:75], v[8:11], 0
  ds_read_b128 v[80:83], v105 offset:36864
  ds_read_b128 v[84:87], v105 offset:37888
  v_exp_f32 v48, v48
  v_exp_f32 v49, v49
  v_exp_f32 v50, v50
  buffer_store_dwordx4 v[252:255], v239, s[28:31], 0 offen sc1
  v_exp_f32 v51, v51
  v_exp_f32 v52, v52
  v_mfma_f32_32x32x16_bf16 v[16:31], v[92:95], v[68:71], v[16:31]
  ds_read_b128 v[88:91], v105 offset:34816
  ds_read_b128 v[92:95], v105 offset:35840
  v_cvt_pk_bf16_f32 v64, v48, v49
  v_exp_f32 v53, v53
  v_cvt_pk_bf16_f32 v65, v50, v51
  v_exp_f32 v54, v54
  v_exp_f32 v55, v55
  v_cvt_pk_bf16_f32 v66, v52, v53
  s_add_u32 m0, s41, 65536
  v_mfma_f32_32x32x16_bf16 v[32:47], v[76:79], v[12:15], v[32:47]
  buffer_load_dwordx4 v104, s[28:31], s40 offen offset:3072 sc1 lds
  v_exp_f32 v56, v56
  v_cvt_pk_bf16_f32 v67, v54, v55
  v_exp_f32 v57, v57
  s_add_u32 m0, s41, 81920
  v_exp_f32 v58, v58
  buffer_load_dwordx4 v104, s[28:31], s39 offen offset:3072 sc1 lds
  s_add_u32 s40, s40, 16384
  s_and_b32 s40, s40, 0x1ffff
  s_or_b32 s40, s40, s12
  s_add_u32 s39, s40, 0x20000
  v_exp_f32 v59, v59
  v_exp_f32 v60, v60
  s_waitcnt lgkmcnt(4)
  v_mfma_f32_32x32x16_bf16 v[16:31], v[96:99], v[64:67], v[16:31]
  v_cvt_pk_bf16_f32 v68, v56, v57
  v_exp_f32 v61, v61
  v_cvt_pk_bf16_f32 v69, v58, v59
  v_exp_f32 v62, v62
  v_exp_f32 v63, v63
  v_cvt_pk_bf16_f32 v70, v60, v61
  v_cvt_pk_bf16_f32 v71, v62, v63
  s_setprio 1
  s_waitcnt lgkmcnt(2)
  v_mfma_f32_32x32x16_bf16 v[48:63], v[80:83], v[8:11], 0
  ds_read_b128 v[72:75], v105 offset:40960
  ds_read_b128 v[76:79], v105 offset:41984
  v_exp_f32 v32, v32
  v_exp_f32 v33, v33
  v_exp_f32 v34, v34
  v_exp_f32 v35, v35
  v_exp_f32 v36, v36
  v_mfma_f32_32x32x16_bf16 v[16:31], v[100:103], v[68:71], v[16:31]
  ds_read_b128 v[96:99], v105 offset:38912
  ds_read_b128 v[100:103], v105 offset:39936
  v_cvt_pk_bf16_f32 v64, v32, v33
  v_exp_f32 v37, v37
  v_cvt_pk_bf16_f32 v65, v34, v35
  v_exp_f32 v38, v38
  v_exp_f32 v39, v39
  v_cvt_pk_bf16_f32 v66, v36, v37
  s_add_u32 m0, s41, 98304
  v_mfma_f32_32x32x16_bf16 v[48:63], v[84:87], v[12:15], v[48:63]
  buffer_load_dwordx4 v104, s[28:31], s40 offen offset:0 sc1 lds
  v_exp_f32 v40, v40
  v_cvt_pk_bf16_f32 v67, v38, v39
  v_exp_f32 v41, v41
  v_exp_f32 v42, v42
  v_exp_f32 v43, v43
  v_exp_f32 v44, v44
  s_waitcnt lgkmcnt(4)
  s_add_u32 m0, s41, 114688
  v_mfma_f32_32x32x16_bf16 v[16:31], v[88:91], v[64:67], v[16:31]
  buffer_load_dwordx4 v104, s[28:31], s39 offen offset:0 sc1 lds
  v_cvt_pk_bf16_f32 v68, v40, v41
  v_exp_f32 v45, v45
  v_cvt_pk_bf16_f32 v69, v42, v43
  v_exp_f32 v46, v46
  v_exp_f32 v47, v47
  v_cvt_pk_bf16_f32 v70, v44, v45
  v_cvt_pk_bf16_f32 v71, v46, v47
  s_setprio 0
  s_waitcnt lgkmcnt(2)
  v_mfma_f32_32x32x16_bf16 v[32:47], v[72:75], v[8:11], 0
  ds_read_b128 v[80:83], v105 offset:45056
  ds_read_b128 v[84:87], v105 offset:46080
  v_exp_f32 v48, v48
  v_exp_f32 v49, v49
  v_exp_f32 v50, v50
  v_exp_f32 v51, v51
  v_exp_f32 v52, v52
  v_mfma_f32_32x32x16_bf16 v[16:31], v[92:95], v[68:71], v[16:31]
  ds_read_b128 v[88:91], v105 offset:43008
  ds_read_b128 v[92:95], v105 offset:44032
  v_cvt_pk_bf16_f32 v64, v48, v49
  v_exp_f32 v53, v53
  v_cvt_pk_bf16_f32 v65, v50, v51
  v_exp_f32 v54, v54
  v_exp_f32 v55, v55
  v_cvt_pk_bf16_f32 v66, v52, v53
  s_add_u32 m0, s41, 98304
  v_mfma_f32_32x32x16_bf16 v[32:47], v[76:79], v[12:15], v[32:47]
  buffer_load_dwordx4 v104, s[28:31], s40 offen offset:1024 sc1 lds
  v_exp_f32 v56, v56
  v_cvt_pk_bf16_f32 v67, v54, v55
  v_exp_f32 v57, v57
  v_exp_f32 v58, v58
  v_exp_f32 v59, v59
  v_exp_f32 v60, v60
  s_waitcnt lgkmcnt(4)
  s_add_u32 m0, s41, 114688
  v_mfma_f32_32x32x16_bf16 v[16:31], v[96:99], v[64:67], v[16:31]
  buffer_load_dwordx4 v104, s[28:31], s39 offen offset:1024 sc1 lds
  v_cvt_pk_bf16_f32 v68, v56, v57
  v_exp_f32 v61, v61
  v_cvt_pk_bf16_f32 v69, v58, v59
  v_exp_f32 v62, v62
  v_exp_f32 v63, v63
  v_cvt_pk_bf16_f32 v70, v60, v61
  v_cvt_pk_bf16_f32 v71, v62, v63
  s_waitcnt vmcnt(4)
  s_barrier
  s_lshl_b32 s34, s2, 2
  s_add_u32 s34, s34, 2392064
  s_cmp_eq_u32 s3, 0
  v_mov_b32 v2, 0
  v_mov_b32 v3, s48
  s_cselect_b64 exec, 1, 0
  buffer_store_dword v3, v2, s[28:31], s34 offen sc1
  s_mov_b64 exec, -1
  s_setprio 3
  s_waitcnt lgkmcnt(2)
  v_mfma_f32_32x32x16_bf16 v[48:63], v[80:83], v[8:11], 0
  ds_read_b128 v[72:75], v106 offset:0
  ds_read_b128 v[76:79], v106 offset:1024
  v_exp_f32 v32, v32
  v_exp_f32 v33, v33
  v_exp_f32 v34, v34
  v_exp_f32 v35, v35
  v_exp_f32 v36, v36
  v_mfma_f32_32x32x16_bf16 v[16:31], v[100:103], v[68:71], v[16:31]
  ds_read_b128 v[96:99], v105 offset:47104
  ds_read_b128 v[100:103], v105 offset:48128
  v_cvt_pk_bf16_f32 v64, v32, v33
  v_exp_f32 v37, v37
  v_cvt_pk_bf16_f32 v65, v34, v35
  v_exp_f32 v38, v38
  v_exp_f32 v39, v39
  v_cvt_pk_bf16_f32 v66, v36, v37
  s_add_u32 m0, s41, 98304
  v_mfma_f32_32x32x16_bf16 v[48:63], v[84:87], v[12:15], v[48:63]
  buffer_load_dwordx4 v104, s[28:31], s40 offen offset:2048 sc1 lds
  v_exp_f32 v40, v40
  v_cvt_pk_bf16_f32 v67, v38, v39
  v_exp_f32 v41, v41
  v_exp_f32 v42, v42
  v_exp_f32 v43, v43
  v_exp_f32 v44, v44
  s_waitcnt lgkmcnt(4)
  s_add_u32 m0, s41, 114688
  v_mfma_f32_32x32x16_bf16 v[16:31], v[88:91], v[64:67], v[16:31]
  buffer_load_dwordx4 v104, s[28:31], s39 offen offset:2048 sc1 lds
  v_cvt_pk_bf16_f32 v68, v40, v41
  v_exp_f32 v45, v45
  v_cvt_pk_bf16_f32 v69, v42, v43
  v_exp_f32 v46, v46
  v_exp_f32 v47, v47
  v_cvt_pk_bf16_f32 v70, v44, v45
  v_cvt_pk_bf16_f32 v71, v46, v47
  s_setprio 2
  s_waitcnt lgkmcnt(2)
  v_mfma_f32_32x32x16_bf16 v[32:47], v[72:75], v[8:11], 0
  ds_read_b128 v[80:83], v106 offset:4096
  ds_read_b128 v[84:87], v106 offset:5120
  v_exp_f32 v48, v48
  v_exp_f32 v49, v49
  v_exp_f32 v50, v50
  v_exp_f32 v51, v51
  v_exp_f32 v52, v52
  v_mfma_f32_32x32x16_bf16 v[16:31], v[92:95], v[68:71], v[16:31]
  ds_read_b128 v[88:91], v106 offset:2048
  ds_read_b128 v[92:95], v106 offset:3072
  v_cvt_pk_bf16_f32 v64, v48, v49
  v_exp_f32 v53, v53
  v_cvt_pk_bf16_f32 v65, v50, v51
  v_exp_f32 v54, v54
  v_exp_f32 v55, v55
  v_cvt_pk_bf16_f32 v66, v52, v53
  s_add_u32 m0, s41, 98304
  v_mfma_f32_32x32x16_bf16 v[32:47], v[76:79], v[12:15], v[32:47]
  buffer_load_dwordx4 v104, s[28:31], s40 offen offset:3072 sc1 lds
  v_exp_f32 v56, v56
  v_cvt_pk_bf16_f32 v67, v54, v55
  v_exp_f32 v57, v57
  v_exp_f32 v58, v58
  v_exp_f32 v59, v59
  v_exp_f32 v60, v60
  s_waitcnt lgkmcnt(4)
  s_add_u32 m0, s41, 114688
  v_mfma_f32_32x32x16_bf16 v[16:31], v[96:99], v[64:67], v[16:31]
  buffer_load_dwordx4 v104, s[28:31], s39 offen offset:3072 sc1 lds
  s_add_u32 s40, s40, 16384
  s_and_b32 s40, s40, 0x1ffff
  s_or_b32 s40, s40, s12
  s_add_u32 s39, s40, 0x20000
  v_cvt_pk_bf16_f32 v68, v56, v57
  v_exp_f32 v61, v61
  v_cvt_pk_bf16_f32 v69, v58, v59
  v_exp_f32 v62, v62
  v_exp_f32 v63, v63
  v_cvt_pk_bf16_f32 v70, v60, v61
  v_cvt_pk_bf16_f32 v71, v62, v63
  s_setprio 1
  s_waitcnt lgkmcnt(2)
  v_mfma_f32_32x32x16_bf16 v[48:63], v[80:83], v[8:11], 0
  ds_read_b128 v[72:75], v106 offset:8192
  ds_read_b128 v[76:79], v106 offset:9216
  v_exp_f32 v32, v32
  v_exp_f32 v33, v33
  v_exp_f32 v34, v34
  v_exp_f32 v35, v35
  v_exp_f32 v36, v36
  v_mfma_f32_32x32x16_bf16 v[16:31], v[100:103], v[68:71], v[16:31]
  ds_read_b128 v[96:99], v106 offset:6144
  ds_read_b128 v[100:103], v106 offset:7168
  v_cvt_pk_bf16_f32 v64, v32, v33
  v_exp_f32 v37, v37
  v_cvt_pk_bf16_f32 v65, v34, v35
  v_exp_f32 v38, v38
  v_exp_f32 v39, v39
  v_cvt_pk_bf16_f32 v66, v36, v37
  s_add_u32 m0, s41, 0
  v_mfma_f32_32x32x16_bf16 v[48:63], v[84:87], v[12:15], v[48:63]
  buffer_load_dwordx4 v104, s[28:31], s40 offen offset:0 sc1 lds
  v_exp_f32 v40, v40
  v_cvt_pk_bf16_f32 v67, v38, v39
  v_exp_f32 v41, v41
  v_exp_f32 v42, v42
  v_exp_f32 v43, v43
  v_exp_f32 v44, v44
  s_waitcnt lgkmcnt(4)
  s_add_u32 m0, s41, 16384
  v_mfma_f32_32x32x16_bf16 v[16:31], v[88:91], v[64:67], v[16:31]
  buffer_load_dwordx4 v104, s[28:31], s39 offen offset:0 sc1 lds
  v_cvt_pk_bf16_f32 v68, v40, v41
  v_exp_f32 v45, v45
  v_cvt_pk_bf16_f32 v69, v42, v43
  v_exp_f32 v46, v46
  v_exp_f32 v47, v47
  v_cvt_pk_bf16_f32 v70, v44, v45
  v_cvt_pk_bf16_f32 v71, v46, v47
  s_setprio 0
  s_waitcnt lgkmcnt(2)
  v_mfma_f32_32x32x16_bf16 v[32:47], v[72:75], v[8:11], 0
  ds_read_b128 v[80:83], v106 offset:12288
  ds_read_b128 v[84:87], v106 offset:13312
  v_exp_f32 v48, v48
  v_exp_f32 v49, v49
  v_exp_f32 v50, v50
  v_exp_f32 v51, v51
  v_exp_f32 v52, v52
  v_mfma_f32_32x32x16_bf16 v[16:31], v[92:95], v[68:71], v[16:31]
  ds_read_b128 v[88:91], v106 offset:10240
  ds_read_b128 v[92:95], v106 offset:11264
  v_cvt_pk_bf16_f32 v64, v48, v49
  v_exp_f32 v53, v53
  v_cvt_pk_bf16_f32 v65, v50, v51
  v_exp_f32 v54, v54
  v_exp_f32 v55, v55
  v_cvt_pk_bf16_f32 v66, v52, v53
  s_add_u32 m0, s41, 0
  v_mfma_f32_32x32x16_bf16 v[32:47], v[76:79], v[12:15], v[32:47]
  buffer_load_dwordx4 v104, s[28:31], s40 offen offset:1024 sc1 lds
  v_exp_f32 v56, v56
  v_cvt_pk_bf16_f32 v67, v54, v55
  v_exp_f32 v57, v57
  v_exp_f32 v58, v58
  v_exp_f32 v59, v59
  v_exp_f32 v60, v60
  s_waitcnt lgkmcnt(4)
  s_add_u32 m0, s41, 16384
  v_mfma_f32_32x32x16_bf16 v[16:31], v[96:99], v[64:67], v[16:31]
  buffer_load_dwordx4 v104, s[28:31], s39 offen offset:1024 sc1 lds
  v_cvt_pk_bf16_f32 v68, v56, v57
  v_exp_f32 v61, v61
  v_cvt_pk_bf16_f32 v69, v58, v59
  v_exp_f32 v62, v62
  v_exp_f32 v63, v63
  v_cvt_pk_bf16_f32 v70, v60, v61
  v_cvt_pk_bf16_f32 v71, v62, v63
  s_waitcnt vmcnt(4)
  s_barrier
  s_setprio 3
  s_waitcnt lgkmcnt(2)
  v_mfma_f32_32x32x16_bf16 v[48:63], v[80:83], v[8:11], 0
  ds_read_b128 v[72:75], v106 offset:32768
  ds_read_b128 v[76:79], v106 offset:33792
  v_exp_f32 v32, v32
  v_exp_f32 v33, v33
  v_exp_f32 v34, v34
  v_exp_f32 v35, v35
  v_exp_f32 v36, v36
  v_mfma_f32_32x32x16_bf16 v[16:31], v[100:103], v[68:71], v[16:31]
  ds_read_b128 v[96:99], v106 offset:14336
  ds_read_b128 v[100:103], v106 offset:15360
  v_cvt_pk_bf16_f32 v64, v32, v33
  v_exp_f32 v37, v37
  v_cvt_pk_bf16_f32 v65, v34, v35
  v_exp_f32 v38, v38
  v_exp_f32 v39, v39
  v_cvt_pk_bf16_f32 v66, v36, v37
  s_add_u32 m0, s41, 0
  v_mfma_f32_32x32x16_bf16 v[48:63], v[84:87], v[12:15], v[48:63]
  buffer_load_dwordx4 v104, s[28:31], s40 offen offset:2048 sc1 lds
  v_exp_f32 v40, v40
  v_cvt_pk_bf16_f32 v67, v38, v39
  v_exp_f32 v41, v41
  v_exp_f32 v42, v42
  v_exp_f32 v43, v43
  v_exp_f32 v44, v44
  s_waitcnt lgkmcnt(4)
  s_add_u32 m0, s41, 16384
  v_mfma_f32_32x32x16_bf16 v[16:31], v[88:91], v[64:67], v[16:31]
  buffer_load_dwordx4 v104, s[28:31], s39 offen offset:2048 sc1 lds
  v_cvt_pk_bf16_f32 v68, v40, v41
  v_exp_f32 v45, v45
  v_cvt_pk_bf16_f32 v69, v42, v43
  v_exp_f32 v46, v46
  v_exp_f32 v47, v47
  v_cvt_pk_bf16_f32 v70, v44, v45
  v_cvt_pk_bf16_f32 v71, v46, v47
  s_setprio 2
  s_waitcnt lgkmcnt(2)
  v_mfma_f32_32x32x16_bf16 v[32:47], v[72:75], v[8:11], 0
  ds_read_b128 v[80:83], v106 offset:36864
  ds_read_b128 v[84:87], v106 offset:37888
  v_exp_f32 v48, v48
  v_exp_f32 v49, v49
  v_exp_f32 v50, v50
  v_exp_f32 v51, v51
  v_exp_f32 v52, v52
  v_mfma_f32_32x32x16_bf16 v[16:31], v[92:95], v[68:71], v[16:31]
  ds_read_b128 v[88:91], v106 offset:34816
  ds_read_b128 v[92:95], v106 offset:35840
  v_cvt_pk_bf16_f32 v64, v48, v49
  v_exp_f32 v53, v53
  v_cvt_pk_bf16_f32 v65, v50, v51
  v_exp_f32 v54, v54
  v_exp_f32 v55, v55
  v_cvt_pk_bf16_f32 v66, v52, v53
  s_add_u32 m0, s41, 0
  v_mfma_f32_32x32x16_bf16 v[32:47], v[76:79], v[12:15], v[32:47]
  buffer_load_dwordx4 v104, s[28:31], s40 offen offset:3072 sc1 lds
  v_exp_f32 v56, v56
  v_cvt_pk_bf16_f32 v67, v54, v55
  v_exp_f32 v57, v57
  v_exp_f32 v58, v58
  v_exp_f32 v59, v59
  v_exp_f32 v60, v60
  s_waitcnt lgkmcnt(4)
  s_add_u32 m0, s41, 16384
  v_mfma_f32_32x32x16_bf16 v[16:31], v[96:99], v[64:67], v[16:31]
  buffer_load_dwordx4 v104, s[28:31], s39 offen offset:3072 sc1 lds
  s_add_u32 s40, s40, 16384
  s_and_b32 s40, s40, 0x1ffff
  s_or_b32 s40, s40, s12
  s_add_u32 s39, s40, 0x20000
  v_cvt_pk_bf16_f32 v68, v56, v57
  v_exp_f32 v61, v61
  v_cvt_pk_bf16_f32 v69, v58, v59
  v_exp_f32 v62, v62
  v_exp_f32 v63, v63
  v_cvt_pk_bf16_f32 v70, v60, v61
  v_cvt_pk_bf16_f32 v71, v62, v63
  s_setprio 1
  s_waitcnt lgkmcnt(2)
  v_mfma_f32_32x32x16_bf16 v[48:63], v[80:83], v[8:11], 0
  ds_read_b128 v[72:75], v106 offset:40960
  ds_read_b128 v[76:79], v106 offset:41984
  v_exp_f32 v32, v32
  v_exp_f32 v33, v33
  v_exp_f32 v34, v34
  v_exp_f32 v35, v35
  v_exp_f32 v36, v36
  v_mfma_f32_32x32x16_bf16 v[16:31], v[100:103], v[68:71], v[16:31]
  ds_read_b128 v[96:99], v106 offset:38912
  ds_read_b128 v[100:103], v106 offset:39936
  v_cvt_pk_bf16_f32 v64, v32, v33
  v_exp_f32 v37, v37
  v_cvt_pk_bf16_f32 v65, v34, v35
  v_exp_f32 v38, v38
  v_exp_f32 v39, v39
  v_cvt_pk_bf16_f32 v66, v36, v37
  s_add_u32 m0, s41, 32768
  v_mfma_f32_32x32x16_bf16 v[48:63], v[84:87], v[12:15], v[48:63]
  buffer_load_dwordx4 v104, s[28:31], s40 offen offset:0 sc1 lds
  v_exp_f32 v40, v40
  v_cvt_pk_bf16_f32 v67, v38, v39
  v_exp_f32 v41, v41
  v_exp_f32 v42, v42
  v_exp_f32 v43, v43
  v_exp_f32 v44, v44
  v_lshlrev_b32 v2, 4, v1
  s_cmp_eq_u32 s3, 0
  s_cselect_b64 exec, -1, 0
  s_mov_b32 s34, 2392064
  buffer_load_dwordx4 v[108:111], v2, s[28:31], s34 offen sc1
  s_mov_b64 exec, -1
  s_waitcnt lgkmcnt(4)
  s_add_u32 m0, s41, 49152
  v_mfma_f32_32x32x16_bf16 v[16:31], v[88:91], v[64:67], v[16:31]
  buffer_load_dwordx4 v104, s[28:31], s39 offen offset:0 sc1 lds
  v_cvt_pk_bf16_f32 v68, v40, v41
  v_exp_f32 v45, v45
  v_cvt_pk_bf16_f32 v69, v42, v43
  v_exp_f32 v46, v46
  v_exp_f32 v47, v47
  v_cvt_pk_bf16_f32 v70, v44, v45
  v_cvt_pk_bf16_f32 v71, v46, v47
  s_setprio 0
  s_waitcnt lgkmcnt(2)
  v_mfma_f32_32x32x16_bf16 v[32:47], v[72:75], v[8:11], 0
  ds_read_b128 v[80:83], v106 offset:45056
  ds_read_b128 v[84:87], v106 offset:46080
  v_exp_f32 v48, v48
  v_exp_f32 v49, v49
  v_exp_f32 v50, v50
  v_exp_f32 v51, v51
  v_exp_f32 v52, v52
  v_mfma_f32_32x32x16_bf16 v[16:31], v[92:95], v[68:71], v[16:31]
  ds_read_b128 v[88:91], v106 offset:43008
  ds_read_b128 v[92:95], v106 offset:44032
  v_cvt_pk_bf16_f32 v64, v48, v49
  v_exp_f32 v53, v53
  v_cvt_pk_bf16_f32 v65, v50, v51
  v_exp_f32 v54, v54
  v_exp_f32 v55, v55
  v_cvt_pk_bf16_f32 v66, v52, v53
  s_add_u32 m0, s41, 32768
  v_mfma_f32_32x32x16_bf16 v[32:47], v[76:79], v[12:15], v[32:47]
  buffer_load_dwordx4 v104, s[28:31], s40 offen offset:1024 sc1 lds
  v_exp_f32 v56, v56
  v_cvt_pk_bf16_f32 v67, v54, v55
  v_exp_f32 v57, v57
  v_exp_f32 v58, v58
  v_exp_f32 v59, v59
  v_exp_f32 v60, v60
  s_waitcnt lgkmcnt(4)
  s_add_u32 m0, s41, 49152
  v_mfma_f32_32x32x16_bf16 v[16:31], v[96:99], v[64:67], v[16:31]
  buffer_load_dwordx4 v104, s[28:31], s39 offen offset:1024 sc1 lds
  v_cvt_pk_bf16_f32 v68, v56, v57
  v_exp_f32 v61, v61
  v_cvt_pk_bf16_f32 v69, v58, v59
  v_exp_f32 v62, v62
  v_exp_f32 v63, v63
  v_cvt_pk_bf16_f32 v70, v60, v61
  v_cvt_pk_bf16_f32 v71, v62, v63
  s_waitcnt vmcnt(3)
  s_cmp_eq_u32 s3, 0
  s_cselect_b64 exec, -1, 0
  v_xor_b32 v108, s48, v108
  v_xor_b32 v109, s48, v109
  v_xor_b32 v110, s48, v110
  v_xor_b32 v111, s48, v111
  v_or3_b32 v108, v108, v109, v110
  v_or_b32 v108, v108, v111
  v_cmp_ne_u32 vcc, 0, v108
  s_mov_b64 exec, -1
  s_cbranch_vccnz L_pk_fbwait
L_pk_fbok:
  s_barrier
  s_setprio 3
  s_waitcnt lgkmcnt(2)
  v_mfma_f32_32x32x16_bf16 v[48:63], v[80:83], v[8:11], 0
  ds_read_b128 v[72:75], v105 offset:0
  ds_read_b128 v[76:79], v105 offset:1024
  v_exp_f32 v32, v32
  v_exp_f32 v33, v33
  v_exp_f32 v34, v34
  v_exp_f32 v35, v35
  v_exp_f32 v36, v36
  v_mfma_f32_32x32x16_bf16 v[16:31], v[100:103], v[68:71], v[16:31]
  ds_read_b128 v[96:99], v106 offset:47104
  ds_read_b128 v[100:103], v106 offset:48128
  v_cvt_pk_bf16_f32 v64, v32, v33
  v_exp_f32 v37, v37
  v_cvt_pk_bf16_f32 v65, v34, v35
  v_exp_f32 v38, v38
  v_exp_f32 v39, v39
  v_cvt_pk_bf16_f32 v66, v36, v37
  s_add_u32 m0, s41, 32768
  v_mfma_f32_32x32x16_bf16 v[48:63], v[84:87], v[12:15], v[48:63]
  buffer_load_dwordx4 v104, s[28:31], s40 offen offset:2048 sc1 lds
  buffer_load_dwordx4 v[112:115], v104, s[52:55], s45 offen offset:0 sc1
  v_exp_f32 v40, v40
  v_cvt_pk_bf16_f32 v67, v38, v39
  v_exp_f32 v41, v41
  v_exp_f32 v42, v42
  v_exp_f32 v43, v43
  v_exp_f32 v44, v44
  s_waitcnt lgkmcnt(4)
  s_add_u32 m0, s41, 49152
  v_mfma_f32_32x32x16_bf16 v[16:31], v[88:91], v[64:67], v[16:31]
  buffer_load_dwordx4 v104, s[28:31], s39 offen offset:2048 sc1 lds
  buffer_load_dwordx4 v[116:119], v104, s[52:55], s45 offen offset:1024 sc1
  v_cvt_pk_bf16_f32 v68, v40, v41
  v_exp_f32 v45, v45
  v_cvt_pk_bf16_f32 v69, v42, v43
  v_exp_f32 v46, v46
  v_exp_f32 v47, v47
  v_cvt_pk_bf16_f32 v70, v44, v45
  v_cvt_pk_bf16_f32 v71, v46, v47
  s_setprio 2
  s_waitcnt lgkmcnt(2)
  v_mfma_f32_32x32x16_bf16 v[32:47], v[72:75], v[8:11], 0
  ds_read_b128 v[80:83], v105 offset:4096
  ds_read_b128 v[84:87], v105 offset:5120
  v_exp_f32 v48, v48
  v_exp_f32 v49, v49
  v_exp_f32 v50, v50
  v_exp_f32 v51, v51
  v_exp_f32 v52, v52
  v_mfma_f32_32x32x16_bf16 v[16:31], v[92:95], v[68:71], v[16:31]
  ds_read_b128 v[88:91], v105 offset:2048
  ds_read_b128 v[92:95], v105 offset:3072
  v_cvt_pk_bf16_f32 v64, v48, v49
  v_exp_f32 v53, v53
  v_cvt_pk_bf16_f32 v65, v50, v51
  v_exp_f32 v54, v54
  v_exp_f32 v55, v55
  v_cvt_pk_bf16_f32 v66, v52, v53
  s_add_u32 m0, s41, 32768
  v_mfma_f32_32x32x16_bf16 v[32:47], v[76:79], v[12:15], v[32:47]
  buffer_load_dwordx4 v104, s[28:31], s40 offen offset:3072 sc1 lds
  buffer_load_dwordx4 v[120:123], v104, s[52:55], s45 offen offset:2048 sc1
  v_exp_f32 v56, v56
  v_cvt_pk_bf16_f32 v67, v54, v55
  v_exp_f32 v57, v57
  v_exp_f32 v58, v58
  v_exp_f32 v59, v59
  v_exp_f32 v60, v60
L_wm_P5:
  s_cbranch_execz L_wm_P7
  s_waitcnt lgkmcnt(4)
  s_add_u32 m0, s41, 49152
  v_mfma_f32_32x32x16_bf16 v[16:31], v[96:99], v[64:67], v[16:31]
  buffer_load_dwordx4 v104, s[28:31], s39 offen offset:3072 sc1 lds
  s_add_u32 s40, s40, 16384
  s_and_b32 s40, s40, 0x1ffff
  s_or_b32 s40, s40, s12
  s_add_u32 s39, s40, 0x20000
  buffer_load_dwordx4 v[124:127], v104, s[52:55], s45 offen offset:3072 sc1
  v_cvt_pk_bf16_f32 v68, v56, v57
  v_exp_f32 v61, v61
  v_cvt_pk_bf16_f32 v69, v58, v59
  v_exp_f32 v62, v62
  v_exp_f32 v63, v63
  v_cvt_pk_bf16_f32 v70, v60, v61
  v_cvt_pk_bf16_f32 v71, v62, v63
  s_setprio 1
  s_waitcnt lgkmcnt(2)
  v_mfma_f32_32x32x16_bf16 v[48:63], v[80:83], v[8:11], 0
  ds_read_b128 v[72:75], v105 offset:8192
  ds_read_b128 v[76:79], v105 offset:9216
  v_exp_f32 v32, v32
  v_exp_f32 v33, v33
  v_exp_f32 v34, v34
  v_exp_f32 v35, v35
  v_exp_f32 v36, v36
  v_mfma_f32_32x32x16_bf16 v[16:31], v[100:103], v[68:71], v[16:31]
  ds_read_b128 v[96:99], v105 offset:6144
  ds_read_b128 v[100:103], v105 offset:7168
  v_cvt_pk_bf16_f32 v64, v32, v33
  v_exp_f32 v37, v37
  v_cvt_pk_bf16_f32 v65, v34, v35
  v_exp_f32 v38, v38
  v_exp_f32 v39, v39
  v_cvt_pk_bf16_f32 v66, v36, v37
  s_add_u32 m0, s41, 65536
  v_mfma_f32_32x32x16_bf16 v[48:63], v[84:87], v[12:15], v[48:63]
  buffer_load_dwordx4 v104, s[28:31], s40 offen offset:0 sc1 lds
  s_add_u32 s45, s45, 4096
  buffer_load_dwordx4 v[128:131], v104, s[52:55], s45 offen offset:0 sc1
  v_exp_f32 v40, v40
  v_cvt_pk_bf16_f32 v67, v38, v39
  v_exp_f32 v41, v41
  v_exp_f32 v42, v42
  v_exp_f32 v43, v43
  v_exp_f32 v44, v44
  s_waitcnt lgkmcnt(4)
  s_add_u32 m0, s41, 81920
  v_mfma_f32_32x32x16_bf16 v[16:31], v[88:91], v[64:67], v[16:31]
  buffer_load_dwordx4 v104, s[28:31], s39 offen offset:0 sc1 lds
  v_cvt_pk_bf16_f32 v68, v40, v41
  v_exp_f32 v45, v45
  v_cvt_pk_bf16_f32 v69, v42, v43
  v_exp_f32 v46, v46
  v_exp_f32 v47, v47
  v_cvt_pk_bf16_f32 v70, v44, v45
  v_cvt_pk_bf16_f32 v71, v46, v47
  s_setprio 0
  s_waitcnt lgkmcnt(2)
  v_mfma_f32_32x32x16_bf16 v[32:47], v[72:75], v[8:11], 0
  ds_read_b128 v[80:83], v105 offset:12288
  ds_read_b128 v[84:87], v105 offset:13312
  v_exp_f32 v48, v48
  v_exp_f32 v49, v49
  v_exp_f32 v50, v50
  v_exp_f32 v51, v51
  v_exp_f32 v52, v52
  v_mfma_f32_32x32x16_bf16 v[16:31], v[92:95], v[68:71], v[16:31]
  ds_read_b128 v[88:91], v105 offset:10240
  ds_read_b128 v[92:95], v105 offset:11264
  v_cvt_pk_bf16_f32 v64, v48, v49
  v_exp_f32 v53, v53
  v_cvt_pk_bf16_f32 v65, v50, v51
  v_exp_f32 v54, v54
  v_exp_f32 v55, v55
  v_cvt_pk_bf16_f32 v66, v52, v53
  s_add_u32 m0, s41, 65536
  v_mfma_f32_32x32x16_bf16 v[32:47], v[76:79], v[12:15], v[32:47]
  buffer_load_dwordx4 v104, s[28:31], s40 offen offset:1024 sc1 lds
  buffer_load_dwordx4 v[132:135], v104, s[52:55], s45 offen offset:1024 sc1
  v_exp_f32 v56, v56
  v_cvt_pk_bf16_f32 v67, v54, v55
  v_exp_f32 v57, v57
  v_exp_f32 v58, v58
  v_exp_f32 v59, v59
  v_exp_f32 v60, v60
  s_waitcnt lgkmcnt(4)
  s_add_u32 m0, s41, 81920
  v_mfma_f32_32x32x16_bf16 v[16:31], v[96:99], v[64:67], v[16:31]
  buffer_load_dwordx4 v104, s[28:31], s39 offen offset:1024 sc1 lds
  buffer_load_dwordx4 v[136:139], v104, s[52:55], s45 offen offset:2048 sc1
  v_cvt_pk_bf16_f32 v68, v56, v57
  v_exp_f32 v61, v61
  v_cvt_pk_bf16_f32 v69, v58, v59
  v_exp_f32 v62, v62
  v_exp_f32 v63, v63
  v_cvt_pk_bf16_f32 v70, v60, v61
  v_cvt_pk_bf16_f32 v71, v62, v63
  s_waitcnt vmcnt(8)
  s_barrier
  s_setprio 3
  s_waitcnt lgkmcnt(2)
  v_mfma_f32_32x32x16_bf16 v[48:63], v[80:83], v[8:11], 0
  ds_read_b128 v[72:75], v105 offset:32768
  ds_read_b128 v[76:79], v105 offset:33792
  v_exp_f32 v32, v32
  v_exp_f32 v33, v33
  v_exp_f32 v34, v34
  v_exp_f32 v35, v35
  v_exp_f32 v36, v36
  v_mfma_f32_32x32x16_bf16 v[16:31], v[100:103], v[68:71], v[16:31]
  ds_read_b128 v[96:99], v105 offset:14336
  ds_read_b128 v[100:103], v105 offset:15360
  v_cvt_pk_bf16_f32 v64, v32, v33
  v_exp_f32 v37, v37
  v_cvt_pk_bf16_f32 v65, v34, v35
  v_exp_f32 v38, v38
  v_exp_f32 v39, v39
  v_cvt_pk_bf16_f32 v66, v36, v37
  s_add_u32 m0, s41, 65536
  v_mfma_f32_32x32x16_bf16 v[48:63], v[84:87], v[12:15], v[48:63]
  buffer_load_dwordx4 v104, s[28:31], s40 offen offset:2048 sc1 lds
  buffer_load_dwordx4 v[140:143], v104, s[52:55], s45 offen offset:3072 sc1
  v_exp_f32 v40, v40
  v_cvt_pk_bf16_f32 v67, v38, v39
  v_exp_f32 v41, v41
  v_exp_f32 v42, v42
  v_exp_f32 v43, v43
  v_exp_f32 v44, v44
  s_waitcnt lgkmcnt(4)
  s_add_u32 m0, s41, 81920
  v_mfma_f32_32x32x16_bf16 v[16:31], v[88:91], v[64:67], v[16:31]
  buffer_load_dwordx4 v104, s[28:31], s39 offen offset:2048 sc1 lds
  v_cvt_pk_bf16_f32 v68, v40, v41
  v_exp_f32 v45, v45
  v_cvt_pk_bf16_f32 v69, v42, v43
  v_exp_f32 v46, v46
  v_exp_f32 v47, v47
  v_cvt_pk_bf16_f32 v70, v44, v45
  v_cvt_pk_bf16_f32 v71, v46, v47
  s_setprio 2
  s_waitcnt lgkmcnt(2)
  v_mfma_f32_32x32x16_bf16 v[32:47], v[72:75], v[8:11], 0
  ds_read_b128 v[80:83], v105 offset:36864
  ds_read_b128 v[84:87], v105 offset:37888
  v_exp_f32 v48, v48
  v_exp_f32 v49, v49
  v_exp_f32 v50, v50
  v_exp_f32 v51, v51
  v_exp_f32 v52, v52
  v_mfma_f32_32x32x16_bf16 v[16:31], v[92:95], v[68:71], v[16:31]
  ds_read_b128 v[88:91], v105 offset:34816
  ds_read_b128 v[92:95], v105 offset:35840
  v_cvt_pk_bf16_f32 v64, v48, v49
  v_exp_f32 v53, v53
  v_cvt_pk_bf16_f32 v65, v50, v51
  v_exp_f32 v54, v54
  v_exp_f32 v55, v55
  v_cvt_pk_bf16_f32 v66, v52, v53
  s_add_u32 m0, s41, 65536
  v_mfma_f32_32x32x16_bf16 v[32:47], v[76:79], v[12:15], v[32:47]
  buffer_load_dwordx4 v104, s[28:31], s40 offen offset:3072 sc1 lds
  s_add_u32 s45, s45, 4096
  buffer_load_dwordx4 v[144:147], v104, s[52:55], s45 offen offset:0 sc1
  v_exp_f32 v56, v56
  v_cvt_pk_bf16_f32 v67, v54, v55
  v_exp_f32 v57, v57
  v_exp_f32 v58, v58
  v_exp_f32 v59, v59
  v_exp_f32 v60, v60
  s_waitcnt lgkmcnt(4)
  s_add_u32 m0, s41, 81920
  v_mfma_f32_32x32x16_bf16 v[16:31], v[96:99], v[64:67], v[16:31]
  buffer_load_dwordx4 v104, s[28:31], s39 offen offset:3072 sc1 lds
  s_add_u32 s40, s40, 16384
  s_and_b32 s40, s40, 0x1ffff
  s_or_b32 s40, s40, s12
  s_add_u32 s39, s40, 0x20000
  buffer_load_dwordx4 v[148:151], v104, s[52:55], s45 offen offset:1024 sc1
  v_cvt_pk_bf16_f32 v68, v56, v57
  v_exp_f32 v61, v61
  v_cvt_pk_bf16_f32 v69, v58, v59
  v_exp_f32 v62, v62
  v_exp_f32 v63, v63
  v_cvt_pk_bf16_f32 v70, v60, v61
  v_cvt_pk_bf16_f32 v71, v62, v63
  s_setprio 1
  s_waitcnt lgkmcnt(2)
  v_mfma_f32_32x32x16_bf16 v[48:63], v[80:83], v[8:11], 0
  ds_read_b128 v[72:75], v105 offset:40960
  ds_read_b128 v[76:79], v105 offset:41984
  v_exp_f32 v32, v32
  v_exp_f32 v33, v33
  v_exp_f32 v34, v34
  v_exp_f32 v35, v35
  v_exp_f32 v36, v36
  v_mfma_f32_32x32x16_bf16 v[16:31], v[100:103], v[68:71], v[16:31]
  ds_read_b128 v[96:99], v105 offset:38912
  ds_read_b128 v[100:103], v105 offset:39936
  v_cvt_pk_bf16_f32 v64, v32, v33
  v_exp_f32 v37, v37
  v_cvt_pk_bf16_f32 v65, v34, v35
  v_exp_f32 v38, v38
  v_exp_f32 v39, v39
  v_cvt_pk_bf16_f32 v66, v36, v37
  s_add_u32 m0, s41, 98304
  v_mfma_f32_32x32x16_bf16 v[48:63], v[84:87], v[12:15], v[48:63]
  buffer_load_dwordx4 v104, s[28:31], s40 offen offset:0 sc1 lds
  buffer_load_dwordx4 v[152:155], v104, s[52:55], s45 offen offset:2048 sc1
  v_exp_f32 v40, v40
  v_cvt_pk_bf16_f32 v67, v38, v39
  v_exp_f32 v41, v41
  v_exp_f32 v42, v42
  v_exp_f32 v43, v43
  v_exp_f32 v44, v44
  s_waitcnt lgkmcnt(4)
  s_add_u32 m0, s41, 114688
  v_mfma_f32_32x32x16_bf16 v[16:31], v[88:91], v[64:67], v[16:31]
  buffer_load_dwordx4 v104, s[28:31], s39 offen offset:0 sc1 lds
  v_cvt_pk_bf16_f32 v68, v40, v41
  v_exp_f32 v45, v45
  v_cvt_pk_bf16_f32 v69, v42, v43
  v_exp_f32 v46, v46
  v_exp_f32 v47, v47
  v_cvt_pk_bf16_f32 v70, v44, v45
  v_cvt_pk_bf16_f32 v71, v46, v47
  s_setprio 0
  s_waitcnt lgkmcnt(2)
  v_mfma_f32_32x32x16_bf16 v[32:47], v[72:75], v[8:11], 0
  ds_read_b128 v[80:83], v105 offset:45056
  ds_read_b128 v[84:87], v105 offset:46080
  v_exp_f32 v48, v48
  v_exp_f32 v49, v49
  v_exp_f32 v50, v50
  v_exp_f32 v51, v51
  v_exp_f32 v52, v52
  v_mfma_f32_32x32x16_bf16 v[16:31], v[92:95], v[68:71], v[16:31]
  ds_read_b128 v[88:91], v105 offset:43008
  ds_read_b128 v[92:95], v105 offset:44032
  v_cvt_pk_bf16_f32 v64, v48, v49
  v_exp_f32 v53, v53
  v_cvt_pk_bf16_f32 v65, v50, v51
  v_exp_f32 v54, v54
  v_exp_f32 v55, v55
  v_cvt_pk_bf16_f32 v66, v52, v53
  s_add_u32 m0, s41, 98304
  v_mfma_f32_32x32x16_bf16 v[32:47], v[76:79], v[12:15], v[32:47]
  buffer_load_dwordx4 v104, s[28:31], s40 offen offset:1024 sc1 lds
  buffer_load_dwordx4 v[156:159], v104, s[52:55], s45 offen offset:3072 sc1
  v_exp_f32 v56, v56
  v_cvt_pk_bf16_f32 v67, v54, v55
  v_exp_f32 v57, v57
  v_exp_f32 v58, v58
  v_exp_f32 v59, v59
  v_exp_f32 v60, v60
  s_waitcnt lgkmcnt(4)
  s_add_u32 m0, s41, 114688
  v_mfma_f32_32x32x16_bf16 v[16:31], v[96:99], v[64:67], v[16:31]
  buffer_load_dwordx4 v104, s[28:31], s39 offen offset:1024 sc1 lds
  s_add_u32 s45, s45, 4096
  buffer_load_dwordx4 v[160:163], v104, s[52:55], s45 offen offset:0 sc1
  v_cvt_pk_bf16_f32 v68, v56, v57
  v_exp_f32 v61, v61
  v_cvt_pk_bf16_f32 v69, v58, v59
  v_exp_f32 v62, v62
  v_exp_f32 v63, v63
  v_cvt_pk_bf16_f32 v70, v60, v61
  v_cvt_pk_bf16_f32 v71, v62, v63
  s_waitcnt vmcnt(8)
  s_barrier
  s_setprio 3
  s_waitcnt lgkmcnt(2)
  v_mfma_f32_32x32x16_bf16 v[48:63], v[80:83], v[8:11], 0
  ds_read_b128 v[72:75], v106 offset:0
  ds_read_b128 v[76:79], v106 offset:1024
  v_exp_f32 v32, v32
  v_exp_f32 v33, v33
  v_exp_f32 v34, v34
  v_exp_f32 v35, v35
  v_exp_f32 v36, v36
  v_mfma_f32_32x32x16_bf16 v[16:31], v[100:103], v[68:71], v[16:31]
  ds_read_b128 v[96:99], v105 offset:47104
  ds_read_b128 v[100:103], v105 offset:48128
  v_cvt_pk_bf16_f32 v64, v32, v33
  v_exp_f32 v37, v37
  v_cvt_pk_bf16_f32 v65, v34, v35
  v_exp_f32 v38, v38
  v_exp_f32 v39, v39
  v_cvt_pk_bf16_f32 v66, v36, v37
  s_add_u32 m0, s41, 98304
  v_mfma_f32_32x32x16_bf16 v[48:63], v[84:87], v[12:15], v[48:63]
  buffer_load_dwordx4 v104, s[28:31], s40 offen offset:2048 sc1 lds
  buffer_load_dwordx4 v[164:167], v104, s[52:55], s45 offen offset:1024 sc1
  v_exp_f32 v40, v40
  v_cvt_pk_bf16_f32 v67, v38, v39
  v_exp_f32 v41, v41
  v_exp_f32 v42, v42
  v_exp_f32 v43, v43
  v_exp_f32 v44, v44
  s_waitcnt lgkmcnt(4)
  s_add_u32 m0, s41, 114688
  v_mfma_f32_32x32x16_bf16 v[16:31], v[88:91], v[64:67], v[16:31]
  buffer_load_dwordx4 v104, s[28:31], s39 offen offset:2048 sc1 lds
  v_cvt_pk_bf16_f32 v68, v40, v41
  v_exp_f32 v45, v45
  v_cvt_pk_bf16_f32 v69, v42, v43
  v_exp_f32 v46, v46
  v_exp_f32 v47, v47
  v_cvt_pk_bf16_f32 v70, v44, v45
  v_cvt_pk_bf16_f32 v71, v46, v47
  s_setprio 2
  s_waitcnt lgkmcnt(2)
  v_mfma_f32_32x32x16_bf16 v[32:47], v[72:75], v[8:11], 0
  ds_read_b128 v[80:83], v106 offset:4096
  ds_read_b128 v[84:87], v106 offset:5120
  v_exp_f32 v48, v48
  v_exp_f32 v49, v49
  v_exp_f32 v50, v50
  v_exp_f32 v51, v51
  v_exp_f32 v52, v52
  v_mfma_f32_32x32x16_bf16 v[16:31], v[92:95], v[68:71], v[16:31]
  ds_read_b128 v[88:91], v106 offset:2048
  ds_read_b128 v[92:95], v106 offset:3072
  v_cvt_pk_bf16_f32 v64, v48, v49
  v_exp_f32 v53, v53
  v_cvt_pk_bf16_f32 v65, v50, v51
  v_exp_f32 v54, v54
  v_exp_f32 v55, v55
  v_cvt_pk_bf16_f32 v66, v52, v53
  s_add_u32 m0, s41, 98304
  v_mfma_f32_32x32x16_bf16 v[32:47], v[76:79], v[12:15], v[32:47]
  buffer_load_dwordx4 v104, s[28:31], s40 offen offset:3072 sc1 lds
  buffer_load_dwordx4 v[168:171], v104, s[52:55], s45 offen offset:2048 sc1
  v_exp_f32 v56, v56
  v_cvt_pk_bf16_f32 v67, v54, v55
  v_exp_f32 v57, v57
  v_exp_f32 v58, v58
  v_exp_f32 v59, v59
  v_exp_f32 v60, v60
  s_waitcnt lgkmcnt(4)
  s_add_u32 m0, s41, 114688
  v_mfma_f32_32x32x16_bf16 v[16:31], v[96:99], v[64:67], v[16:31]
  buffer_load_dwordx4 v104, s[28:31], s39 offen offset:3072 sc1 lds
  buffer_load_dwordx4 v[172:175], v104, s[52:55], s45 offen offset:3072 sc1
  v_cvt_pk_bf16_f32 v68, v56, v57
  v_exp_f32 v61, v61
  v_cvt_pk_bf16_f32 v69, v58, v59
  v_exp_f32 v62, v62
  v_exp_f32 v63, v63
  v_cvt_pk_bf16_f32 v70, v60, v61
  v_cvt_pk_bf16_f32 v71, v62, v63
  s_setprio 1
  s_waitcnt lgkmcnt(2)
  v_mfma_f32_32x32x16_bf16 v[48:63], v[80:83], v[8:11], 0
  ds_read_b128 v[72:75], v106 offset:8192
  ds_read_b128 v[76:79], v106 offset:9216
  v_exp_f32 v32, v32
  v_exp_f32 v33, v33
  v_exp_f32 v34, v34
  v_exp_f32 v35, v35
  v_exp_f32 v36, v36
  v_mfma_f32_32x32x16_bf16 v[16:31], v[100:103], v[68:71], v[16:31]
  ds_read_b128 v[96:99], v106 offset:6144
  ds_read_b128 v[100:103], v106 offset:7168
  v_cvt_pk_bf16_f32 v64, v32, v33
  v_exp_f32 v37, v37
  v_cvt_pk_bf16_f32 v65, v34, v35
  v_exp_f32 v38, v38
  v_exp_f32 v39, v39
  v_cvt_pk_bf16_f32 v66, v36, v37
  s_add_u32 m0, s13, 0
  s_add_u32 s34, s22, 0
  v_mfma_f32_32x32x16_bf16 v[48:63], v[84:87], v[12:15], v[48:63]
  buffer_load_dwordx4 v104, s[28:31], s34 offen offset:0 sc1 lds
  s_add_u32 s45, s45, 4096
  buffer_load_dwordx4 v[176:179], v104, s[52:55], s45 offen offset:0 sc1
  v_exp_f32 v40, v40
  v_cvt_pk_bf16_f32 v67, v38, v39
  v_exp_f32 v41, v41
  v_exp_f32 v42, v42
  v_exp_f32 v43, v43
  v_exp_f32 v44, v44
  s_waitcnt lgkmcnt(4)
  s_add_u32 m0, s13, 0
  s_add_u32 s34, s22, 0
  v_mfma_f32_32x32x16_bf16 v[16:31], v[88:91], v[64:67], v[16:31]
  buffer_load_dwordx4 v104, s[28:31], s34 offen offset:1024 sc1 lds
  buffer_load_dwordx4 v[180:183], v104, s[52:55], s45 offen offset:1024 sc1
  v_cvt_pk_bf16_f32 v68, v40, v41
  v_exp_f32 v45, v45
  v_cvt_pk_bf16_f32 v69, v42, v43
  v_exp_f32 v46, v46
  v_exp_f32 v47, v47
  v_cvt_pk_bf16_f32 v70, v44, v45
  v_cvt_pk_bf16_f32 v71, v46, v47
  s_setprio 0
  s_waitcnt lgkmcnt(2)
  v_mfma_f32_32x32x16_bf16 v[32:47], v[72:75], v[8:11], 0
  ds_read_b128 v[80:83], v106 offset:12288
  ds_read_b128 v[84:87], v106 offset:13312
  v_exp_f32 v48, v48
  v_exp_f32 v49, v49
  v_exp_f32 v50, v50
  v_exp_f32 v51, v51
  v_exp_f32 v52, v52
  v_mfma_f32_32x32x16_bf16 v[16:31], v[92:95], v[68:71], v[16:31]
  ds_read_b128 v[88:91], v106 offset:10240
  ds_read_b128 v[92:95], v106 offset:11264
  v_cvt_pk_bf16_f32 v64, v48, v49
  v_exp_f32 v53, v53
  v_cvt_pk_bf16_f32 v65, v50, v51
  v_exp_f32 v54, v54
  v_exp_f32 v55, v55
  v_cvt_pk_bf16_f32 v66, v52, v53
  s_add_u32 m0, s13, 0
  s_add_u32 s34, s22, 0
  v_mfma_f32_32x32x16_bf16 v[32:47], v[76:79], v[12:15], v[32:47]
  buffer_load_dwordx4 v104, s[28:31], s34 offen offset:2048 sc1 lds
  buffer_load_dwordx4 v[184:187], v104, s[52:55], s45 offen offset:2048 sc1
  v_exp_f32 v56, v56
  v_cvt_pk_bf16_f32 v67, v54, v55
  v_exp_f32 v57, v57
  v_exp_f32 v58, v58
  v_exp_f32 v59, v59
  v_exp_f32 v60, v60
  s_waitcnt lgkmcnt(4)
  s_add_u32 m0, s13, 0
  s_add_u32 s34, s22, 0
  v_mfma_f32_32x32x16_bf16 v[16:31], v[96:99], v[64:67], v[16:31]
  buffer_load_dwordx4 v104, s[28:31], s34 offen offset:3072 sc1 lds
  v_cvt_pk_bf16_f32 v68, v56, v57
  v_exp_f32 v61, v61
  v_cvt_pk_bf16_f32 v69, v58, v59
  v_exp_f32 v62, v62
  v_exp_f32 v63, v63
  v_cvt_pk_bf16_f32 v70, v60, v61
  v_cvt_pk_bf16_f32 v71, v62, v63
  s_waitcnt vmcnt(8)
  s_barrier
  s_setprio 2
  s_waitcnt lgkmcnt(2)
  v_mfma_f32_32x32x16_bf16 v[48:63], v[80:83], v[8:11], 0
  ds_read_b128 v[72:75], v106 offset:32768
  ds_read_b128 v[76:79], v106 offset:33792
  v_exp_f32 v32, v32
  v_exp_f32 v33, v33
  v_exp_f32 v34, v34
  v_exp_f32 v35, v35
  v_exp_f32 v36, v36
  v_mfma_f32_32x32x16_bf16 v[16:31], v[100:103], v[68:71], v[16:31]
  ds_read_b128 v[96:99], v106 offset:14336
  ds_read_b128 v[100:103], v106 offset:15360
  v_cvt_pk_bf16_f32 v64, v32, v33
  v_exp_f32 v37, v37
  v_cvt_pk_bf16_f32 v65, v34, v35
  v_exp_f32 v38, v38
  v_exp_f32 v39, v39
  v_cvt_pk_bf16_f32 v66, v36, v37
  s_add_u32 m0, s13, 4096
  s_add_u32 s34, s22, 4096
  v_mfma_f32_32x32x16_bf16 v[48:63], v[84:87], v[12:15], v[48:63]
  buffer_load_dwordx4 v104, s[28:31], s34 offen offset:0 sc1 lds
  buffer_load_dwordx4 v[188:191], v104, s[52:55], s45 offen offset:3072 sc1
  v_exp_f32 v40, v40
  v_cvt_pk_bf16_f32 v67, v38, v39
  v_exp_f32 v41, v41
  v_exp_f32 v42, v42
  v_exp_f32 v43, v43
  v_exp_f32 v44, v44
  s_waitcnt lgkmcnt(4)
  s_add_u32 m0, s13, 4096
  s_add_u32 s34, s22, 4096
  v_mfma_f32_32x32x16_bf16 v[16:31], v[88:91], v[64:67], v[16:31]
  buffer_load_dwordx4 v104, s[28:31], s34 offen offset:1024 sc1 lds
  s_add_u32 s45, s45, 4096
  buffer_load_dwordx4 v[192:195], v104, s[52:55], s45 offen offset:0 sc1
  v_cvt_pk_bf16_f32 v68, v40, v41
  v_exp_f32 v45, v45
  v_cvt_pk_bf16_f32 v69, v42, v43
  v_exp_f32 v46, v46
  v_exp_f32 v47, v47
  v_cvt_pk_bf16_f32 v70, v44, v45
  v_cvt_pk_bf16_f32 v71, v46, v47
  s_setprio 1
  s_waitcnt lgkmcnt(2)
  v_mfma_f32_32x32x16_bf16 v[32:47], v[72:75], v[8:11], 0
  ds_read_b128 v[80:83], v106 offset:36864
  ds_read_b128 v[84:87], v106 offset:37888
  v_exp_f32 v48, v48
  v_exp_f32 v49, v49
  v_exp_f32 v50, v50
  v_exp_f32 v51, v51
  v_exp_f32 v52, v52
  v_mfma_f32_32x32x16_bf16 v[16:31], v[92:95], v[68:71], v[16:31]
  ds_read_b128 v[88:91], v106 offset:34816
  ds_read_b128 v[92:95], v106 offset:35840
  v_cvt_pk_bf16_f32 v64, v48, v49
  v_exp_f32 v53, v53
  v_cvt_pk_bf16_f32 v65, v50, v51
  v_exp_f32 v54, v54
  v_exp_f32 v55, v55
  v_cvt_pk_bf16_f32 v66, v52, v53
  s_add_u32 m0, s13, 4096
  s_add_u32 s34, s22, 4096
  v_mfma_f32_32x32x16_bf16 v[32:47], v[76:79], v[12:15], v[32:47]
  buffer_load_dwordx4 v104, s[28:31], s34 offen offset:2048 sc1 lds
  buffer_load_dwordx4 v[196:199], v104, s[52:55], s45 offen offset:1024 sc1
  v_exp_f32 v56, v56
  v_cvt_pk_bf16_f32 v67, v54, v55
  v_exp_f32 v57, v57
  v_exp_f32 v58, v58
  v_exp_f32 v59, v59
  v_exp_f32 v60, v60
  s_waitcnt lgkmcnt(4)
  v_mfma_f32_32x32x16_bf16 v[16:31], v[96:99], v[64:67], v[16:31]
  v_cvt_pk_bf16_f32 v68, v56, v57
  v_exp_f32 v61, v61
  v_cvt_pk_bf16_f32 v69, v58, v59
  v_exp_f32 v62, v62
  v_exp_f32 v63, v63
  v_cvt_pk_bf16_f32 v70, v60, v61
  v_cvt_pk_bf16_f32 v71, v62, v63
  s_setprio 1
  s_waitcnt lgkmcnt(2)
  v_mfma_f32_32x32x16_bf16 v[48:63], v[80:83], v[8:11], 0
  ds_read_b128 v[72:75], v106 offset:40960
  ds_read_b128 v[76:79], v106 offset:41984
  v_exp_f32 v32, v32
  v_exp_f32 v33, v33
  v_exp_f32 v34, v34
  v_exp_f32 v35, v35
  v_exp_f32 v36, v36
  v_mfma_f32_32x32x16_bf16 v[16:31], v[100:103], v[68:71], v[16:31]
  ds_read_b128 v[96:99], v106 offset:38912
  ds_read_b128 v[100:103], v106 offset:39936
  v_cvt_pk_bf16_f32 v64, v32, v33
  v_exp_f32 v37, v37
  v_cvt_pk_bf16_f32 v65, v34, v35
  v_exp_f32 v38, v38
  v_exp_f32 v39, v39
  v_cvt_pk_bf16_f32 v66, v36, v37
  s_add_u32 m0, s13, 28672
  s_add_u32 s34, s22, 28672
  v_mfma_f32_32x32x16_bf16 v[48:63], v[84:87], v[12:15], v[48:63]
  buffer_load_dwordx4 v104, s[28:31], s34 offen offset:0 sc1 lds
  buffer_load_dwordx4 v[200:203], v104, s[52:55], s45 offen offset:2048 sc1
  v_exp_f32 v40, v40
  v_cvt_pk_bf16_f32 v67, v38, v39
  v_exp_f32 v41, v41
  v_exp_f32 v42, v42
  v_exp_f32 v43, v43
  v_exp_f32 v44, v44
  s_waitcnt lgkmcnt(4)
  s_add_u32 m0, s13, 28672
  s_add_u32 s34, s22, 28672
  v_mfma_f32_32x32x16_bf16 v[16:31], v[88:91], v[64:67], v[16:31]
  buffer_load_dwordx4 v104, s[28:31], s34 offen offset:1024 sc1 lds
  buffer_load_dwordx4 v[204:207], v104, s[52:55], s45 offen offset:3072 sc1
  v_cvt_pk_bf16_f32 v68, v40, v41
  v_exp_f32 v45, v45
  v_cvt_pk_bf16_f32 v69, v42, v43
  v_exp_f32 v46, v46
  v_exp_f32 v47, v47
  v_cvt_pk_bf16_f32 v70, v44, v45
  v_cvt_pk_bf16_f32 v71, v46, v47
  s_setprio 0
  s_waitcnt lgkmcnt(2)
  v_mfma_f32_32x32x16_bf16 v[32:47], v[72:75], v[8:11], 0
  ds_read_b128 v[80:83], v106 offset:45056
  ds_read_b128 v[84:87], v106 offset:46080
  v_exp_f32 v48, v48
  v_exp_f32 v49, v49
  v_exp_f32 v50, v50
  v_exp_f32 v51, v51
  v_exp_f32 v52, v52
  v_mfma_f32_32x32x16_bf16 v[16:31], v[92:95], v[68:71], v[16:31]
  ds_read_b128 v[88:91], v106 offset:43008
  ds_read_b128 v[92:95], v106 offset:44032
  v_cvt_pk_bf16_f32 v64, v48, v49
  v_exp_f32 v53, v53
  v_cvt_pk_bf16_f32 v65, v50, v51
  v_exp_f32 v54, v54
  v_exp_f32 v55, v55
  v_cvt_pk_bf16_f32 v66, v52, v53
  s_add_u32 m0, s13, 28672
  s_add_u32 s34, s22, 28672
  v_mfma_f32_32x32x16_bf16 v[32:47], v[76:79], v[12:15], v[32:47]
  buffer_load_dwordx4 v104, s[28:31], s34 offen offset:2048 sc1 lds
  s_add_u32 s45, s45, 4096
  buffer_load_dwordx4 v[208:211], v104, s[52:55], s45 offen offset:0 sc1
  v_exp_f32 v56, v56
  v_cvt_pk_bf16_f32 v67, v54, v55
  v_exp_f32 v57, v57
  v_exp_f32 v58, v58
  v_exp_f32 v59, v59
  v_exp_f32 v60, v60
  s_waitcnt lgkmcnt(4)
  s_add_u32 m0, s13, 28672
  s_add_u32 s34, s22, 28672
  v_mfma_f32_32x32x16_bf16 v[16:31], v[96:99], v[64:67], v[16:31]
  buffer_load_dwordx4 v104, s[28:31], s34 offen offset:3072 sc1 lds
  v_cvt_pk_bf16_f32 v68, v56, v57
  v_exp_f32 v61, v61
  v_cvt_pk_bf16_f32 v69, v58, v59
  v_exp_f32 v62, v62
  v_exp_f32 v63, v63
  v_cvt_pk_bf16_f32 v70, v60, v61
  v_cvt_pk_bf16_f32 v71, v62, v63
  s_setprio 0
  s_waitcnt lgkmcnt(2)
  v_mfma_f32_32x32x16_bf16 v[48:63], v[80:83], v[8:11], 0
  v_exp_f32 v32, v32
  v_exp_f32 v33, v33
  v_exp_f32 v34, v34
  v_exp_f32 v35, v35
  v_exp_f32 v36, v36
  v_mfma_f32_32x32x16_bf16 v[16:31], v[100:103], v[68:71], v[16:31]
  ds_read_b128 v[96:99], v106 offset:47104
  ds_read_b128 v[100:103], v106 offset:48128
  v_cvt_pk_bf16_f32 v64, v32, v33
  v_exp_f32 v37, v37
  v_cvt_pk_bf16_f32 v65, v34, v35
  v_exp_f32 v38, v38
  v_exp_f32 v39, v39
  v_cvt_pk_bf16_f32 v66, v36, v37
  s_add_u32 m0, s13, 32768
  s_add_u32 s34, s22, 32768
  v_mfma_f32_32x32x16_bf16 v[48:63], v[84:87], v[12:15], v[48:63]
  buffer_load_dwordx4 v104, s[28:31], s34 offen offset:0 sc1 lds
  buffer_load_dwordx4 v[212:215], v104, s[52:55], s45 offen offset:1024 sc1
  v_exp_f32 v40, v40
  v_cvt_pk_bf16_f32 v67, v38, v39
  v_exp_f32 v41, v41
  v_exp_f32 v42, v42
  v_exp_f32 v43, v43
  v_exp_f32 v44, v44
  s_waitcnt lgkmcnt(2)
  s_add_u32 m0, s13, 32768
  s_add_u32 s34, s22, 32768
  v_mfma_f32_32x32x16_bf16 v[16:31], v[88:91], v[64:67], v[16:31]
  buffer_load_dwordx4 v104, s[28:31], s34 offen offset:1024 sc1 lds
  buffer_load_dwordx4 v[216:219], v104, s[52:55], s45 offen offset:2048 sc1
  v_cvt_pk_bf16_f32 v68, v40, v41
  v_exp_f32 v45, v45
  v_cvt_pk_bf16_f32 v69, v42, v43
  v_exp_f32 v46, v46
  v_exp_f32 v47, v47
  v_cvt_pk_bf16_f32 v70, v44, v45
  v_cvt_pk_bf16_f32 v71, v46, v47
  s_setprio 0
  v_exp_f32 v48, v48
  v_exp_f32 v49, v49
  v_exp_f32 v50, v50
  v_exp_f32 v51, v51
  v_exp_f32 v52, v52
  v_mfma_f32_32x32x16_bf16 v[16:31], v[92:95], v[68:71], v[16:31]
  v_cvt_pk_bf16_f32 v64, v48, v49
  v_exp_f32 v53, v53
  v_cvt_pk_bf16_f32 v65, v50, v51
  v_exp_f32 v54, v54
  v_exp_f32 v55, v55
  v_cvt_pk_bf16_f32 v66, v52, v53
  s_add_u32 m0, s13, 32768
  s_add_u32 s34, s22, 32768
  s_nop 0
  buffer_load_dwordx4 v104, s[28:31], s34 offen offset:2048 sc1 lds
  buffer_load_dwordx4 v[220:223], v104, s[52:55], s45 offen offset:3072 sc1
  v_exp_f32 v56, v56
  v_cvt_pk_bf16_f32 v67, v54, v55
  v_exp_f32 v57, v57
L_wm_P6:
  s_cbranch_execz L_wm_L_pk_idle7
  v_exp_f32 v58, v58
  v_exp_f32 v59, v59
  v_exp_f32 v60, v60
  s_waitcnt lgkmcnt(0)
  v_mfma_f32_32x32x16_bf16 v[16:31], v[96:99], v[64:67], v[16:31]
  v_cvt_pk_bf16_f32 v68, v56, v57
  v_exp_f32 v61, v61
  v_cvt_pk_bf16_f32 v69, v58, v59
  v_exp_f32 v62, v62
  v_exp_f32 v63, v63
  v_cvt_pk_bf16_f32 v70, v60, v61
  v_cvt_pk_bf16_f32 v71, v62, v63
  s_setprio 3
  s_nop 0
  v_mfma_f32_32x32x16_bf16 v[16:31], v[100:103], v[68:71], v[16:31]
  buffer_load_ushort v4, v234, s[4:7], 0 offen
  buffer_load_dwordx4 v[224:227], v232, s[16:19], 0 offen
  buffer_load_dwordx4 v[228:231], v233, s[16:19], 0 offen
L_pk_join0:
  v_and_b32 v2, 31, v1
  s_lshl_b32 s34, s3, 8
  s_add_u32 s34, s34, 157696
  v_lshl_add_u32 v3, v2, 3, s34
  s_lshl_b32 s34, s3, 11
  s_add_u32 s34, s34, 131072
  v_add_u32 v106, s34, v104
  s_bfe_u32 s35, s3, 0x10001
  s_lshl_b32 s35, s35, 9
  s_and_b32 s36, s3, 1
  s_nop 2
  v_mov_b32 v108, v28
  v_mov_b32 v109, v28
  ds_write_b128 v106, v[24:27]
  ds_write_b128 v106, v[28:31] offset:1024
  v_permlane32_swap_b32 v108, v109
  s_nop 0
  v_mov_b32 v108, v107
  ds_write_b64 v3, v[108:109]
  v_xor_b32 v3, 1024, v3
  v_xor_b32 v106, 8192, v106
  v_lshrrev_b32 v107, 5, v1
  v_lshlrev_b32 v107, 10, v107
  v_lshl_add_u32 v107, v2, 4, v107
  s_lshl_b32 s36, s36, 11
  s_add_u32 s35, s35, s36
  v_mov_b32 v105, v107
  s_lshl_b32 s36, s43, 14
  s_add_u32 s36, s36, 23068672
  s_add_u32 s36, s36, s35
  s_mul_i32 s37, s33, 7168
  s_add_u32 s37, s37, s35
  s_add_u32 s37, s37, 65536
  v_add_u32 v2, s37, v105
  s_waitcnt lgkmcnt(0)
  s_barrier
  ds_read_b64 v[110:111], v3
  ds_read_b128 v[32:35], v106
  ds_read_b128 v[36:39], v106 offset:1024
  s_waitcnt lgkmcnt(2)
  v_max_f32 v3, v108, v110
  v_sub_f32 v108, v108, v3
  v_sub_f32 v110, v110, v3
  v_exp_f32 v108, v108
  v_exp_f32 v110, v110
  v_mul_f32 v109, v109, v108
  v_fmac_f32 v109, v111, v110
  v_rcp_f32 v109, v109
  v_mul_f32 v108, 0x3ff5238e, v108
  v_mul_f32 v110, 0x3ff5238e, v110
  v_mul_f32 v108, v108, v109
  v_mul_f32 v110, v110, v109
  v_pk_mul_f32 v[16:17], v[16:17], v[108:109] op_sel_hi:[1,0]
  v_pk_mul_f32 v[18:19], v[18:19], v[108:109] op_sel_hi:[1,0]
  v_pk_mul_f32 v[20:21], v[20:21], v[108:109] op_sel_hi:[1,0]
  v_pk_mul_f32 v[22:23], v[22:23], v[108:109] op_sel_hi:[1,0]
  s_waitcnt lgkmcnt(0)
  v_pk_fma_f32 v[16:17], v[32:33], v[110:111], v[16:17] op_sel_hi:[1,0,1]
  v_pk_fma_f32 v[18:19], v[34:35], v[110:111], v[18:19] op_sel_hi:[1,0,1]
  v_pk_fma_f32 v[20:21], v[36:37], v[110:111], v[20:21] op_sel_hi:[1,0,1]
  v_pk_fma_f32 v[22:23], v[38:39], v[110:111], v[22:23] op_sel_hi:[1,0,1]
  v_cvt_pk_bf16_f32 v8, v16, v17
  v_cvt_pk_bf16_f32 v9, v18, v19
  v_cvt_pk_bf16_f32 v10, v20, v21
  v_cvt_pk_bf16_f32 v11, v22, v23
  s_cmp_lg_u32 s49, 0
  s_cbranch_scc1 L_pk_far1
  buffer_store_dwordx4 v[8:11], v105, s[28:31], s36 offen
L_pk_near1:
  ds_write_b128 v2, v[8:11]
  s_setprio 0
  s_mov_b32 s46, 0x3f803f80
  v_dot2_f32_bf16 v84, v112, s46, 0
  v_dot2_f32_bf16 v85, v113, s46, 0
  v_dot2_f32_bf16 v86, v114, s46, 0
  v_dot2_f32_bf16 v87, v115, s46, 0
  v_dot2_f32_bf16 v84, v116, s46, v84
  v_dot2_f32_bf16 v85, v117, s46, v85
  v_dot2_f32_bf16 v86, v118, s46, v86
  v_dot2_f32_bf16 v87, v119, s46, v87
  v_dot2_f32_bf16 v84, v120, s46, v84
  v_dot2_f32_bf16 v85, v121, s46, v85
  v_dot2_f32_bf16 v86, v122, s46, v86
  v_dot2_f32_bf16 v87, v123, s46, v87
  v_dot2_f32_bf16 v84, v124, s46, v84
  v_dot2_f32_bf16 v85, v125, s46, v85
  v_dot2_f32_bf16 v86, v126, s46, v86
  v_dot2_f32_bf16 v87, v127, s46, v87
  v_dot2_f32_bf16 v84, v128, s46, v84
  v_dot2_f32_bf16 v85, v129, s46, v85
  v_dot2_f32_bf16 v86, v130, s46, v86
  v_dot2_f32_bf16 v87, v131, s46, v87
  v_dot2_f32_bf16 v84, v132, s46, v84
  v_dot2_f32_bf16 v85, v133, s46, v85
  v_dot2_f32_bf16 v86, v134, s46, v86
  v_dot2_f32_bf16 v87, v135, s46, v87
  v_dot2_f32_bf16 v84, v136, s46, v84
  v_dot2_f32_bf16 v85, v137, s46, v85
  v_dot2_f32_bf16 v86, v138, s46, v86
  v_dot2_f32_bf16 v87, v139, s46, v87
  v_dot2_f32_bf16 v84, v140, s46, v84
  v_dot2_f32_bf16 v85, v141, s46, v85
  v_dot2_f32_bf16 v86, v142, s46, v86
  v_dot2_f32_bf16 v87, v143, s46, v87
  v_dot2_f32_bf16 v84, v144, s46, v84
  v_dot2_f32_bf16 v85, v145, s46, v85
  v_dot2_f32_bf16 v86, v146, s46, v86
  v_dot2_f32_bf16 v87, v147, s46, v87
  v_dot2_f32_bf16 v84, v148, s46, v84
  v_dot2_f32_bf16 v85, v149, s46, v85
  v_dot2_f32_bf16 v86, v150, s46, v86
  v_dot2_f32_bf16 v87, v151, s46, v87
  v_dot2_f32_bf16 v84, v152, s46, v84
  v_dot2_f32_bf16 v85, v153, s46, v85
  v_dot2_f32_bf16 v86, v154, s46, v86
  v_dot2_f32_bf16 v87, v155, s46, v87
  v_dot2_f32_bf16 v84, v156, s46, v84
  v_dot2_f32_bf16 v85, v157, s46, v85
  v_dot2_f32_bf16 v86, v158, s46, v86
  v_dot2_f32_bf16 v87, v159, s46, v87
  s_mul_i32 s34, s3, 7168
  s_add_u32 s34, s34, 65536
  s_add_u32 s35, s34, 4096
  v_add_u32 v2, s34, v104
  s_add_u32 s38, s42, 0
  s_add_u32 s39, s38, 4096
  s_mov_b32 s37, 262144
  s_cmp_eq_u32 s3, s33
  s_cselect_b32 s30, 0, s30
  s_cselect_b32 s34, 147456, s34
  s_cselect_b32 s35, 147456, s35
  s_cselect_b32 s36, 147456, s36
  s_cselect_b32 s37, 0, s37
  s_mov_b32 m0, s34
  s_nop 0
  buffer_load_dwordx4 v104, s[28:31], s38 offen offset:0 sc1 lds
  buffer_load_dwordx4 v104, s[28:31], s38 offen offset:1024 sc1 lds
  buffer_load_dwordx4 v104, s[28:31], s38 offen offset:2048 sc1 lds
  buffer_load_dwordx4 v104, s[28:31], s38 offen offset:3072 sc1 lds
  s_mov_b32 m0, s35
  s_nop 0
  buffer_load_dwordx4 v104, s[28:31], s39 offen offset:0 sc1 lds
  buffer_load_dwordx4 v104, s[28:31], s39 offen offset:1024 sc1 lds
  buffer_load_dwordx4 v104, s[28:31], s39 offen offset:2048 sc1 lds
  s_mov_b32 s30, 29360128
  v_dot2_f32_bf16 v84, v160, s46, v84
  v_dot2_f32_bf16 v85, v161, s46, v85
  v_dot2_f32_bf16 v86, v162, s46, v86
  v_dot2_f32_bf16 v87, v163, s46, v87
  v_dot2_f32_bf16 v84, v164, s46, v84
  v_dot2_f32_bf16 v85, v165, s46, v85
  v_dot2_f32_bf16 v86, v166, s46, v86
  v_dot2_f32_bf16 v87, v167, s46, v87
  v_dot2_f32_bf16 v84, v168, s46, v84
  v_dot2_f32_bf16 v85, v169, s46, v85
  v_dot2_f32_bf16 v86, v170, s46, v86
  v_dot2_f32_bf16 v87, v171, s46, v87
  s_waitcnt vmcnt(37)
  v_dot2_f32_bf16 v84, v172, s46, v84
  v_dot2_f32_bf16 v85, v173, s46, v85
  v_dot2_f32_bf16 v86, v174, s46, v86
  v_dot2_f32_bf16 v87, v175, s46, v87
  s_waitcnt vmcnt(35)
  v_dot2_f32_bf16 v84, v176, s46, v84
  v_dot2_f32_bf16 v85, v177, s46, v85
  v_dot2_f32_bf16 v86, v178, s46, v86
  v_dot2_f32_bf16 v87, v179, s46, v87
  s_waitcnt vmcnt(33)
  v_dot2_f32_bf16 v84, v180, s46, v84
  v_dot2_f32_bf16 v85, v181, s46, v85
  v_dot2_f32_bf16 v86, v182, s46, v86
  v_dot2_f32_bf16 v87, v183, s46, v87
  s_waitcnt vmcnt(31)
  v_dot2_f32_bf16 v84, v184, s46, v84
  v_dot2_f32_bf16 v85, v185, s46, v85
  v_dot2_f32_bf16 v86, v186, s46, v86
  v_dot2_f32_bf16 v87, v187, s46, v87
  s_waitcnt vmcnt(28)
  v_dot2_f32_bf16 v84, v188, s46, v84
  v_dot2_f32_bf16 v85, v189, s46, v85
  v_dot2_f32_bf16 v86, v190, s46, v86
  v_dot2_f32_bf16 v87, v191, s46, v87
  s_waitcnt vmcnt(26)
  v_dot2_f32_bf16 v84, v192, s46, v84
  v_dot2_f32_bf16 v85, v193, s46, v85
  v_dot2_f32_bf16 v86, v194, s46, v86
  v_dot2_f32_bf16 v87, v195, s46, v87
  s_waitcnt vmcnt(8)
  v_lshrrev_b32 v105, 5, v1
  v_bfe_u32 v106, v1, 2, 2
  v_lshl_add_u32 v105, v105, 3, v106
  v_bfe_u32 v106, v1, 0, 1
  v_bfe_u32 v64, v1, 1, 1
  v_lshl_add_u32 v106, v106, 1, v64
  v_bfe_u32 v64, v1, 4, 1
  v_lshl_add_u32 v106, v64, 2, v106
  v_bfe_u32 v64, v1, 3, 1
  s_and_b32 s21, s3, 1
  v_xor_b32 v64, s21, v64
  v_lshl_add_u32 v106, v64, 3, v106
  v_lshlrev_b32 v106, 3, v106
  v_lshl_add_u32 v105, v105, 7, v106
  s_lshr_b32 s20, s3, 1
  s_lshl_b32 s20, s20, 9
  s_add_u32 s22, s20, 65536
  v_add_u32 v106, s22, v107
  v_permlane16_swap_b32 v224, v228
  v_permlane16_swap_b32 v225, v229
  v_permlane16_swap_b32 v226, v230
  v_permlane16_swap_b32 v227, v231
  s_nop 0
  v_lshlrev_b32 v16, 16, v224
  v_and_b32 v17, 0xffff0000, v224
  v_lshlrev_b32 v18, 16, v225
  v_and_b32 v19, 0xffff0000, v225
  v_lshlrev_b32 v20, 16, v226
  v_and_b32 v21, 0xffff0000, v226
  v_lshlrev_b32 v22, 16, v227
  v_and_b32 v23, 0xffff0000, v227
  v_lshlrev_b32 v24, 16, v228
  v_and_b32 v25, 0xffff0000, v228
  v_lshlrev_b32 v26, 16, v229
  v_and_b32 v27, 0xffff0000, v229
  v_lshlrev_b32 v28, 16, v230
  v_and_b32 v29, 0xffff0000, v230
  v_lshlrev_b32 v30, 16, v231
  v_and_b32 v31, 0xffff0000, v231
  s_waitcnt vmcnt(0)
L_pk_o0chk:
  ds_read_b128 v[32:35], v2 offset:0
  ds_read_b128 v[36:39], v2 offset:1024
  ds_read_b128 v[40:43], v2 offset:2048
  ds_read_b128 v[44:47], v2 offset:3072
  ds_read_b128 v[48:51], v2 offset:4096
  ds_read_b128 v[52:55], v2 offset:5120
  ds_read_b128 v[56:59], v2 offset:6144
  s_waitcnt lgkmcnt(6)
  v_max3_u32 v108, v32, v33, 0
  v_max3_u32 v108, v34, v35, v108
  s_waitcnt lgkmcnt(5)
  v_max3_u32 v108, v36, v37, v108
  v_max3_u32 v108, v38, v39, v108
  s_waitcnt lgkmcnt(4)
  v_max3_u32 v108, v40, v41, v108
  v_max3_u32 v108, v42, v43, v108
  s_waitcnt lgkmcnt(3)
  v_max3_u32 v108, v44, v45, v108
  v_max3_u32 v108, v46, v47, v108
  s_waitcnt lgkmcnt(2)
  v_max3_u32 v108, v48, v49, v108
  v_max3_u32 v108, v50, v51, v108
  s_waitcnt lgkmcnt(1)
  v_max3_u32 v108, v52, v53, v108
  v_max3_u32 v108, v54, v55, v108
  s_waitcnt lgkmcnt(0)
  v_max3_u32 v108, v56, v57, v108
  v_max3_u32 v108, v58, v59, v108
  v_cmp_eq_u32 vcc, -1, v108
  s_cbranch_vccnz L_pk_o0again
L_pk_o0ok:
  s_waitcnt lgkmcnt(0)
  s_barrier
  s_setprio 3
  ds_read_b64_tr_b16 v[32:33], v105 offset:0
  ds_read_b64_tr_b16 v[34:35], v105 offset:512
  ds_read_b128 v[36:39], v106 offset:0
  ds_read_b64_tr_b16 v[40:41], v105 offset:2048
  ds_read_b64_tr_b16 v[42:43], v105 offset:2560
  ds_read_b128 v[44:47], v106 offset:2048
  ds_read_b64_tr_b16 v[48:49], v105 offset:4096
  ds_read_b64_tr_b16 v[50:51], v105 offset:4608
  ds_read_b128 v[52:55], v106 offset:4096
  ds_read_b64_tr_b16 v[56:57], v105 offset:6144
  ds_read_b64_tr_b16 v[58:59], v105 offset:6656
  ds_read_b128 v[60:63], v106 offset:6144
  ds_read_b64_tr_b16 v[64:65], v105 offset:8192
  ds_read_b64_tr_b16 v[66:67], v105 offset:8704
  ds_read_b128 v[68:71], v106 offset:8192
  s_waitcnt lgkmcnt(12)
  v_mfma_f32_32x32x16_bf16 v[16:31], v[32:35], v[36:39], v[16:31]
  ds_read_b64_tr_b16 v[32:33], v105 offset:10240
  ds_read_b64_tr_b16 v[34:35], v105 offset:10752
  ds_read_b128 v[36:39], v106 offset:10240
  v_lshrrev_b32 v111, 5, v1
  v_lshlrev_b32 v111, 9, v111
  v_sub_u32 v111, v107, v111
  s_waitcnt lgkmcnt(12)
  v_mfma_f32_32x32x16_bf16 v[16:31], v[40:43], v[44:47], v[16:31]
  ds_read_b64_tr_b16 v[40:41], v105 offset:12288
  ds_read_b64_tr_b16 v[42:43], v105 offset:12800
  ds_read_b128 v[44:47], v106 offset:12288
  s_lshl_b32 s34, s21, 11
  s_lshl_b32 s37, s20, 3
  s_add_u32 s35, s34, s37
  s_waitcnt lgkmcnt(12)
  v_mfma_f32_32x32x16_bf16 v[16:31], v[48:51], v[52:55], v[16:31]
  ds_read_b64_tr_b16 v[48:49], v105 offset:14336
  ds_read_b64_tr_b16 v[50:51], v105 offset:14848
  ds_read_b128 v[52:55], v106 offset:14336
  s_lshl_b32 s36, s43, 14
  s_add_u32 s36, s36, 23075840
  s_add_u32 s35, s35, s36
  s_waitcnt lgkmcnt(12)
  v_mfma_f32_32x32x16_bf16 v[16:31], v[56:59], v[60:63], v[16:31]
  ds_read_b64_tr_b16 v[56:57], v105 offset:16384
  ds_read_b64_tr_b16 v[58:59], v105 offset:16896
  ds_read_b128 v[60:63], v106 offset:16384
  s_add_u32 s36, s36, s37
  s_lshl_b32 s37, s37, 3
  s_lshl_b32 s38, s33, 12
  s_waitcnt lgkmcnt(12)
  v_mfma_f32_32x32x16_bf16 v[16:31], v[64:67], v[68:71], v[16:31]
  ds_read_b64_tr_b16 v[64:65], v105 offset:18432
  ds_read_b64_tr_b16 v[66:67], v105 offset:18944
  ds_read_b128 v[68:71], v106 offset:18432
  s_add_u32 s37, s37, s38
  s_add_u32 s34, s34, s37
  v_add_u32 v2, s34, v111
  s_waitcnt lgkmcnt(12)
  v_mfma_f32_32x32x16_bf16 v[16:31], v[32:35], v[36:39], v[16:31]
  ds_read_b64_tr_b16 v[32:33], v105 offset:20480
  ds_read_b64_tr_b16 v[34:35], v105 offset:20992
  ds_read_b128 v[36:39], v106 offset:20480
  v_and_b32 v3, 31, v1
  s_lshl_b32 s34, s21, 3
  s_add_u32 s34, s34, 3584
  s_waitcnt lgkmcnt(12)
  v_mfma_f32_32x32x16_bf16 v[16:31], v[40:43], v[44:47], v[16:31]
  ds_read_b64_tr_b16 v[40:41], v105 offset:22528
  ds_read_b64_tr_b16 v[42:43], v105 offset:23040
  ds_read_b128 v[44:47], v106 offset:22528
  s_add_u32 s36, s36, s34
  s_add_u32 s37, s37, s34
  s_cmp_eq_u32 s21, 0
  s_waitcnt lgkmcnt(12)
  v_mfma_f32_32x32x16_bf16 v[16:31], v[48:51], v[52:55], v[16:31]
  ds_read_b64_tr_b16 v[48:49], v105 offset:24576
  ds_read_b64_tr_b16 v[50:51], v105 offset:25088
  ds_read_b128 v[52:55], v106 offset:24576
  s_cselect_b32 s39, -1, 0
  s_mov_b32 s38, -1
  v_lshlrev_b32 v3, 4, v3
  s_waitcnt lgkmcnt(12)
  v_mfma_f32_32x32x16_bf16 v[16:31], v[56:59], v[60:63], v[16:31]
  ds_read_b64_tr_b16 v[56:57], v105 offset:26624
  ds_read_b64_tr_b16 v[58:59], v105 offset:27136
  ds_read_b128 v[60:63], v106 offset:26624
  v_lshrrev_b32 v108, 5, v1
  v_lshl_add_u32 v3, v108, 2, v3
  v_add_u32 v109, s37, v3
  s_waitcnt lgkmcnt(12)
  v_mfma_f32_32x32x16_bf16 v[16:31], v[64:67], v[68:71], v[16:31]
  ds_read_b64_tr_b16 v[64:65], v105 offset:28672
  ds_read_b64_tr_b16 v[66:67], v105 offset:29184
  ds_read_b128 v[68:71], v106 offset:28672
  v_bfe_u32 v110, v1, 3, 2
  v_mul_u32_u24 v110, 896, v110
  v_lshl_add_u32 v110, v108, 7, v110
  s_waitcnt lgkmcnt(12)
  v_mfma_f32_32x32x16_bf16 v[16:31], v[32:35], v[36:39], v[16:31]
  ds_read_b64_tr_b16 v[32:33], v105 offset:30720
  ds_read_b64_tr_b16 v[34:35], v105 offset:31232
  ds_read_b128 v[36:39], v106 offset:30720
  v_and_b32 v108, 7, v1
  v_lshl_add_u32 v110, v108, 4, v110
  s_mul_i32 s34, s20, 7
  s_waitcnt lgkmcnt(12)
  v_mfma_f32_32x32x16_bf16 v[16:31], v[40:43], v[44:47], v[16:31]
  ds_read_b64_tr_b16 v[40:41], v105 offset:32768
  ds_read_b64_tr_b16 v[42:43], v105 offset:33280
  ds_read_b128 v[44:47], v106 offset:32768
  buffer_load_dwordx4 v[88:91], v104, s[52:55], s47 offen offset:0 sc1
  s_waitcnt lgkmcnt(12)
  v_mfma_f32_32x32x16_bf16 v[16:31], v[48:51], v[52:55], v[16:31]
  ds_read_b64_tr_b16 v[48:49], v105 offset:34816
  ds_read_b64_tr_b16 v[50:51], v105 offset:35328
  ds_read_b128 v[52:55], v106 offset:34816
  s_lshl_b32 s37, s21, 9
  s_add_u32 s34, s34, s37
  s_add_u32 s34, s34, 98304
  s_waitcnt lgkmcnt(12)
  v_mfma_f32_32x32x16_bf16 v[16:31], v[56:59], v[60:63], v[16:31]
  ds_read_b64_tr_b16 v[56:57], v105 offset:36864
  ds_read_b64_tr_b16 v[58:59], v105 offset:37376
  ds_read_b128 v[60:63], v106 offset:36864
  v_add_u32 v110, s34, v110
  s_waitcnt lgkmcnt(12)
  v_mfma_f32_32x32x16_bf16 v[16:31], v[64:67], v[68:71], v[16:31]
  ds_read_b64_tr_b16 v[64:65], v105 offset:38912
  ds_read_b64_tr_b16 v[66:67], v105 offset:39424
  ds_read_b128 v[68:71], v106 offset:38912
  s_waitcnt lgkmcnt(12)
  v_mfma_f32_32x32x16_bf16 v[16:31], v[32:35], v[36:39], v[16:31]
  ds_read_b64_tr_b16 v[32:33], v105 offset:40960
  ds_read_b64_tr_b16 v[34:35], v105 offset:41472
  ds_read_b128 v[36:39], v106 offset:40960
  s_waitcnt lgkmcnt(12)
  v_mfma_f32_32x32x16_bf16 v[16:31], v[40:43], v[44:47], v[16:31]
  ds_read_b64_tr_b16 v[40:41], v105 offset:43008
  ds_read_b64_tr_b16 v[42:43], v105 offset:43520
  ds_read_b128 v[44:47], v106 offset:43008
  s_waitcnt lgkmcnt(12)
  v_mfma_f32_32x32x16_bf16 v[16:31], v[48:51], v[52:55], v[16:31]
  ds_read_b64_tr_b16 v[48:49], v105 offset:45056
  ds_read_b64_tr_b16 v[50:51], v105 offset:45568
  ds_read_b128 v[52:55], v106 offset:45056
  s_waitcnt lgkmcnt(12)
  v_mfma_f32_32x32x16_bf16 v[16:31], v[56:59], v[60:63], v[16:31]
  ds_read_b64_tr_b16 v[56:57], v105 offset:47104
  ds_read_b64_tr_b16 v[58:59], v105 offset:47616
  ds_read_b128 v[60:63], v106 offset:47104
  s_waitcnt lgkmcnt(12)
  v_mfma_f32_32x32x16_bf16 v[16:31], v[64:67], v[68:71], v[16:31]
  ds_read_b64_tr_b16 v[64:65], v105 offset:49152
  ds_read_b64_tr_b16 v[66:67], v105 offset:49664
  ds_read_b128 v[68:71], v106 offset:49152
  s_waitcnt lgkmcnt(12)
  v_mfma_f32_32x32x16_bf16 v[16:31], v[32:35], v[36:39], v[16:31]
  ds_read_b64_tr_b16 v[32:33], v105 offset:51200
  ds_read_b64_tr_b16 v[34:35], v105 offset:51712
  ds_read_b128 v[36:39], v106 offset:51200
  s_waitcnt lgkmcnt(12)
  v_mfma_f32_32x32x16_bf16 v[16:31], v[40:43], v[44:47], v[16:31]
  ds_read_b64_tr_b16 v[40:41], v105 offset:53248
  ds_read_b64_tr_b16 v[42:43], v105 offset:53760
  ds_read_b128 v[44:47], v106 offset:53248
  s_waitcnt lgkmcnt(12)
  v_mfma_f32_32x32x16_bf16 v[16:31], v[48:51], v[52:55], v[16:31]
  ds_read_b64_tr_b16 v[48:49], v105 offset:55296
  ds_read_b64_tr_b16 v[50:51], v105 offset:55808
  ds_read_b128 v[52:55], v106 offset:55296
  s_waitcnt lgkmcnt(12)
  v_mfma_f32_32x32x16_bf16 v[16:31], v[56:59], v[60:63], v[16:31]
  buffer_load_dwordx4 v[92:95], v104, s[52:55], s47 offen offset:1024 sc1
  s_waitcnt lgkmcnt(9)
  v_mfma_f32_32x32x16_bf16 v[16:31], v[64:67], v[68:71], v[16:31]
  s_waitcnt lgkmcnt(6)
  v_mfma_f32_32x32x16_bf16 v[16:31], v[32:35], v[36:39], v[16:31]
  s_waitcnt lgkmcnt(3)
  v_mfma_f32_32x32x16_bf16 v[16:31], v[40:43], v[44:47], v[16:31]
  s_waitcnt lgkmcnt(0)
  v_mfma_f32_32x32x16_bf16 v[16:31], v[48:51], v[52:55], v[16:31]
  s_nop 7
  s_nop 3
  v_cvt_pk_bf16_f32 v32, v16, v17
  v_cvt_pk_bf16_f32 v33, v18, v19
  v_cvt_pk_bf16_f32 v34, v20, v21
  v_cvt_pk_bf16_f32 v35, v22, v23
  v_cvt_pk_bf16_f32 v36, v24, v25
  v_cvt_pk_bf16_f32 v37, v26, v27
  v_cvt_pk_bf16_f32 v38, v28, v29
  v_cvt_pk_bf16_f32 v39, v30, v31
  s_cmp_lg_u32 s49, 0
  s_cbranch_scc1 L_pk_far3
  buffer_store_dwordx4 v[32:35], v111, s[28:31], s35 offen
L_pk_near3:
  s_mov_b64 exec, s[38:39]
  s_cmp_lg_u32 s49, 0
  s_cbranch_scc1 L_pk_far4
  buffer_store_dwordx4 v[36:39], v111, s[28:31], s35 offen offset:1024
L_pk_near4:
  s_mov_b64 exec, -1
  v_pk_add_f32 v[40:41], v[16:17], v[18:19]
  v_pk_add_f32 v[44:45], v[24:25], v[26:27]
  v_pk_mul_f32 v[42:43], v[16:17], v[16:17]
  v_pk_mul_f32 v[46:47], v[24:25], v[24:25]
  v_pk_add_f32 v[40:41], v[40:41], v[20:21]
  v_pk_add_f32 v[44:45], v[44:45], v[28:29]
  v_pk_fma_f32 v[42:43], v[18:19], v[18:19], v[42:43]
  v_pk_fma_f32 v[46:47], v[26:27], v[26:27], v[46:47]
  v_pk_add_f32 v[40:41], v[40:41], v[22:23]
  v_pk_add_f32 v[44:45], v[44:45], v[30:31]
  v_pk_fma_f32 v[42:43], v[20:21], v[20:21], v[42:43]
  v_pk_fma_f32 v[46:47], v[28:29], v[28:29], v[46:47]
  v_add_f32 v40, v40, v41
  v_add_f32 v44, v44, v45
  v_pk_fma_f32 v[42:43], v[22:23], v[22:23], v[42:43]
  v_pk_fma_f32 v[46:47], v[30:31], v[30:31], v[46:47]
  v_add_f32 v41, v42, v43
  v_add_f32 v45, v46, v47
  s_mov_b64 exec, s[38:39]
  v_pk_add_f32 v[40:41], v[40:41], v[44:45]
  s_mov_b64 exec, -1
  s_nop 1
  v_permlane32_swap_b32 v40, v41
  s_nop 1
  v_add_f32 v40, v40, v41
  s_cmp_lg_u32 s49, 0
  s_cbranch_scc1 L_pk_far5
  buffer_store_dword v40, v3, s[28:31], s36 offen
L_pk_near5:
  s_setprio 0
  s_barrier
  s_mov_b64 s[20:21], s[38:39]
  v_mov_b32 v105, v2
  s_sleep 1
  s_lshl_b32 s34, s3, 12
  v_add_u32 v3, s34, v104
  s_add_u32 s38, s42, 7168
  s_mov_b32 s37, 262144
  s_cmp_eq_u32 s3, s33
  s_cselect_b32 s30, 0, s30
  s_cselect_b32 s34, 147456, s34
  s_cselect_b32 s37, 0, s37
  s_mov_b32 m0, s34
  s_nop 0
  buffer_load_dwordx4 v104, s[28:31], s38 offen offset:0 sc1 lds
  buffer_load_dwordx4 v104, s[28:31], s38 offen offset:1024 sc1 lds
  buffer_load_dwordx4 v104, s[28:31], s38 offen offset:2048 sc1 lds
  buffer_load_dwordx4 v104, s[28:31], s38 offen offset:3072 sc1 lds
  s_mov_b32 s30, 29360128
  ds_write_b128 v105, v[32:35]
  ds_write_b32 v109, v40
  ds_write_b128 v110, v[16:19]
  ds_write_b128 v110, v[20:23] offset:7168
  s_mov_b64 exec, s[20:21]
  ds_write_b128 v105, v[36:39] offset:1024
  ds_write_b128 v110, v[24:27] offset:256
  ds_write_b128 v110, v[28:31] offset:7424
  s_mov_b64 exec, -1
  v_dot2_f32_bf16 v84, v196, s46, v84
  v_dot2_f32_bf16 v85, v197, s46, v85
  v_dot2_f32_bf16 v86, v198, s46, v86
  v_dot2_f32_bf16 v87, v199, s46, v87
  v_dot2_f32_bf16 v84, v200, s46, v84
  v_dot2_f32_bf16 v85, v201, s46, v85
  v_dot2_f32_bf16 v86, v202, s46, v86
  v_dot2_f32_bf16 v87, v203, s46, v87
  v_dot2_f32_bf16 v84, v204, s46, v84
  v_dot2_f32_bf16 v85, v205, s46, v85
  v_dot2_f32_bf16 v86, v206, s46, v86
  v_dot2_f32_bf16 v87, v207, s46, v87
  v_dot2_f32_bf16 v84, v208, s46, v84
  v_dot2_f32_bf16 v85, v209, s46, v85
  v_dot2_f32_bf16 v86, v210, s46, v86
  v_dot2_f32_bf16 v87, v211, s46, v87
  v_dot2_f32_bf16 v84, v212, s46, v84
  v_dot2_f32_bf16 v85, v213, s46, v85
  v_dot2_f32_bf16 v86, v214, s46, v86
  v_dot2_f32_bf16 v87, v215, s46, v87
  v_dot2_f32_bf16 v84, v216, s46, v84
  v_dot2_f32_bf16 v85, v217, s46, v85
  v_dot2_f32_bf16 v86, v218, s46, v86
  v_dot2_f32_bf16 v87, v219, s46, v87
  v_dot2_f32_bf16 v84, v220, s46, v84
  v_dot2_f32_bf16 v85, v221, s46, v85
  v_dot2_f32_bf16 v86, v222, s46, v86
  v_dot2_f32_bf16 v87, v223, s46, v87
  v_lshlrev_b32 v4, 16, v4
  v_cmp_gt_u32 vcc, 32, v1
  v_mov_b32 v11, 0
  v_add_f32 v84, v84, v85
  v_add_f32 v86, v86, v87
  v_add_f32 v84, v84, v86
  v_mov_b32 v85, v84
  s_nop 1
  v_permlane32_swap_b32 v84, v85
  s_nop 1
  v_add_f32 v84, v84, v85
  v_cvt_pk_bf16_f32 v8, v84, v4
  v_lshlrev_b32 v85, 16, v8
  v_sub_f32 v84, v84, v85
  v_cvt_pk_bf16_f32 v10, v84, v11
  v_cndmask_b32 v8, 0, v8, vcc
  v_cndmask_b32 v10, 0, v10, vcc
  v_mov_b32 v9, v8
  v_mov_b32 v15, 0
  v_mov_b32 v106, 159744
  ds_write_b32 v106, v15
  ds_write_b32 v106, v15 offset:4
  v_lshrrev_b32 v14, 5, v1
  s_lshl_b32 s46, s3, 3
  v_add_u32 v14, s46, v14
  v_bfe_u32 v12, v1, 3, 2
  v_mul_u32_u24 v12, 896, v12
  v_and_b32 v13, 7, v1
  v_lshl_add_u32 v12, v13, 4, v12
  v_mul_u32_u24 v13, 147, v14
  v_lshrrev_b32 v13, 10, v13
  v_mul_u32_u24 v13, 56448, v13
  v_lshl_add_u32 v13, v14, 7, v13
  v_add_u32 v4, v12, v13
  v_add_u32 v14, 2, v14
  v_mul_u32_u24 v13, 147, v14
  v_lshrrev_b32 v13, 10, v13
  v_mul_u32_u24 v13, 56448, v13
  v_lshl_add_u32 v13, v14, 7, v13
  v_add_u32 v5, v12, v13
  v_add_u32 v14, 2, v14
  v_mul_u32_u24 v13, 147, v14
  v_lshrrev_b32 v13, 10, v13
  v_mul_u32_u24 v13, 56448, v13
  v_lshl_add_u32 v13, v14, 7, v13
  v_add_u32 v6, v12, v13
  v_add_u32 v14, 2, v14
  v_mul_u32_u24 v13, 147, v14
  v_lshrrev_b32 v13, 10, v13
  v_mul_u32_u24 v13, 56448, v13
  v_lshl_add_u32 v13, v14, 7, v13
  v_add_u32 v7, v12, v13
  s_lshl_b32 s40, s32, 6
  s_add_u32 s40, s40, s33
  s_mul_i32 s40, s40, 7168
  s_add_u32 s40, s40, 8388608
  s_add_u32 s41, s40, 3584
  v_add_u32 v110, 157696, v107
  s_waitcnt vmcnt(0)
L_pk_h0chk:
  ds_read_b128 v[48:51], v3 offset:0
  ds_read_b128 v[52:55], v3 offset:1024
  ds_read_b128 v[56:59], v3 offset:2048
  s_nop 0
L_wm_P7:
  s_cbranch_execz L_wm_P10
  ds_read_b128 v[60:63], v3 offset:3072
  s_waitcnt lgkmcnt(3)
  v_max3_u32 v108, v48, v49, 0
  v_max3_u32 v108, v50, v51, v108
  s_waitcnt lgkmcnt(2)
  v_max3_u32 v108, v52, v53, v108
  v_max3_u32 v108, v54, v55, v108
  s_waitcnt lgkmcnt(1)
  v_max3_u32 v108, v56, v57, v108
  v_max3_u32 v108, v58, v59, v108
  s_waitcnt lgkmcnt(0)
  v_max3_u32 v108, v60, v61, v108
  v_max3_u32 v108, v62, v63, v108
  v_cmp_eq_u32 vcc, -1, v108
  s_cbranch_vccnz L_pk_h0again
L_pk_h0ok:
  s_branch L_pk_x2
L_pk_role1:
L_wm_L_pk_role1:
  s_cbranch_execz L_wm_P8
  s_waitcnt vmcnt(2)
  s_barrier
  ds_read_b128 v[72:75], v105 offset:0
  ds_read_b128 v[76:79], v105 offset:1024
  ds_read_b128 v[80:83], v105 offset:4096
  ds_read_b128 v[84:87], v105 offset:5120
  ds_read_b128 v[88:91], v105 offset:2048
  ds_read_b128 v[92:95], v105 offset:3072
  buffer_load_dwordx4 v104, s[28:31], s40 offen offset:2048 sc1 lds
  buffer_load_dwordx4 v104, s[28:31], s40 offen offset:3072 sc1 lds
  s_add_u32 s40, s40, 16384
  s_and_b32 s40, s40, 0x1ffff
  s_or_b32 s40, s40, s12
  s_add_u32 s39, s40, 0x20000
  s_waitcnt lgkmcnt(4)
  v_mfma_f32_32x32x16_bf16 v[32:47], v[72:75], v[8:11], 0
  v_mfma_f32_32x32x16_bf16 v[32:47], v[76:79], v[12:15], v[32:47]
  s_lshl_b32 s39, s43, 2
  s_add_u32 s39, s39, s20
  s_lshl_b32 s39, s39, 12
  s_add_u32 s39, s39, 23068672
  s_add_u32 s40, s39, 0x10000
  s_cmp_lt_u32 s33, 4
  s_cselect_b32 s34, 0, 0x40000000
  v_or_b32 v7, s34, v104
  v_mov_b32 v108, -1
  v_mov_b32 v109, -1
  v_mov_b32 v110, -1
  v_mov_b32 v111, -1
  v_and_b32 v2, 31, v1
  s_lshr_b32 s34, s46, 2
  s_lshl_b32 s34, s34, 8
  s_and_b32 s35, s46, 3
  s_lshl_b32 s35, s35, 1
  s_add_u32 s34, s34, s35
  v_lshl_add_u32 v234, v2, 3, s34
  s_setprio 1
  s_waitcnt lgkmcnt(2)
  v_mfma_f32_32x32x16_bf16 v[48:63], v[80:83], v[8:11], 0
  ds_read_b128 v[72:75], v105 offset:8192
  ds_read_b128 v[76:79], v105 offset:9216
  v_exp_f32 v32, v32
  v_exp_f32 v33, v33
  v_exp_f32 v34, v34
  v_exp_f32 v35, v35
  v_exp_f32 v36, v36
  ds_read_b128 v[96:99], v105 offset:6144
  ds_read_b128 v[100:103], v105 offset:7168
  v_cvt_pk_bf16_f32 v64, v32, v33
  v_exp_f32 v37, v37
  v_cvt_pk_bf16_f32 v65, v34, v35
  v_exp_f32 v38, v38
  v_exp_f32 v39, v39
  v_cvt_pk_bf16_f32 v66, v36, v37
  v_mfma_f32_32x32x16_bf16 v[48:63], v[84:87], v[12:15], v[48:63]
  buffer_store_dwordx4 v[240:243], v236, s[28:31], 0 offen sc1
  v_exp_f32 v40, v40
  v_cvt_pk_bf16_f32 v67, v38, v39
  v_exp_f32 v41, v41
  v_exp_f32 v42, v42
  v_exp_f32 v43, v43
  v_exp_f32 v44, v44
  s_waitcnt lgkmcnt(4)
  v_mfma_f32_32x32x16_bf16 v[16:31], v[88:91], v[64:67], 0
  s_cmp_lg_u32 s49, 0
  s_cbranch_scc1 L_pk_far7
  buffer_store_dwordx4 v[108:111], v7, s[28:31], s39 offen offset:0
  buffer_store_dwordx4 v[108:111], v7, s[28:31], s39 offen offset:1024
L_pk_near7:
  v_cvt_pk_bf16_f32 v68, v40, v41
  v_exp_f32 v45, v45
  v_cvt_pk_bf16_f32 v69, v42, v43
  v_exp_f32 v46, v46
  v_exp_f32 v47, v47
  v_cvt_pk_bf16_f32 v70, v44, v45
  v_cvt_pk_bf16_f32 v71, v46, v47
  s_setprio 0
  s_waitcnt lgkmcnt(2)
  v_mfma_f32_32x32x16_bf16 v[32:47], v[72:75], v[8:11], 0
  ds_read_b128 v[80:83], v105 offset:12288
  ds_read_b128 v[84:87], v105 offset:13312
  v_exp_f32 v48, v48
  v_exp_f32 v49, v49
  v_exp_f32 v50, v50
  v_exp_f32 v51, v51
  v_exp_f32 v52, v52
  v_mfma_f32_32x32x16_bf16 v[16:31], v[92:95], v[68:71], v[16:31]
  ds_read_b128 v[88:91], v105 offset:10240
  ds_read_b128 v[92:95], v105 offset:11264
  v_cvt_pk_bf16_f32 v64, v48, v49
  v_exp_f32 v53, v53
  v_cvt_pk_bf16_f32 v65, v50, v51
  v_exp_f32 v54, v54
  v_exp_f32 v55, v55
  v_cvt_pk_bf16_f32 v66, v52, v53
  v_mfma_f32_32x32x16_bf16 v[32:47], v[76:79], v[12:15], v[32:47]
  buffer_store_dwordx4 v[244:247], v237, s[28:31], 0 offen sc1
  v_exp_f32 v56, v56
  v_cvt_pk_bf16_f32 v67, v54, v55
  v_exp_f32 v57, v57
  v_exp_f32 v58, v58
  v_exp_f32 v59, v59
  v_exp_f32 v60, v60
  s_waitcnt lgkmcnt(4)
  v_mfma_f32_32x32x16_bf16 v[16:31], v[96:99], v[64:67], v[16:31]
  s_cmp_lg_u32 s49, 0
  s_cbranch_scc1 L_pk_far8
  buffer_store_dwordx4 v[108:111], v7, s[28:31], s39 offen offset:2048
  buffer_store_dwordx4 v[108:111], v7, s[28:31], s39 offen offset:3072
L_pk_near8:
  v_cvt_pk_bf16_f32 v68, v56, v57
  v_exp_f32 v61, v61
  v_cvt_pk_bf16_f32 v69, v58, v59
  v_exp_f32 v62, v62
  v_exp_f32 v63, v63
  v_cvt_pk_bf16_f32 v70, v60, v61
  v_cvt_pk_bf16_f32 v71, v62, v63
  s_waitcnt vmcnt(6)
  s_barrier
  s_setprio 3
  s_waitcnt lgkmcnt(2)
  v_mfma_f32_32x32x16_bf16 v[48:63], v[80:83], v[8:11], 0
  ds_read_b128 v[72:75], v105 offset:32768
  ds_read_b128 v[76:79], v105 offset:33792
  v_exp_f32 v32, v32
  v_exp_f32 v33, v33
  v_exp_f32 v34, v34
  v_exp_f32 v35, v35
  v_exp_f32 v36, v36
  v_mfma_f32_32x32x16_bf16 v[16:31], v[100:103], v[68:71], v[16:31]
  ds_read_b128 v[96:99], v105 offset:14336
  ds_read_b128 v[100:103], v105 offset:15360
  v_cvt_pk_bf16_f32 v64, v32, v33
  v_exp_f32 v37, v37
  v_cvt_pk_bf16_f32 v65, v34, v35
  v_exp_f32 v38, v38
  v_exp_f32 v39, v39
  v_cvt_pk_bf16_f32 v66, v36, v37
  v_mfma_f32_32x32x16_bf16 v[48:63], v[84:87], v[12:15], v[48:63]
  buffer_store_dwordx4 v[248:251], v238, s[28:31], 0 offen sc1
  v_exp_f32 v40, v40
  v_cvt_pk_bf16_f32 v67, v38, v39
  v_exp_f32 v41, v41
  v_exp_f32 v42, v42
  v_exp_f32 v43, v43
  v_exp_f32 v44, v44
  s_waitcnt lgkmcnt(4)
  v_mfma_f32_32x32x16_bf16 v[16:31], v[88:91], v[64:67], v[16:31]
  s_cmp_lg_u32 s49, 0
  s_cbranch_scc1 L_pk_far9
  buffer_store_dwordx4 v[108:111], v7, s[28:31], s40 offen offset:0
  buffer_store_dwordx4 v[108:111], v7, s[28:31], s40 offen offset:1024
L_pk_near9:
  v_cvt_pk_bf16_f32 v68, v40, v41
  v_exp_f32 v45, v45
  v_cvt_pk_bf16_f32 v69, v42, v43
  v_exp_f32 v46, v46
  v_exp_f32 v47, v47
  v_cvt_pk_bf16_f32 v70, v44, v45
  v_cvt_pk_bf16_f32 v71, v46, v47
  s_setprio 2
  s_waitcnt lgkmcnt(2)
  v_mfma_f32_32x32x16_bf16 v[32:47], v[72:75], v[8:11], 0
  ds_read_b128 v[80:83], v105 offset:36864
  ds_read_b128 v[84:87], v105 offset:37888
  v_exp_f32 v48, v48
  v_exp_f32 v49, v49
  v_exp_f32 v50, v50
  v_exp_f32 v51, v51
  v_exp_f32 v52, v52
  v_mfma_f32_32x32x16_bf16 v[16:31], v[92:95], v[68:71], v[16:31]
  ds_read_b128 v[88:91], v105 offset:34816
  ds_read_b128 v[92:95], v105 offset:35840
  v_cvt_pk_bf16_f32 v64, v48, v49
  v_exp_f32 v53, v53
  v_cvt_pk_bf16_f32 v65, v50, v51
  v_exp_f32 v54, v54
  v_exp_f32 v55, v55
  v_cvt_pk_bf16_f32 v66, v52, v53
  v_mfma_f32_32x32x16_bf16 v[32:47], v[76:79], v[12:15], v[32:47]
  buffer_store_dwordx4 v[252:255], v239, s[28:31], 0 offen sc1
  v_exp_f32 v56, v56
  v_cvt_pk_bf16_f32 v67, v54, v55
  v_exp_f32 v57, v57
  v_exp_f32 v58, v58
  v_exp_f32 v59, v59
  v_exp_f32 v60, v60
  s_waitcnt lgkmcnt(4)
  v_mfma_f32_32x32x16_bf16 v[16:31], v[96:99], v[64:67], v[16:31]
  s_cmp_lg_u32 s49, 0
  s_cbranch_scc1 L_pk_far10
  buffer_store_dwordx4 v[108:111], v7, s[28:31], s40 offen offset:2048
  buffer_store_dwordx4 v[108:111], v7, s[28:31], s40 offen offset:3072
L_pk_near10:
  v_cvt_pk_bf16_f32 v68, v56, v57
  v_exp_f32 v61, v61
  v_cvt_pk_bf16_f32 v69, v58, v59
  v_exp_f32 v62, v62
  v_exp_f32 v63, v63
  v_cvt_pk_bf16_f32 v70, v60, v61
  v_cvt_pk_bf16_f32 v71, v62, v63
  s_setprio 1
  s_waitcnt lgkmcnt(2)
  v_mfma_f32_32x32x16_bf16 v[48:63], v[80:83], v[8:11], 0
  ds_read_b128 v[72:75], v105 offset:40960
  ds_read_b128 v[76:79], v105 offset:41984
  v_exp_f32 v32, v32
  v_exp_f32 v33, v33
  v_exp_f32 v34, v34
  v_exp_f32 v35, v35
  v_exp_f32 v36, v36
  v_mfma_f32_32x32x16_bf16 v[16:31], v[100:103], v[68:71], v[16:31]
  ds_read_b128 v[96:99], v105 offset:38912
  ds_read_b128 v[100:103], v105 offset:39936
  v_cvt_pk_bf16_f32 v64, v32, v33
  v_exp_f32 v37, v37
  v_cvt_pk_bf16_f32 v65, v34, v35
  v_exp_f32 v38, v38
  v_exp_f32 v39, v39
  v_cvt_pk_bf16_f32 v66, v36, v37
  v_mfma_f32_32x32x16_bf16 v[48:63], v[84:87], v[12:15], v[48:63]
  v_exp_f32 v40, v40
  v_cvt_pk_bf16_f32 v67, v38, v39
  v_exp_f32 v41, v41
  v_exp_f32 v42, v42
  v_exp_f32 v43, v43
  v_exp_f32 v44, v44
  s_waitcnt lgkmcnt(4)
  v_mfma_f32_32x32x16_bf16 v[16:31], v[88:91], v[64:67], v[16:31]
  v_cvt_pk_bf16_f32 v68, v40, v41
  v_exp_f32 v45, v45
  v_cvt_pk_bf16_f32 v69, v42, v43
  v_exp_f32 v46, v46
  v_exp_f32 v47, v47
  v_cvt_pk_bf16_f32 v70, v44, v45
  v_cvt_pk_bf16_f32 v71, v46, v47
  s_setprio 0
  s_waitcnt lgkmcnt(2)
  v_mfma_f32_32x32x16_bf16 v[32:47], v[72:75], v[8:11], 0
  ds_read_b128 v[80:83], v105 offset:45056
  ds_read_b128 v[84:87], v105 offset:46080
  v_exp_f32 v48, v48
  v_exp_f32 v49, v49
  v_exp_f32 v50, v50
  v_exp_f32 v51, v51
  v_exp_f32 v52, v52
  v_mfma_f32_32x32x16_bf16 v[16:31], v[92:95], v[68:71], v[16:31]
  ds_read_b128 v[88:91], v105 offset:43008
  ds_read_b128 v[92:95], v105 offset:44032
  v_cvt_pk_bf16_f32 v64, v48, v49
  v_exp_f32 v53, v53
  v_cvt_pk_bf16_f32 v65, v50, v51
  v_exp_f32 v54, v54
  v_exp_f32 v55, v55
  v_cvt_pk_bf16_f32 v66, v52, v53
  v_mfma_f32_32x32x16_bf16 v[32:47], v[76:79], v[12:15], v[32:47]
  v_exp_f32 v56, v56
  v_cvt_pk_bf16_f32 v67, v54, v55
  v_exp_f32 v57, v57
  v_exp_f32 v58, v58
  v_exp_f32 v59, v59
  v_exp_f32 v60, v60
  s_waitcnt lgkmcnt(4)
  v_mfma_f32_32x32x16_bf16 v[16:31], v[96:99], v[64:67], v[16:31]
  v_cvt_pk_bf16_f32 v68, v56, v57
  v_exp_f32 v61, v61
  v_cvt_pk_bf16_f32 v69, v58, v59
  v_exp_f32 v62, v62
  v_exp_f32 v63, v63
  v_cvt_pk_bf16_f32 v70, v60, v61
  v_cvt_pk_bf16_f32 v71, v62, v63
  s_waitcnt vmcnt(0)
  s_barrier
  s_setprio 3
  s_waitcnt lgkmcnt(2)
  v_mfma_f32_32x32x16_bf16 v[48:63], v[80:83], v[8:11], 0
  ds_read_b128 v[72:75], v106 offset:0
  ds_read_b128 v[76:79], v106 offset:1024
  v_exp_f32 v32, v32
  v_exp_f32 v33, v33
  v_exp_f32 v34, v34
  v_exp_f32 v35, v35
  v_exp_f32 v36, v36
  v_mfma_f32_32x32x16_bf16 v[16:31], v[100:103], v[68:71], v[16:31]
  ds_read_b128 v[96:99], v105 offset:47104
  ds_read_b128 v[100:103], v105 offset:48128
  v_cvt_pk_bf16_f32 v64, v32, v33
  v_exp_f32 v37, v37
  v_cvt_pk_bf16_f32 v65, v34, v35
  v_exp_f32 v38, v38
  v_exp_f32 v39, v39
  v_cvt_pk_bf16_f32 v66, v36, v37
  v_mfma_f32_32x32x16_bf16 v[48:63], v[84:87], v[12:15], v[48:63]
  s_cmp_lg_u32 s49, 0
  s_cbranch_scc1 L_pk_far11
  buffer_store_dwordx4 v[108:111], v5, s[28:31], s51 offen offset:0
  buffer_store_dwordx4 v[108:111], v5, s[28:31], s51 offen offset:3584
L_pk_near11:
  s_add_u32 s51, s51, 7168
  v_exp_f32 v40, v40
  v_cvt_pk_bf16_f32 v67, v38, v39
  v_exp_f32 v41, v41
  v_exp_f32 v42, v42
  v_exp_f32 v43, v43
  v_exp_f32 v44, v44
  s_waitcnt lgkmcnt(4)
  v_mfma_f32_32x32x16_bf16 v[16:31], v[88:91], v[64:67], v[16:31]
  v_cvt_pk_bf16_f32 v68, v40, v41
  v_exp_f32 v45, v45
  v_cvt_pk_bf16_f32 v69, v42, v43
  v_exp_f32 v46, v46
  v_exp_f32 v47, v47
  v_cvt_pk_bf16_f32 v70, v44, v45
  v_cvt_pk_bf16_f32 v71, v46, v47
  s_setprio 2
  s_waitcnt lgkmcnt(2)
  v_mfma_f32_32x32x16_bf16 v[32:47], v[72:75], v[8:11], 0
  ds_read_b128 v[80:83], v106 offset:4096
  ds_read_b128 v[84:87], v106 offset:5120
  v_exp_f32 v48, v48
  v_exp_f32 v49, v49
  v_exp_f32 v50, v50
  v_exp_f32 v51, v51
  v_exp_f32 v52, v52
  v_mfma_f32_32x32x16_bf16 v[16:31], v[92:95], v[68:71], v[16:31]
  ds_read_b128 v[88:91], v106 offset:2048
  ds_read_b128 v[92:95], v106 offset:3072
  v_cvt_pk_bf16_f32 v64, v48, v49
  v_exp_f32 v53, v53
  v_cvt_pk_bf16_f32 v65, v50, v51
  v_exp_f32 v54, v54
  v_exp_f32 v55, v55
  v_cvt_pk_bf16_f32 v66, v52, v53
  v_mfma_f32_32x32x16_bf16 v[32:47], v[76:79], v[12:15], v[32:47]
  s_cmp_lg_u32 s49, 0
  s_cbranch_scc1 L_pk_far12
  buffer_store_dwordx4 v[108:111], v5, s[28:31], s51 offen offset:0
  buffer_store_dwordx4 v[108:111], v5, s[28:31], s51 offen offset:3584
L_pk_near12:
  s_add_u32 s51, s51, 7168
  v_exp_f32 v56, v56
  v_cvt_pk_bf16_f32 v67, v54, v55
  v_exp_f32 v57, v57
  v_exp_f32 v58, v58
  v_exp_f32 v59, v59
  v_exp_f32 v60, v60
  s_waitcnt lgkmcnt(4)
  v_mfma_f32_32x32x16_bf16 v[16:31], v[96:99], v[64:67], v[16:31]
  v_cvt_pk_bf16_f32 v68, v56, v57
  v_exp_f32 v61, v61
  v_cvt_pk_bf16_f32 v69, v58, v59
  v_exp_f32 v62, v62
  v_exp_f32 v63, v63
  v_cvt_pk_bf16_f32 v70, v60, v61
  v_cvt_pk_bf16_f32 v71, v62, v63
  s_setprio 1
  s_waitcnt lgkmcnt(2)
  v_mfma_f32_32x32x16_bf16 v[48:63], v[80:83], v[8:11], 0
  ds_read_b128 v[72:75], v106 offset:8192
  ds_read_b128 v[76:79], v106 offset:9216
  v_exp_f32 v32, v32
  v_exp_f32 v33, v33
  v_exp_f32 v34, v34
  v_exp_f32 v35, v35
  v_exp_f32 v36, v36
  v_mfma_f32_32x32x16_bf16 v[16:31], v[100:103], v[68:71], v[16:31]
  ds_read_b128 v[96:99], v106 offset:6144
  ds_read_b128 v[100:103], v106 offset:7168
  v_cvt_pk_bf16_f32 v64, v32, v33
  v_exp_f32 v37, v37
  v_cvt_pk_bf16_f32 v65, v34, v35
  v_exp_f32 v38, v38
  v_exp_f32 v39, v39
  v_cvt_pk_bf16_f32 v66, v36, v37
  v_mfma_f32_32x32x16_bf16 v[48:63], v[84:87], v[12:15], v[48:63]
  s_cmp_lg_u32 s49, 0
  s_cbranch_scc1 L_pk_far13
  buffer_store_dwordx4 v[108:111], v5, s[28:31], s51 offen offset:0
  buffer_store_dwordx4 v[108:111], v5, s[28:31], s51 offen offset:3584
L_pk_near13:
  s_add_u32 s51, s51, 7168
  v_exp_f32 v40, v40
  v_cvt_pk_bf16_f32 v67, v38, v39
  v_exp_f32 v41, v41
  v_exp_f32 v42, v42
  v_exp_f32 v43, v43
  v_exp_f32 v44, v44
  s_waitcnt lgkmcnt(4)
  v_mfma_f32_32x32x16_bf16 v[16:31], v[88:91], v[64:67], v[16:31]
  v_cvt_pk_bf16_f32 v68, v40, v41
  v_exp_f32 v45, v45
  v_cvt_pk_bf16_f32 v69, v42, v43
  v_exp_f32 v46, v46
  v_exp_f32 v47, v47
  v_cvt_pk_bf16_f32 v70, v44, v45
  v_cvt_pk_bf16_f32 v71, v46, v47
  s_setprio 0
  s_waitcnt lgkmcnt(2)
  v_mfma_f32_32x32x16_bf16 v[32:47], v[72:75], v[8:11], 0
  ds_read_b128 v[80:83], v106 offset:12288
  ds_read_b128 v[84:87], v106 offset:13312
  v_exp_f32 v48, v48
  v_exp_f32 v49, v49
  v_exp_f32 v50, v50
  v_exp_f32 v51, v51
  v_exp_f32 v52, v52
  v_mfma_f32_32x32x16_bf16 v[16:31], v[92:95], v[68:71], v[16:31]
  ds_read_b128 v[88:91], v106 offset:10240
  ds_read_b128 v[92:95], v106 offset:11264
  v_cvt_pk_bf16_f32 v64, v48, v49
  v_exp_f32 v53, v53
  v_cvt_pk_bf16_f32 v65, v50, v51
  v_exp_f32 v54, v54
  v_exp_f32 v55, v55
  v_cvt_pk_bf16_f32 v66, v52, v53
  v_mfma_f32_32x32x16_bf16 v[32:47], v[76:79], v[12:15], v[32:47]
  s_cmp_lg_u32 s49, 0
  s_cbranch_scc1 L_pk_far14
  buffer_store_dwordx4 v[108:111], v5, s[28:31], s51 offen offset:0
  buffer_store_dwordx4 v[108:111], v5, s[28:31], s51 offen offset:3584
L_pk_near14:
  s_add_u32 s51, s51, 7168
  v_exp_f32 v56, v56
  v_cvt_pk_bf16_f32 v67, v54, v55
  v_exp_f32 v57, v57
  v_exp_f32 v58, v58
  v_exp_f32 v59, v59
  v_exp_f32 v60, v60
  s_waitcnt lgkmcnt(4)
  v_mfma_f32_32x32x16_bf16 v[16:31], v[96:99], v[64:67], v[16:31]
  v_cvt_pk_bf16_f32 v68, v56, v57
  v_exp_f32 v61, v61
  v_cvt_pk_bf16_f32 v69, v58, v59
  v_exp_f32 v62, v62
  v_exp_f32 v63, v63
  v_cvt_pk_bf16_f32 v70, v60, v61
  v_cvt_pk_bf16_f32 v71, v62, v63
  s_barrier
  s_setprio 3
  s_waitcnt lgkmcnt(2)
  v_mfma_f32_32x32x16_bf16 v[48:63], v[80:83], v[8:11], 0
  ds_read_b128 v[72:75], v106 offset:32768
  ds_read_b128 v[76:79], v106 offset:33792
  v_exp_f32 v32, v32
  v_exp_f32 v33, v33
  v_exp_f32 v34, v34
  v_exp_f32 v35, v35
  v_exp_f32 v36, v36
  v_mfma_f32_32x32x16_bf16 v[16:31], v[100:103], v[68:71], v[16:31]
  ds_read_b128 v[96:99], v106 offset:14336
  ds_read_b128 v[100:103], v106 offset:15360
  v_cvt_pk_bf16_f32 v64, v32, v33
  v_exp_f32 v37, v37
  v_cvt_pk_bf16_f32 v65, v34, v35
  v_exp_f32 v38, v38
  v_exp_f32 v39, v39
  v_cvt_pk_bf16_f32 v66, v36, v37
  v_mfma_f32_32x32x16_bf16 v[48:63], v[84:87], v[12:15], v[48:63]
  s_cmp_lg_u32 s49, 0
  s_cbranch_scc1 L_pk_far15
  buffer_store_dwordx4 v[108:111], v5, s[28:31], s51 offen offset:0
  buffer_store_dwordx4 v[108:111], v5, s[28:31], s51 offen offset:3584
L_pk_near15:
  s_add_u32 s51, s51, 7168
  v_exp_f32 v40, v40
  v_cvt_pk_bf16_f32 v67, v38, v39
  v_exp_f32 v41, v41
  v_exp_f32 v42, v42
  v_exp_f32 v43, v43
  v_exp_f32 v44, v44
  s_waitcnt lgkmcnt(4)
  v_mfma_f32_32x32x16_bf16 v[16:31], v[88:91], v[64:67], v[16:31]
  v_cvt_pk_bf16_f32 v68, v40, v41
  v_exp_f32 v45, v45
  v_cvt_pk_bf16_f32 v69, v42, v43
  v_exp_f32 v46, v46
  v_exp_f32 v47, v47
  v_cvt_pk_bf16_f32 v70, v44, v45
  v_cvt_pk_bf16_f32 v71, v46, v47
  s_setprio 2
  s_waitcnt lgkmcnt(2)
  v_mfma_f32_32x32x16_bf16 v[32:47], v[72:75], v[8:11], 0
  ds_read_b128 v[80:83], v106 offset:36864
  ds_read_b128 v[84:87], v106 offset:37888
  v_exp_f32 v48, v48
  v_exp_f32 v49, v49
  v_exp_f32 v50, v50
  v_exp_f32 v51, v51
  v_exp_f32 v52, v52
  v_mfma_f32_32x32x16_bf16 v[16:31], v[92:95], v[68:71], v[16:31]
  ds_read_b128 v[88:91], v106 offset:34816
  ds_read_b128 v[92:95], v106 offset:35840
  v_cvt_pk_bf16_f32 v64, v48, v49
  v_exp_f32 v53, v53
  v_cvt_pk_bf16_f32 v65, v50, v51
  v_exp_f32 v54, v54
  v_exp_f32 v55, v55
  v_cvt_pk_bf16_f32 v66, v52, v53
  v_mfma_f32_32x32x16_bf16 v[32:47], v[76:79], v[12:15], v[32:47]
  s_cmp_lg_u32 s49, 0
  s_cbranch_scc1 L_pk_far16
  buffer_store_dwordx4 v[108:111], v5, s[28:31], s51 offen offset:0
  buffer_store_dwordx4 v[108:111], v5, s[28:31], s51 offen offset:3584
L_pk_near16:
  s_add_u32 s51, s51, 7168
  v_exp_f32 v56, v56
  v_cvt_pk_bf16_f32 v67, v54, v55
  v_exp_f32 v57, v57
  v_exp_f32 v58, v58
  v_exp_f32 v59, v59
  v_exp_f32 v60, v60
  s_waitcnt lgkmcnt(4)
  v_mfma_f32_32x32x16_bf16 v[16:31], v[96:99], v[64:67], v[16:31]
  v_cvt_pk_bf16_f32 v68, v56, v57
  v_exp_f32 v61, v61
  v_cvt_pk_bf16_f32 v69, v58, v59
  v_exp_f32 v62, v62
  v_exp_f32 v63, v63
  v_cvt_pk_bf16_f32 v70, v60, v61
  v_cvt_pk_bf16_f32 v71, v62, v63
  s_setprio 1
  s_waitcnt lgkmcnt(2)
  v_mfma_f32_32x32x16_bf16 v[48:63], v[80:83], v[8:11], 0
  ds_read_b128 v[72:75], v106 offset:40960
  ds_read_b128 v[76:79], v106 offset:41984
  v_exp_f32 v32, v32
  v_exp_f32 v33, v33
  v_exp_f32 v34, v34
  v_exp_f32 v35, v35
  v_exp_f32 v36, v36
  v_mfma_f32_32x32x16_bf16 v[16:31], v[100:103], v[68:71], v[16:31]
  ds_read_b128 v[96:99], v106 offset:38912
  ds_read_b128 v[100:103], v106 offset:39936
  v_cvt_pk_bf16_f32 v64, v32, v33
  v_exp_f32 v37, v37
  v_cvt_pk_bf16_f32 v65, v34, v35
  v_exp_f32 v38, v38
  v_exp_f32 v39, v39
  v_cvt_pk_bf16_f32 v66, v36, v37
  v_mfma_f32_32x32x16_bf16 v[48:63], v[84:87], v[12:15], v[48:63]
  s_cmp_lg_u32 s49, 0
  s_cbranch_scc1 L_pk_far17
  buffer_store_dwordx4 v[108:111], v5, s[28:31], s51 offen offset:0
  buffer_store_dwordx4 v[108:111], v5, s[28:31], s51 offen offset:3584
L_pk_near17:
  s_add_u32 s51, s51, 7168
  v_exp_f32 v40, v40
  v_cvt_pk_bf16_f32 v67, v38, v39
  v_exp_f32 v41, v41
  v_exp_f32 v42, v42
  v_exp_f32 v43, v43
  v_exp_f32 v44, v44
  s_waitcnt lgkmcnt(4)
  v_mfma_f32_32x32x16_bf16 v[16:31], v[88:91], v[64:67], v[16:31]
  v_cvt_pk_bf16_f32 v68, v40, v41
  v_exp_f32 v45, v45
  v_cvt_pk_bf16_f32 v69, v42, v43
  v_exp_f32 v46, v46
  v_exp_f32 v47, v47
  v_cvt_pk_bf16_f32 v70, v44, v45
  v_cvt_pk_bf16_f32 v71, v46, v47
  s_setprio 0
  s_waitcnt lgkmcnt(2)
  v_mfma_f32_32x32x16_bf16 v[32:47], v[72:75], v[8:11], 0
  ds_read_b128 v[80:83], v106 offset:45056
  ds_read_b128 v[84:87], v106 offset:46080
  v_exp_f32 v48, v48
  v_exp_f32 v49, v49
  v_exp_f32 v50, v50
  v_exp_f32 v51, v51
  v_exp_f32 v52, v52
  v_mfma_f32_32x32x16_bf16 v[16:31], v[92:95], v[68:71], v[16:31]
  ds_read_b128 v[88:91], v106 offset:43008
  ds_read_b128 v[92:95], v106 offset:44032
  v_cvt_pk_bf16_f32 v64, v48, v49
  v_exp_f32 v53, v53
  v_cvt_pk_bf16_f32 v65, v50, v51
  v_exp_f32 v54, v54
  v_exp_f32 v55, v55
  v_cvt_pk_bf16_f32 v66, v52, v53
  v_mfma_f32_32x32x16_bf16 v[32:47], v[76:79], v[12:15], v[32:47]
  s_cmp_lg_u32 s49, 0
  s_cbranch_scc1 L_pk_far18
  buffer_store_dwordx4 v[108:111], v5, s[28:31], s51 offen offset:0
  buffer_store_dwordx4 v[108:111], v5, s[28:31], s51 offen offset:3584
L_pk_near18:
  s_add_u32 s51, s51, 7168
  v_exp_f32 v56, v56
  v_cvt_pk_bf16_f32 v67, v54, v55
  v_exp_f32 v57, v57
  v_exp_f32 v58, v58
  v_exp_f32 v59, v59
  v_exp_f32 v60, v60
  s_waitcnt lgkmcnt(4)
  v_mfma_f32_32x32x16_bf16 v[16:31], v[96:99], v[64:67], v[16:31]
  v_cvt_pk_bf16_f32 v68, v56, v57
  v_exp_f32 v61, v61
  v_cvt_pk_bf16_f32 v69, v58, v59
  v_exp_f32 v62, v62
  v_exp_f32 v63, v63
  v_cvt_pk_bf16_f32 v70, v60, v61
  v_cvt_pk_bf16_f32 v71, v62, v63
  s_barrier
  s_setprio 3
  s_waitcnt lgkmcnt(2)
  v_mfma_f32_32x32x16_bf16 v[48:63], v[80:83], v[8:11], 0
  ds_read_b128 v[72:75], v105 offset:0
  ds_read_b128 v[76:79], v105 offset:1024
  v_exp_f32 v32, v32
  v_exp_f32 v33, v33
  v_exp_f32 v34, v34
  v_exp_f32 v35, v35
  v_exp_f32 v36, v36
  v_mfma_f32_32x32x16_bf16 v[16:31], v[100:103], v[68:71], v[16:31]
  ds_read_b128 v[96:99], v106 offset:47104
  ds_read_b128 v[100:103], v106 offset:48128
  v_cvt_pk_bf16_f32 v64, v32, v33
  v_exp_f32 v37, v37
  v_cvt_pk_bf16_f32 v65, v34, v35
  v_exp_f32 v38, v38
  v_exp_f32 v39, v39
  v_cvt_pk_bf16_f32 v66, v36, v37
  v_mfma_f32_32x32x16_bf16 v[48:63], v[84:87], v[12:15], v[48:63]
  buffer_load_dwordx4 v[112:115], v104, s[52:55], s45 offen offset:0 sc1
  v_exp_f32 v40, v40
  v_cvt_pk_bf16_f32 v67, v38, v39
  v_exp_f32 v41, v41
  v_exp_f32 v42, v42
  v_exp_f32 v43, v43
  v_exp_f32 v44, v44
  s_waitcnt lgkmcnt(4)
  v_mfma_f32_32x32x16_bf16 v[16:31], v[88:91], v[64:67], v[16:31]
  buffer_load_dwordx4 v[116:119], v104, s[52:55], s45 offen offset:1024 sc1
  v_cvt_pk_bf16_f32 v68, v40, v41
  v_exp_f32 v45, v45
  v_cvt_pk_bf16_f32 v69, v42, v43
  v_exp_f32 v46, v46
  v_exp_f32 v47, v47
  v_cvt_pk_bf16_f32 v70, v44, v45
  v_cvt_pk_bf16_f32 v71, v46, v47
  s_setprio 2
  s_waitcnt lgkmcnt(2)
  v_mfma_f32_32x32x16_bf16 v[32:47], v[72:75], v[8:11], 0
  ds_read_b128 v[80:83], v105 offset:4096
  ds_read_b128 v[84:87], v105 offset:5120
  v_exp_f32 v48, v48
  v_exp_f32 v49, v49
  v_exp_f32 v50, v50
  v_exp_f32 v51, v51
  v_exp_f32 v52, v52
  v_mfma_f32_32x32x16_bf16 v[16:31], v[92:95], v[68:71], v[16:31]
  ds_read_b128 v[88:91], v105 offset:2048
  ds_read_b128 v[92:95], v105 offset:3072
  v_cvt_pk_bf16_f32 v64, v48, v49
  v_exp_f32 v53, v53
  v_cvt_pk_bf16_f32 v65, v50, v51
  v_exp_f32 v54, v54
  v_exp_f32 v55, v55
  v_cvt_pk_bf16_f32 v66, v52, v53
  v_mfma_f32_32x32x16_bf16 v[32:47], v[76:79], v[12:15], v[32:47]
  buffer_load_dwordx4 v[120:123], v104, s[52:55], s45 offen offset:2048 sc1
  v_exp_f32 v56, v56
  v_cvt_pk_bf16_f32 v67, v54, v55
  v_exp_f32 v57, v57
  v_exp_f32 v58, v58
  v_exp_f32 v59, v59
  v_exp_f32 v60, v60
  s_waitcnt lgkmcnt(4)
  v_mfma_f32_32x32x16_bf16 v[16:31], v[96:99], v[64:67], v[16:31]
  buffer_load_dwordx4 v[124:127], v104, s[52:55], s45 offen offset:3072 sc1
  v_cvt_pk_bf16_f32 v68, v56, v57
  v_exp_f32 v61, v61
  v_cvt_pk_bf16_f32 v69, v58, v59
  v_exp_f32 v62, v62
  v_exp_f32 v63, v63
  v_cvt_pk_bf16_f32 v70, v60, v61
  v_cvt_pk_bf16_f32 v71, v62, v63
  s_setprio 1
  s_waitcnt lgkmcnt(2)
  v_mfma_f32_32x32x16_bf16 v[48:63], v[80:83], v[8:11], 0
  ds_read_b128 v[72:75], v105 offset:8192
  ds_read_b128 v[76:79], v105 offset:9216
  v_exp_f32 v32, v32
  v_exp_f32 v33, v33
  v_exp_f32 v34, v34
  v_exp_f32 v35, v35
  v_exp_f32 v36, v36
  v_mfma_f32_32x32x16_bf16 v[16:31], v[100:103], v[68:71], v[16:31]
  ds_read_b128 v[96:99], v105 offset:6144
  ds_read_b128 v[100:103], v105 offset:7168
  v_cvt_pk_bf16_f32 v64, v32, v33
L_wm_P8:
  s_cbranch_execz L_wm_P9
  v_exp_f32 v37, v37
  v_cvt_pk_bf16_f32 v65, v34, v35
  v_exp_f32 v38, v38
  v_exp_f32 v39, v39
  v_cvt_pk_bf16_f32 v66, v36, v37
  v_mfma_f32_32x32x16_bf16 v[48:63], v[84:87], v[12:15], v[48:63]
  s_add_u32 s45, s45, 4096
  buffer_load_dwordx4 v[128:131], v104, s[52:55], s45 offen offset:0 sc1
  v_exp_f32 v40, v40
  v_cvt_pk_bf16_f32 v67, v38, v39
  v_exp_f32 v41, v41
  v_exp_f32 v42, v42
  v_exp_f32 v43, v43
  v_exp_f32 v44, v44
  s_waitcnt lgkmcnt(4)
  v_mfma_f32_32x32x16_bf16 v[16:31], v[88:91], v[64:67], v[16:31]
  v_cvt_pk_bf16_f32 v68, v40, v41
  v_exp_f32 v45, v45
  v_cvt_pk_bf16_f32 v69, v42, v43
  v_exp_f32 v46, v46
  v_exp_f32 v47, v47
  v_cvt_pk_bf16_f32 v70, v44, v45
  v_cvt_pk_bf16_f32 v71, v46, v47
  s_setprio 0
  s_waitcnt lgkmcnt(2)
  v_mfma_f32_32x32x16_bf16 v[32:47], v[72:75], v[8:11], 0
  ds_read_b128 v[80:83], v105 offset:12288
  ds_read_b128 v[84:87], v105 offset:13312
  v_exp_f32 v48, v48
  v_exp_f32 v49, v49
  v_exp_f32 v50, v50
  v_exp_f32 v51, v51
  v_exp_f32 v52, v52
  v_mfma_f32_32x32x16_bf16 v[16:31], v[92:95], v[68:71], v[16:31]
  ds_read_b128 v[88:91], v105 offset:10240
  ds_read_b128 v[92:95], v105 offset:11264
  v_cvt_pk_bf16_f32 v64, v48, v49
  v_exp_f32 v53, v53
  v_cvt_pk_bf16_f32 v65, v50, v51
  v_exp_f32 v54, v54
  v_exp_f32 v55, v55
  v_cvt_pk_bf16_f32 v66, v52, v53
  v_mfma_f32_32x32x16_bf16 v[32:47], v[76:79], v[12:15], v[32:47]
  buffer_load_dwordx4 v[132:135], v104, s[52:55], s45 offen offset:1024 sc1
  v_exp_f32 v56, v56
  v_cvt_pk_bf16_f32 v67, v54, v55
  v_exp_f32 v57, v57
  v_exp_f32 v58, v58
  v_exp_f32 v59, v59
  v_exp_f32 v60, v60
  s_waitcnt lgkmcnt(4)
  v_mfma_f32_32x32x16_bf16 v[16:31], v[96:99], v[64:67], v[16:31]
  buffer_load_dwordx4 v[136:139], v104, s[52:55], s45 offen offset:2048 sc1
  v_cvt_pk_bf16_f32 v68, v56, v57
  v_exp_f32 v61, v61
  v_cvt_pk_bf16_f32 v69, v58, v59
  v_exp_f32 v62, v62
  v_exp_f32 v63, v63
  v_cvt_pk_bf16_f32 v70, v60, v61
  v_cvt_pk_bf16_f32 v71, v62, v63
  s_barrier
  s_setprio 3
  s_waitcnt lgkmcnt(2)
  v_mfma_f32_32x32x16_bf16 v[48:63], v[80:83], v[8:11], 0
  ds_read_b128 v[72:75], v105 offset:32768
  ds_read_b128 v[76:79], v105 offset:33792
  v_exp_f32 v32, v32
  v_exp_f32 v33, v33
  v_exp_f32 v34, v34
  v_exp_f32 v35, v35
  v_exp_f32 v36, v36
  v_mfma_f32_32x32x16_bf16 v[16:31], v[100:103], v[68:71], v[16:31]
  ds_read_b128 v[96:99], v105 offset:14336
  ds_read_b128 v[100:103], v105 offset:15360
  v_cvt_pk_bf16_f32 v64, v32, v33
  v_exp_f32 v37, v37
  v_cvt_pk_bf16_f32 v65, v34, v35
  v_exp_f32 v38, v38
  v_exp_f32 v39, v39
  v_cvt_pk_bf16_f32 v66, v36, v37
  v_mfma_f32_32x32x16_bf16 v[48:63], v[84:87], v[12:15], v[48:63]
  buffer_load_dwordx4 v[140:143], v104, s[52:55], s45 offen offset:3072 sc1
  v_exp_f32 v40, v40
  v_cvt_pk_bf16_f32 v67, v38, v39
  v_exp_f32 v41, v41
  v_exp_f32 v42, v42
  v_exp_f32 v43, v43
  v_exp_f32 v44, v44
  s_waitcnt lgkmcnt(4)
  v_mfma_f32_32x32x16_bf16 v[16:31], v[88:91], v[64:67], v[16:31]
  v_cvt_pk_bf16_f32 v68, v40, v41
  v_exp_f32 v45, v45
  v_cvt_pk_bf16_f32 v69, v42, v43
  v_exp_f32 v46, v46
  v_exp_f32 v47, v47
  v_cvt_pk_bf16_f32 v70, v44, v45
  v_cvt_pk_bf16_f32 v71, v46, v47
  s_setprio 2
  s_waitcnt lgkmcnt(2)
  v_mfma_f32_32x32x16_bf16 v[32:47], v[72:75], v[8:11], 0
  ds_read_b128 v[80:83], v105 offset:36864
  ds_read_b128 v[84:87], v105 offset:37888
  v_exp_f32 v48, v48
  v_exp_f32 v49, v49
  v_exp_f32 v50, v50
  v_exp_f32 v51, v51
  v_exp_f32 v52, v52
  v_mfma_f32_32x32x16_bf16 v[16:31], v[92:95], v[68:71], v[16:31]
  ds_read_b128 v[88:91], v105 offset:34816
  ds_read_b128 v[92:95], v105 offset:35840
  v_cvt_pk_bf16_f32 v64, v48, v49
  v_exp_f32 v53, v53
  v_cvt_pk_bf16_f32 v65, v50, v51
  v_exp_f32 v54, v54
  v_exp_f32 v55, v55
  v_cvt_pk_bf16_f32 v66, v52, v53
  v_mfma_f32_32x32x16_bf16 v[32:47], v[76:79], v[12:15], v[32:47]
  s_add_u32 s45, s45, 4096
  buffer_load_dwordx4 v[144:147], v104, s[52:55], s45 offen offset:0 sc1
  v_exp_f32 v56, v56
  v_cvt_pk_bf16_f32 v67, v54, v55
  v_exp_f32 v57, v57
  v_exp_f32 v58, v58
  v_exp_f32 v59, v59
  v_exp_f32 v60, v60
  s_waitcnt lgkmcnt(4)
  v_mfma_f32_32x32x16_bf16 v[16:31], v[96:99], v[64:67], v[16:31]
  buffer_load_dwordx4 v[148:151], v104, s[52:55], s45 offen offset:1024 sc1
  v_cvt_pk_bf16_f32 v68, v56, v57
  v_exp_f32 v61, v61
  v_cvt_pk_bf16_f32 v69, v58, v59
  v_exp_f32 v62, v62
  v_exp_f32 v63, v63
  v_cvt_pk_bf16_f32 v70, v60, v61
  v_cvt_pk_bf16_f32 v71, v62, v63
  s_setprio 1
  s_waitcnt lgkmcnt(2)
  v_mfma_f32_32x32x16_bf16 v[48:63], v[80:83], v[8:11], 0
  ds_read_b128 v[72:75], v105 offset:40960
  ds_read_b128 v[76:79], v105 offset:41984
  v_exp_f32 v32, v32
  v_exp_f32 v33, v33
  v_exp_f32 v34, v34
  v_exp_f32 v35, v35
  v_exp_f32 v36, v36
  v_mfma_f32_32x32x16_bf16 v[16:31], v[100:103], v[68:71], v[16:31]
  ds_read_b128 v[96:99], v105 offset:38912
  ds_read_b128 v[100:103], v105 offset:39936
  v_cvt_pk_bf16_f32 v64, v32, v33
  v_exp_f32 v37, v37
  v_cvt_pk_bf16_f32 v65, v34, v35
  v_exp_f32 v38, v38
  v_exp_f32 v39, v39
  v_cvt_pk_bf16_f32 v66, v36, v37
  v_mfma_f32_32x32x16_bf16 v[48:63], v[84:87], v[12:15], v[48:63]
  buffer_load_dwordx4 v[152:155], v104, s[52:55], s45 offen offset:2048 sc1
  v_exp_f32 v40, v40
  v_cvt_pk_bf16_f32 v67, v38, v39
  v_exp_f32 v41, v41
  v_exp_f32 v42, v42
  v_exp_f32 v43, v43
  v_exp_f32 v44, v44
  s_waitcnt lgkmcnt(4)
  v_mfma_f32_32x32x16_bf16 v[16:31], v[88:91], v[64:67], v[16:31]
  v_cvt_pk_bf16_f32 v68, v40, v41
  v_exp_f32 v45, v45
  v_cvt_pk_bf16_f32 v69, v42, v43
  v_exp_f32 v46, v46
  v_exp_f32 v47, v47
  v_cvt_pk_bf16_f32 v70, v44, v45
  v_cvt_pk_bf16_f32 v71, v46, v47
  s_setprio 0
  s_waitcnt lgkmcnt(2)
  v_mfma_f32_32x32x16_bf16 v[32:47], v[72:75], v[8:11], 0
  ds_read_b128 v[80:83], v105 offset:45056
  ds_read_b128 v[84:87], v105 offset:46080
  v_exp_f32 v48, v48
  v_exp_f32 v49, v49
  v_exp_f32 v50, v50
  v_exp_f32 v51, v51
  v_exp_f32 v52, v52
  v_mfma_f32_32x32x16_bf16 v[16:31], v[92:95], v[68:71], v[16:31]
  ds_read_b128 v[88:91], v105 offset:43008
  ds_read_b128 v[92:95], v105 offset:44032
  v_cvt_pk_bf16_f32 v64, v48, v49
  v_exp_f32 v53, v53
  v_cvt_pk_bf16_f32 v65, v50, v51
  v_exp_f32 v54, v54
  v_exp_f32 v55, v55
  v_cvt_pk_bf16_f32 v66, v52, v53
  v_mfma_f32_32x32x16_bf16 v[32:47], v[76:79], v[12:15], v[32:47]
  buffer_load_dwordx4 v[156:159], v104, s[52:55], s45 offen offset:3072 sc1
  v_exp_f32 v56, v56
  v_cvt_pk_bf16_f32 v67, v54, v55
  v_exp_f32 v57, v57
  v_exp_f32 v58, v58
  v_exp_f32 v59, v59
  v_exp_f32 v60, v60
  s_waitcnt lgkmcnt(4)
  v_mfma_f32_32x32x16_bf16 v[16:31], v[96:99], v[64:67], v[16:31]
  s_add_u32 s45, s45, 4096
  buffer_load_dwordx4 v[160:163], v104, s[52:55], s45 offen offset:0 sc1
  v_cvt_pk_bf16_f32 v68, v56, v57
  v_exp_f32 v61, v61
  v_cvt_pk_bf16_f32 v69, v58, v59
  v_exp_f32 v62, v62
  v_exp_f32 v63, v63
  v_cvt_pk_bf16_f32 v70, v60, v61
  v_cvt_pk_bf16_f32 v71, v62, v63
  s_barrier
  s_setprio 3
  s_waitcnt lgkmcnt(2)
  v_mfma_f32_32x32x16_bf16 v[48:63], v[80:83], v[8:11], 0
  ds_read_b128 v[72:75], v106 offset:0
  ds_read_b128 v[76:79], v106 offset:1024
  v_exp_f32 v32, v32
  v_exp_f32 v33, v33
  v_exp_f32 v34, v34
  v_exp_f32 v35, v35
  v_exp_f32 v36, v36
  v_mfma_f32_32x32x16_bf16 v[16:31], v[100:103], v[68:71], v[16:31]
  ds_read_b128 v[96:99], v105 offset:47104
  ds_read_b128 v[100:103], v105 offset:48128
  v_cvt_pk_bf16_f32 v64, v32, v33
  v_exp_f32 v37, v37
  v_cvt_pk_bf16_f32 v65, v34, v35
  v_exp_f32 v38, v38
  v_exp_f32 v39, v39
  v_cvt_pk_bf16_f32 v66, v36, v37
  v_mfma_f32_32x32x16_bf16 v[48:63], v[84:87], v[12:15], v[48:63]
  buffer_load_dwordx4 v[164:167], v104, s[52:55], s45 offen offset:1024 sc1
  v_exp_f32 v40, v40
  v_cvt_pk_bf16_f32 v67, v38, v39
  v_exp_f32 v41, v41
  v_exp_f32 v42, v42
  v_exp_f32 v43, v43
  v_exp_f32 v44, v44
  s_waitcnt lgkmcnt(4)
  v_mfma_f32_32x32x16_bf16 v[16:31], v[88:91], v[64:67], v[16:31]
  v_cvt_pk_bf16_f32 v68, v40, v41
  v_exp_f32 v45, v45
  v_cvt_pk_bf16_f32 v69, v42, v43
  v_exp_f32 v46, v46
  v_exp_f32 v47, v47
  v_cvt_pk_bf16_f32 v70, v44, v45
  v_cvt_pk_bf16_f32 v71, v46, v47
  s_setprio 2
  s_waitcnt lgkmcnt(2)
  v_mfma_f32_32x32x16_bf16 v[32:47], v[72:75], v[8:11], 0
  ds_read_b128 v[80:83], v106 offset:4096
  ds_read_b128 v[84:87], v106 offset:5120
  v_exp_f32 v48, v48
  v_exp_f32 v49, v49
  v_exp_f32 v50, v50
  v_exp_f32 v51, v51
  v_exp_f32 v52, v52
  v_mfma_f32_32x32x16_bf16 v[16:31], v[92:95], v[68:71], v[16:31]
  ds_read_b128 v[88:91], v106 offset:2048
  ds_read_b128 v[92:95], v106 offset:3072
  v_cvt_pk_bf16_f32 v64, v48, v49
  v_exp_f32 v53, v53
  v_cvt_pk_bf16_f32 v65, v50, v51
  v_exp_f32 v54, v54
  v_exp_f32 v55, v55
  v_cvt_pk_bf16_f32 v66, v52, v53
  v_mfma_f32_32x32x16_bf16 v[32:47], v[76:79], v[12:15], v[32:47]
  buffer_load_dwordx4 v[168:171], v104, s[52:55], s45 offen offset:2048 sc1
  v_exp_f32 v56, v56
  v_cvt_pk_bf16_f32 v67, v54, v55
  v_exp_f32 v57, v57
  v_exp_f32 v58, v58
  v_exp_f32 v59, v59
  v_exp_f32 v60, v60
  s_waitcnt lgkmcnt(4)
  v_mfma_f32_32x32x16_bf16 v[16:31], v[96:99], v[64:67], v[16:31]
  buffer_load_dwordx4 v[172:175], v104, s[52:55], s45 offen offset:3072 sc1
  v_cvt_pk_bf16_f32 v68, v56, v57
  v_exp_f32 v61, v61
  v_cvt_pk_bf16_f32 v69, v58, v59
  v_exp_f32 v62, v62
  v_exp_f32 v63, v63
  v_cvt_pk_bf16_f32 v70, v60, v61
  v_cvt_pk_bf16_f32 v71, v62, v63
  s_setprio 1
  s_waitcnt lgkmcnt(2)
  v_mfma_f32_32x32x16_bf16 v[48:63], v[80:83], v[8:11], 0
  ds_read_b128 v[72:75], v106 offset:8192
  ds_read_b128 v[76:79], v106 offset:9216
  v_exp_f32 v32, v32
  v_exp_f32 v33, v33
  v_exp_f32 v34, v34
  v_exp_f32 v35, v35
  v_exp_f32 v36, v36
  v_mfma_f32_32x32x16_bf16 v[16:31], v[100:103], v[68:71], v[16:31]
  ds_read_b128 v[96:99], v106 offset:6144
  ds_read_b128 v[100:103], v106 offset:7168
  v_cvt_pk_bf16_f32 v64, v32, v33
  v_exp_f32 v37, v37
  v_cvt_pk_bf16_f32 v65, v34, v35
  v_exp_f32 v38, v38
  v_exp_f32 v39, v39
  v_cvt_pk_bf16_f32 v66, v36, v37
  v_mfma_f32_32x32x16_bf16 v[48:63], v[84:87], v[12:15], v[48:63]
  s_add_u32 s45, s45, 4096
  buffer_load_dwordx4 v[176:179], v104, s[52:55], s45 offen offset:0 sc1
  v_exp_f32 v40, v40
  v_cvt_pk_bf16_f32 v67, v38, v39
  v_exp_f32 v41, v41
  v_exp_f32 v42, v42
  v_exp_f32 v43, v43
  v_exp_f32 v44, v44
  s_waitcnt lgkmcnt(4)
  v_mfma_f32_32x32x16_bf16 v[16:31], v[88:91], v[64:67], v[16:31]
  buffer_load_dwordx4 v[180:183], v104, s[52:55], s45 offen offset:1024 sc1
  v_cvt_pk_bf16_f32 v68, v40, v41
  v_exp_f32 v45, v45
  v_cvt_pk_bf16_f32 v69, v42, v43
  v_exp_f32 v46, v46
  v_exp_f32 v47, v47
  v_cvt_pk_bf16_f32 v70, v44, v45
  v_cvt_pk_bf16_f32 v71, v46, v47
  s_setprio 0
  s_waitcnt lgkmcnt(2)
  v_mfma_f32_32x32x16_bf16 v[32:47], v[72:75], v[8:11], 0
  ds_read_b128 v[80:83], v106 offset:12288
  ds_read_b128 v[84:87], v106 offset:13312
  v_exp_f32 v48, v48
  v_exp_f32 v49, v49
  v_exp_f32 v50, v50
  v_exp_f32 v51, v51
  v_exp_f32 v52, v52
  v_mfma_f32_32x32x16_bf16 v[16:31], v[92:95], v[68:71], v[16:31]
  ds_read_b128 v[88:91], v106 offset:10240
  ds_read_b128 v[92:95], v106 offset:11264
  v_cvt_pk_bf16_f32 v64, v48, v49
  v_exp_f32 v53, v53
  v_cvt_pk_bf16_f32 v65, v50, v51
  v_exp_f32 v54, v54
  v_exp_f32 v55, v55
  v_cvt_pk_bf16_f32 v66, v52, v53
  v_mfma_f32_32x32x16_bf16 v[32:47], v[76:79], v[12:15], v[32:47]
  buffer_load_dwordx4 v[184:187], v104, s[52:55], s45 offen offset:2048 sc1
  v_exp_f32 v56, v56
  v_cvt_pk_bf16_f32 v67, v54, v55
  v_exp_f32 v57, v57
  v_exp_f32 v58, v58
  v_exp_f32 v59, v59
  v_exp_f32 v60, v60
  s_waitcnt lgkmcnt(4)
  v_mfma_f32_32x32x16_bf16 v[16:31], v[96:99], v[64:67], v[16:31]
  v_cvt_pk_bf16_f32 v68, v56, v57
  v_exp_f32 v61, v61
  v_cvt_pk_bf16_f32 v69, v58, v59
  v_exp_f32 v62, v62
  v_exp_f32 v63, v63
  v_cvt_pk_bf16_f32 v70, v60, v61
  v_cvt_pk_bf16_f32 v71, v62, v63
  s_barrier
  s_setprio 3
  s_waitcnt lgkmcnt(2)
  v_mfma_f32_32x32x16_bf16 v[48:63], v[80:83], v[8:11], 0
  ds_read_b128 v[72:75], v106 offset:32768
  ds_read_b128 v[76:79], v106 offset:33792
  v_exp_f32 v32, v32
  v_exp_f32 v33, v33
  v_exp_f32 v34, v34
  v_exp_f32 v35, v35
  v_exp_f32 v36, v36
  v_mfma_f32_32x32x16_bf16 v[16:31], v[100:103], v[68:71], v[16:31]
  ds_read_b128 v[96:99], v106 offset:14336
  ds_read_b128 v[100:103], v106 offset:15360
  v_cvt_pk_bf16_f32 v64, v32, v33
  v_exp_f32 v37, v37
  v_cvt_pk_bf16_f32 v65, v34, v35
  v_exp_f32 v38, v38
  v_exp_f32 v39, v39
  v_cvt_pk_bf16_f32 v66, v36, v37
  v_mfma_f32_32x32x16_bf16 v[48:63], v[84:87], v[12:15], v[48:63]
  buffer_load_dwordx4 v[188:191], v104, s[52:55], s45 offen offset:3072 sc1
  v_exp_f32 v40, v40
  v_cvt_pk_bf16_f32 v67, v38, v39
  v_exp_f32 v41, v41
  v_exp_f32 v42, v42
  v_exp_f32 v43, v43
  v_exp_f32 v44, v44
  s_waitcnt lgkmcnt(4)
  v_mfma_f32_32x32x16_bf16 v[16:31], v[88:91], v[64:67], v[16:31]
  s_add_u32 s45, s45, 4096
  buffer_load_dwordx4 v[192:195], v104, s[52:55], s45 offen offset:0 sc1
  v_cvt_pk_bf16_f32 v68, v40, v41
  v_exp_f32 v45, v45
  v_cvt_pk_bf16_f32 v69, v42, v43
  v_exp_f32 v46, v46
  v_exp_f32 v47, v47
  v_cvt_pk_bf16_f32 v70, v44, v45
  v_cvt_pk_bf16_f32 v71, v46, v47
  s_setprio 2
  s_waitcnt lgkmcnt(2)
  v_mfma_f32_32x32x16_bf16 v[32:47], v[72:75], v[8:11], 0
  ds_read_b128 v[80:83], v106 offset:36864
  ds_read_b128 v[84:87], v106 offset:37888
  v_exp_f32 v48, v48
  v_exp_f32 v49, v49
  v_exp_f32 v50, v50
  v_exp_f32 v51, v51
  v_exp_f32 v52, v52
  v_mfma_f32_32x32x16_bf16 v[16:31], v[92:95], v[68:71], v[16:31]
  ds_read_b128 v[88:91], v106 offset:34816
  ds_read_b128 v[92:95], v106 offset:35840
  v_cvt_pk_bf16_f32 v64, v48, v49
  v_exp_f32 v53, v53
  v_cvt_pk_bf16_f32 v65, v50, v51
  v_exp_f32 v54, v54
  v_exp_f32 v55, v55
  v_cvt_pk_bf16_f32 v66, v52, v53
  v_mfma_f32_32x32x16_bf16 v[32:47], v[76:79], v[12:15], v[32:47]
  buffer_load_dwordx4 v[196:199], v104, s[52:55], s45 offen offset:1024 sc1
  v_exp_f32 v56, v56
  v_cvt_pk_bf16_f32 v67, v54, v55
  v_exp_f32 v57, v57
  v_exp_f32 v58, v58
  v_exp_f32 v59, v59
  v_exp_f32 v60, v60
  s_waitcnt lgkmcnt(4)
  v_mfma_f32_32x32x16_bf16 v[16:31], v[96:99], v[64:67], v[16:31]
  v_cvt_pk_bf16_f32 v68, v56, v57
  v_exp_f32 v61, v61
  v_cvt_pk_bf16_f32 v69, v58, v59
  v_exp_f32 v62, v62
  v_exp_f32 v63, v63
  v_cvt_pk_bf16_f32 v70, v60, v61
  v_cvt_pk_bf16_f32 v71, v62, v63
  s_setprio 2
  s_waitcnt lgkmcnt(2)
  v_mfma_f32_32x32x16_bf16 v[48:63], v[80:83], v[8:11], 0
  ds_read_b128 v[72:75], v106 offset:40960
  ds_read_b128 v[76:79], v106 offset:41984
  v_exp_f32 v32, v32
  v_exp_f32 v33, v33
  v_exp_f32 v34, v34
  v_exp_f32 v35, v35
  v_exp_f32 v36, v36
  v_mfma_f32_32x32x16_bf16 v[16:31], v[100:103], v[68:71], v[16:31]
  ds_read_b128 v[96:99], v106 offset:38912
  ds_read_b128 v[100:103], v106 offset:39936
  v_cvt_pk_bf16_f32 v64, v32, v33
  v_exp_f32 v37, v37
  v_cvt_pk_bf16_f32 v65, v34, v35
  v_exp_f32 v38, v38
  v_exp_f32 v39, v39
  v_cvt_pk_bf16_f32 v66, v36, v37
  v_mfma_f32_32x32x16_bf16 v[48:63], v[84:87], v[12:15], v[48:63]
  buffer_load_dwordx4 v[200:203], v104, s[52:55], s45 offen offset:2048 sc1
  v_exp_f32 v40, v40
  v_cvt_pk_bf16_f32 v67, v38, v39
  v_exp_f32 v41, v41
  v_exp_f32 v42, v42
  v_exp_f32 v43, v43
  v_exp_f32 v44, v44
  s_waitcnt lgkmcnt(4)
  v_mfma_f32_32x32x16_bf16 v[16:31], v[88:91], v[64:67], v[16:31]
  buffer_load_dwordx4 v[204:207], v104, s[52:55], s45 offen offset:3072 sc1
  v_cvt_pk_bf16_f32 v68, v40, v41
  v_exp_f32 v45, v45
  v_cvt_pk_bf16_f32 v69, v42, v43
  v_exp_f32 v46, v46
  v_exp_f32 v47, v47
  v_cvt_pk_bf16_f32 v70, v44, v45
  v_cvt_pk_bf16_f32 v71, v46, v47
  s_setprio 1
  s_waitcnt lgkmcnt(2)
  v_mfma_f32_32x32x16_bf16 v[32:47], v[72:75], v[8:11], 0
  ds_read_b128 v[80:83], v106 offset:45056
  ds_read_b128 v[84:87], v106 offset:46080
  v_exp_f32 v48, v48
  v_exp_f32 v49, v49
  v_exp_f32 v50, v50
  v_exp_f32 v51, v51
  v_exp_f32 v52, v52
  v_mfma_f32_32x32x16_bf16 v[16:31], v[92:95], v[68:71], v[16:31]
  ds_read_b128 v[88:91], v106 offset:43008
  ds_read_b128 v[92:95], v106 offset:44032
  v_cvt_pk_bf16_f32 v64, v48, v49
  v_exp_f32 v53, v53
  v_cvt_pk_bf16_f32 v65, v50, v51
  v_exp_f32 v54, v54
  v_exp_f32 v55, v55
  v_cvt_pk_bf16_f32 v66, v52, v53
  v_mfma_f32_32x32x16_bf16 v[32:47], v[76:79], v[12:15], v[32:47]
  s_add_u32 s45, s45, 4096
  buffer_load_dwordx4 v[208:211], v104, s[52:55], s45 offen offset:0 sc1
  v_exp_f32 v56, v56
  v_cvt_pk_bf16_f32 v67, v54, v55
  v_exp_f32 v57, v57
  v_exp_f32 v58, v58
  v_exp_f32 v59, v59
  v_exp_f32 v60, v60
  s_waitcnt lgkmcnt(4)
  v_mfma_f32_32x32x16_bf16 v[16:31], v[96:99], v[64:67], v[16:31]
  v_cvt_pk_bf16_f32 v68, v56, v57
  v_exp_f32 v61, v61
  v_cvt_pk_bf16_f32 v69, v58, v59
  v_exp_f32 v62, v62
  v_exp_f32 v63, v63
  v_cvt_pk_bf16_f32 v70, v60, v61
  v_cvt_pk_bf16_f32 v71, v62, v63
  s_setprio 1
  s_waitcnt lgkmcnt(2)
  v_mfma_f32_32x32x16_bf16 v[48:63], v[80:83], v[8:11], 0
  v_exp_f32 v32, v32
  v_exp_f32 v33, v33
  v_exp_f32 v34, v34
  v_exp_f32 v35, v35
  v_exp_f32 v36, v36
  v_mfma_f32_32x32x16_bf16 v[16:31], v[100:103], v[68:71], v[16:31]
  ds_read_b128 v[96:99], v106 offset:47104
  ds_read_b128 v[100:103], v106 offset:48128
  v_cvt_pk_bf16_f32 v64, v32, v33
  v_exp_f32 v37, v37
  v_cvt_pk_bf16_f32 v65, v34, v35
  v_exp_f32 v38, v38
  v_exp_f32 v39, v39
  v_cvt_pk_bf16_f32 v66, v36, v37
  v_mfma_f32_32x32x16_bf16 v[48:63], v[84:87], v[12:15], v[48:63]
  buffer_load_dwordx4 v[212:215], v104, s[52:55], s45 offen offset:1024 sc1
  v_exp_f32 v40, v40
  v_cvt_pk_bf16_f32 v67, v38, v39
  v_exp_f32 v41, v41
  v_exp_f32 v42, v42
  v_exp_f32 v43, v43
  v_exp_f32 v44, v44
  s_waitcnt lgkmcnt(2)
  v_mfma_f32_32x32x16_bf16 v[16:31], v[88:91], v[64:67], v[16:31]
  buffer_load_dwordx4 v[216:219], v104, s[52:55], s45 offen offset:2048 sc1
  v_cvt_pk_bf16_f32 v68, v40, v41
  v_exp_f32 v45, v45
  v_cvt_pk_bf16_f32 v69, v42, v43
  v_exp_f32 v46, v46
  v_exp_f32 v47, v47
  v_cvt_pk_bf16_f32 v70, v44, v45
  v_cvt_pk_bf16_f32 v71, v46, v47
  s_setprio 0
  v_exp_f32 v48, v48
  v_exp_f32 v49, v49
  v_exp_f32 v50, v50
  v_exp_f32 v51, v51
  v_exp_f32 v52, v52
  v_mfma_f32_32x32x16_bf16 v[16:31], v[92:95], v[68:71], v[16:31]
  v_cvt_pk_bf16_f32 v64, v48, v49
  v_exp_f32 v53, v53
  v_cvt_pk_bf16_f32 v65, v50, v51
  v_exp_f32 v54, v54
  v_exp_f32 v55, v55
  v_cvt_pk_bf16_f32 v66, v52, v53
  buffer_load_dwordx4 v[220:223], v104, s[52:55], s45 offen offset:3072 sc1
  v_exp_f32 v56, v56
  v_cvt_pk_bf16_f32 v67, v54, v55
  v_exp_f32 v57, v57
  v_exp_f32 v58, v58
  v_exp_f32 v59, v59
  v_exp_f32 v60, v60
  s_waitcnt lgkmcnt(0)
  v_mfma_f32_32x32x16_bf16 v[16:31], v[96:99], v[64:67], v[16:31]
  v_cvt_pk_bf16_f32 v68, v56, v57
  v_exp_f32 v61, v61
  v_cvt_pk_bf16_f32 v69, v58, v59
  v_exp_f32 v62, v62
  v_exp_f32 v63, v63
  v_cvt_pk_bf16_f32 v70, v60, v61
  v_cvt_pk_bf16_f32 v71, v62, v63
  s_setprio 3
  s_nop 0
  v_mfma_f32_32x32x16_bf16 v[16:31], v[100:103], v[68:71], v[16:31]
  buffer_load_ushort v4, v234, s[4:7], 0 offen
  s_waitcnt vmcnt(29)
L_pk_join1:
  v_and_b32 v2, 31, v1
  s_lshl_b32 s34, s3, 8
  s_add_u32 s34, s34, 157696
  v_lshl_add_u32 v3, v2, 3, s34
  s_lshl_b32 s34, s3, 11
  s_add_u32 s34, s34, 131072
  v_add_u32 v106, s34, v104
  s_bfe_u32 s35, s3, 0x10001
  s_lshl_b32 s35, s35, 9
  s_and_b32 s36, s3, 1
  s_nop 2
  v_mov_b32 v108, v28
  v_mov_b32 v109, v28
  ds_write_b128 v106, v[16:19]
  ds_write_b128 v106, v[20:23] offset:1024
  v_permlane32_swap_b32 v108, v109
  s_nop 0
  v_mov_b32 v108, v107
  ds_write_b64 v3, v[108:109]
  v_xor_b32 v3, 1024, v3
  v_xor_b32 v106, 8192, v106
  v_lshrrev_b32 v107, 5, v1
  v_lshlrev_b32 v107, 10, v107
  v_lshl_add_u32 v107, v2, 4, v107
  s_lshl_b32 s37, s36, 10
  s_add_u32 s37, s37, 4096
  s_lshl_b32 s36, s36, 3
  s_add_u32 s36, s36, 6144
  v_cmp_lt_u32 vcc, 31, v1
  v_mov_b32 v105, s37
  v_mov_b32 v32, s36
  v_cndmask_b32 v105, v105, v32, vcc
  v_lshl_add_u32 v105, v2, 4, v105
  s_lshl_b32 s36, s43, 14
  s_add_u32 s36, s36, 23068672
  s_add_u32 s36, s36, s35
  s_mul_i32 s37, s33, 7168
  s_add_u32 s37, s37, s35
  s_add_u32 s37, s37, 65536
  v_add_u32 v2, s37, v105
  s_waitcnt lgkmcnt(0)
  s_barrier
  ds_read_b64 v[110:111], v3
  ds_read_b128 v[32:35], v106
  ds_read_b128 v[36:39], v106 offset:1024
  s_waitcnt lgkmcnt(2)
  v_max_f32 v3, v108, v110
  v_sub_f32 v108, v108, v3
  v_sub_f32 v110, v110, v3
  v_exp_f32 v108, v108
  v_exp_f32 v110, v110
  v_mul_f32 v109, v109, v108
  v_fmac_f32 v109, v111, v110
  v_rcp_f32 v109, v109
  v_mul_f32 v108, 0x3ff5238e, v108
  v_mul_f32 v110, 0x3ff5238e, v110
  v_mul_f32 v108, v108, v109
  v_mul_f32 v110, v110, v109
  v_pk_mul_f32 v[24:25], v[24:25], v[108:109] op_sel_hi:[1,0]
  v_pk_mul_f32 v[26:27], v[26:27], v[108:109] op_sel_hi:[1,0]
  v_pk_mul_f32 v[28:29], v[28:29], v[108:109] op_sel_hi:[1,0]
  v_pk_mul_f32 v[30:31], v[30:31], v[108:109] op_sel_hi:[1,0]
  s_waitcnt lgkmcnt(0)
  v_pk_fma_f32 v[24:25], v[32:33], v[110:111], v[24:25] op_sel_hi:[1,0,1]
  v_pk_fma_f32 v[26:27], v[34:35], v[110:111], v[26:27] op_sel_hi:[1,0,1]
  v_pk_fma_f32 v[28:29], v[36:37], v[110:111], v[28:29] op_sel_hi:[1,0,1]
  v_pk_fma_f32 v[30:31], v[38:39], v[110:111], v[30:31] op_sel_hi:[1,0,1]
  v_cvt_pk_bf16_f32 v8, v24, v25
  v_cvt_pk_bf16_f32 v9, v26, v27
  v_cvt_pk_bf16_f32 v10, v28, v29
  v_cvt_pk_bf16_f32 v11, v30, v31
  s_mov_b32 exec_hi, 0
  s_cmp_lg_u32 s49, 0
  s_cbranch_scc1 L_pk_far19
  buffer_store_dwordx4 v[8:11], v105, s[28:31], s36 offen
L_pk_near19:
  ds_write_b128 v2, v[8:11]
  s_not_b64 exec, exec
  s_cmp_lg_u32 s49, 0
  s_cbranch_scc1 L_pk_far20
  buffer_store_dwordx2 v[8:9], v105, s[28:31], s36 offen
L_pk_near20:
  ds_write_b64 v2, v[8:9]
  s_mov_b64 exec, -1
  s_setprio 0
  s_mov_b32 s46, 0x3f803f80
  s_waitcnt vmcnt(30)
  v_dot2_f32_bf16 v84, v112, s46, 0
  v_dot2_f32_bf16 v85, v113, s46, 0
  v_dot2_f32_bf16 v86, v114, s46, 0
  v_dot2_f32_bf16 v87, v115, s46, 0
  s_waitcnt vmcnt(29)
  v_dot2_f32_bf16 v84, v116, s46, v84
  v_dot2_f32_bf16 v85, v117, s46, v85
  v_dot2_f32_bf16 v86, v118, s46, v86
  v_dot2_f32_bf16 v87, v119, s46, v87
  s_waitcnt vmcnt(28)
  v_dot2_f32_bf16 v84, v120, s46, v84
  v_dot2_f32_bf16 v85, v121, s46, v85
  v_dot2_f32_bf16 v86, v122, s46, v86
  v_dot2_f32_bf16 v87, v123, s46, v87
  s_waitcnt vmcnt(27)
  v_dot2_f32_bf16 v84, v124, s46, v84
  v_dot2_f32_bf16 v85, v125, s46, v85
  v_dot2_f32_bf16 v86, v126, s46, v86
  v_dot2_f32_bf16 v87, v127, s46, v87
  s_waitcnt vmcnt(26)
  v_dot2_f32_bf16 v84, v128, s46, v84
  v_dot2_f32_bf16 v85, v129, s46, v85
  v_dot2_f32_bf16 v86, v130, s46, v86
  v_dot2_f32_bf16 v87, v131, s46, v87
  s_waitcnt vmcnt(25)
  v_dot2_f32_bf16 v84, v132, s46, v84
  v_dot2_f32_bf16 v85, v133, s46, v85
  v_dot2_f32_bf16 v86, v134, s46, v86
  s_nop 0
L_wm_P9:
  s_cbranch_execz L_wm_L_pk_x2
  v_dot2_f32_bf16 v87, v135, s46, v87
  s_waitcnt vmcnt(24)
  v_dot2_f32_bf16 v84, v136, s46, v84
  v_dot2_f32_bf16 v85, v137, s46, v85
  v_dot2_f32_bf16 v86, v138, s46, v86
  v_dot2_f32_bf16 v87, v139, s46, v87
  s_waitcnt vmcnt(23)
  v_dot2_f32_bf16 v84, v140, s46, v84
  v_dot2_f32_bf16 v85, v141, s46, v85
  v_dot2_f32_bf16 v86, v142, s46, v86
  v_dot2_f32_bf16 v87, v143, s46, v87
  s_waitcnt vmcnt(22)
  v_dot2_f32_bf16 v84, v144, s46, v84
  v_dot2_f32_bf16 v85, v145, s46, v85
  v_dot2_f32_bf16 v86, v146, s46, v86
  v_dot2_f32_bf16 v87, v147, s46, v87
  s_waitcnt vmcnt(21)
  v_dot2_f32_bf16 v84, v148, s46, v84
  v_dot2_f32_bf16 v85, v149, s46, v85
  v_dot2_f32_bf16 v86, v150, s46, v86
  v_dot2_f32_bf16 v87, v151, s46, v87
  s_waitcnt vmcnt(20)
  v_dot2_f32_bf16 v84, v152, s46, v84
  v_dot2_f32_bf16 v85, v153, s46, v85
  v_dot2_f32_bf16 v86, v154, s46, v86
  v_dot2_f32_bf16 v87, v155, s46, v87
  s_waitcnt vmcnt(19)
  v_dot2_f32_bf16 v84, v156, s46, v84
  v_dot2_f32_bf16 v85, v157, s46, v85
  v_dot2_f32_bf16 v86, v158, s46, v86
  v_dot2_f32_bf16 v87, v159, s46, v87
  s_mul_i32 s34, s3, 7168
  s_add_u32 s34, s34, 65536
  s_add_u32 s35, s34, 4096
  v_add_u32 v2, s34, v104
  s_add_u32 s38, s42, 0
  s_add_u32 s39, s38, 4096
  s_mov_b32 s37, 262144
  s_cmp_eq_u32 s3, s33
  s_cselect_b32 s30, 0, s30
  s_cselect_b32 s34, 147456, s34
  s_cselect_b32 s35, 147456, s35
  s_cselect_b32 s36, 147456, s36
  s_cselect_b32 s37, 0, s37
  s_mov_b32 m0, s34
  s_nop 0
  buffer_load_dwordx4 v104, s[28:31], s38 offen offset:0 sc1 lds
  buffer_load_dwordx4 v104, s[28:31], s38 offen offset:1024 sc1 lds
  buffer_load_dwordx4 v104, s[28:31], s38 offen offset:2048 sc1 lds
  buffer_load_dwordx4 v104, s[28:31], s38 offen offset:3072 sc1 lds
  s_mov_b32 m0, s35
  s_nop 0
  buffer_load_dwordx4 v104, s[28:31], s39 offen offset:0 sc1 lds
  buffer_load_dwordx4 v104, s[28:31], s39 offen offset:1024 sc1 lds
  buffer_load_dwordx4 v104, s[28:31], s39 offen offset:2048 sc1 lds
  s_mov_b32 s30, 29360128
  s_waitcnt vmcnt(25)
  v_dot2_f32_bf16 v84, v160, s46, v84
  v_dot2_f32_bf16 v85, v161, s46, v85
  v_dot2_f32_bf16 v86, v162, s46, v86
  v_dot2_f32_bf16 v87, v163, s46, v87
  s_waitcnt vmcnt(24)
  v_dot2_f32_bf16 v84, v164, s46, v84
  v_dot2_f32_bf16 v85, v165, s46, v85
  v_dot2_f32_bf16 v86, v166, s46, v86
  v_dot2_f32_bf16 v87, v167, s46, v87
  s_waitcnt vmcnt(23)
  v_dot2_f32_bf16 v84, v168, s46, v84
  v_dot2_f32_bf16 v85, v169, s46, v85
  v_dot2_f32_bf16 v86, v170, s46, v86
  v_dot2_f32_bf16 v87, v171, s46, v87
  s_waitcnt vmcnt(22)
  v_dot2_f32_bf16 v84, v172, s46, v84
  v_dot2_f32_bf16 v85, v173, s46, v85
  v_dot2_f32_bf16 v86, v174, s46, v86
  v_dot2_f32_bf16 v87, v175, s46, v87
  s_waitcnt vmcnt(21)
  v_dot2_f32_bf16 v84, v176, s46, v84
  v_dot2_f32_bf16 v85, v177, s46, v85
  v_dot2_f32_bf16 v86, v178, s46, v86
  v_dot2_f32_bf16 v87, v179, s46, v87
  s_waitcnt vmcnt(20)
  v_dot2_f32_bf16 v84, v180, s46, v84
  v_dot2_f32_bf16 v85, v181, s46, v85
  v_dot2_f32_bf16 v86, v182, s46, v86
  v_dot2_f32_bf16 v87, v183, s46, v87
  s_waitcnt vmcnt(19)
  v_dot2_f32_bf16 v84, v184, s46, v84
  v_dot2_f32_bf16 v85, v185, s46, v85
  v_dot2_f32_bf16 v86, v186, s46, v86
  v_dot2_f32_bf16 v87, v187, s46, v87
  s_waitcnt vmcnt(18)
  v_dot2_f32_bf16 v84, v188, s46, v84
  v_dot2_f32_bf16 v85, v189, s46, v85
  v_dot2_f32_bf16 v86, v190, s46, v86
  v_dot2_f32_bf16 v87, v191, s46, v87
  s_waitcnt vmcnt(17)
  v_dot2_f32_bf16 v84, v192, s46, v84
  v_dot2_f32_bf16 v85, v193, s46, v85
  v_dot2_f32_bf16 v86, v194, s46, v86
  v_dot2_f32_bf16 v87, v195, s46, v87
  s_waitcnt vmcnt(16)
  v_dot2_f32_bf16 v84, v196, s46, v84
  v_dot2_f32_bf16 v85, v197, s46, v85
  v_dot2_f32_bf16 v86, v198, s46, v86
  v_dot2_f32_bf16 v87, v199, s46, v87
  s_waitcnt vmcnt(15)
  v_dot2_f32_bf16 v84, v200, s46, v84
  v_dot2_f32_bf16 v85, v201, s46, v85
  v_dot2_f32_bf16 v86, v202, s46, v86
  v_dot2_f32_bf16 v87, v203, s46, v87
  s_waitcnt vmcnt(14)
  v_dot2_f32_bf16 v84, v204, s46, v84
  v_dot2_f32_bf16 v85, v205, s46, v85
  v_dot2_f32_bf16 v86, v206, s46, v86
  v_dot2_f32_bf16 v87, v207, s46, v87
  s_waitcnt vmcnt(13)
  v_dot2_f32_bf16 v84, v208, s46, v84
  v_dot2_f32_bf16 v85, v209, s46, v85
  v_dot2_f32_bf16 v86, v210, s46, v86
  v_dot2_f32_bf16 v87, v211, s46, v87
  s_waitcnt vmcnt(12)
  v_dot2_f32_bf16 v84, v212, s46, v84
  v_dot2_f32_bf16 v85, v213, s46, v85
  v_dot2_f32_bf16 v86, v214, s46, v86
  v_dot2_f32_bf16 v87, v215, s46, v87
  s_waitcnt vmcnt(11)
  v_dot2_f32_bf16 v84, v216, s46, v84
  v_dot2_f32_bf16 v85, v217, s46, v85
  v_dot2_f32_bf16 v86, v218, s46, v86
  v_dot2_f32_bf16 v87, v219, s46, v87
  s_waitcnt vmcnt(10)
  v_dot2_f32_bf16 v84, v220, s46, v84
  v_dot2_f32_bf16 v85, v221, s46, v85
  v_dot2_f32_bf16 v86, v222, s46, v86
  v_dot2_f32_bf16 v87, v223, s46, v87
  s_waitcnt vmcnt(0)
L_pk_o1chk:
  ds_read_b128 v[32:35], v2 offset:0
  ds_read_b128 v[36:39], v2 offset:1024
  ds_read_b128 v[40:43], v2 offset:2048
  ds_read_b128 v[44:47], v2 offset:3072
  ds_read_b128 v[48:51], v2 offset:4096
  ds_read_b128 v[52:55], v2 offset:5120
  ds_read_b128 v[56:59], v2 offset:6144
  s_waitcnt lgkmcnt(6)
  v_max3_u32 v108, v32, v33, 0
  v_max3_u32 v108, v34, v35, v108
  s_waitcnt lgkmcnt(5)
  v_max3_u32 v108, v36, v37, v108
  v_max3_u32 v108, v38, v39, v108
  s_waitcnt lgkmcnt(4)
  v_max3_u32 v108, v40, v41, v108
  v_max3_u32 v108, v42, v43, v108
  s_waitcnt lgkmcnt(3)
  v_max3_u32 v108, v44, v45, v108
  v_max3_u32 v108, v46, v47, v108
  s_waitcnt lgkmcnt(2)
  v_max3_u32 v108, v48, v49, v108
  v_max3_u32 v108, v50, v51, v108
  s_waitcnt lgkmcnt(1)
  v_max3_u32 v108, v52, v53, v108
  v_max3_u32 v108, v54, v55, v108
  s_waitcnt lgkmcnt(0)
  v_max3_u32 v108, v56, v57, v108
  v_max3_u32 v108, v58, v59, v108
  v_cmp_eq_u32 vcc, -1, v108
  s_cbranch_vccnz L_pk_o1again
L_pk_o1ok:
  s_waitcnt lgkmcnt(0)
  s_barrier
  buffer_load_dwordx4 v[88:91], v104, s[52:55], s47 offen offset:0 sc1
  buffer_load_dwordx4 v[92:95], v104, s[52:55], s47 offen offset:1024 sc1
  buffer_load_dwordx4 v[96:99], v104, s[52:55], s47 offen offset:2048 sc1
  buffer_load_dwordx4 v[100:103], v104, s[52:55], s47 offen offset:3072 sc1
  s_add_u32 s47, s47, 4096
  buffer_load_dwordx4 v[224:227], v104, s[52:55], s47 offen offset:0 sc1
  buffer_load_dwordx4 v[228:231], v104, s[52:55], s47 offen offset:1024 sc1
  buffer_load_dwordx4 v[232:235], v104, s[52:55], s47 offen offset:2048 sc1
  buffer_load_dwordx4 v[236:239], v104, s[52:55], s47 offen offset:3072 sc1
  s_add_u32 s47, s47, 4096
  buffer_load_dwordx4 v[240:243], v104, s[52:55], s47 offen offset:0 sc1
  buffer_load_dwordx4 v[244:247], v104, s[52:55], s47 offen offset:1024 sc1
  buffer_load_dwordx4 v[248:251], v104, s[52:55], s47 offen offset:2048 sc1
  buffer_load_dwordx4 v[252:255], v104, s[52:55], s47 offen offset:3072 sc1
L_pk_wi:
  v_lshlrev_b32 v4, 16, v4
  v_cmp_gt_u32 vcc, 32, v1
  v_mov_b32 v11, 0
  v_add_f32 v84, v84, v85
  v_add_f32 v86, v86, v87
  v_add_f32 v84, v84, v86
  v_mov_b32 v85, v84
  s_nop 1
  v_permlane32_swap_b32 v84, v85
  s_nop 1
  v_add_f32 v84, v84, v85
  v_cvt_pk_bf16_f32 v8, v84, v4
  v_lshlrev_b32 v85, 16, v8
  v_sub_f32 v84, v84, v85
  v_cvt_pk_bf16_f32 v10, v84, v11
  v_cndmask_b32 v8, 0, v8, vcc
  v_cndmask_b32 v10, 0, v10, vcc
  v_mov_b32 v9, v8
  v_mov_b32 v15, 0
  v_mov_b32 v106, 159744
  ds_write_b32 v106, v15
  ds_write_b32 v106, v15 offset:4
  v_lshrrev_b32 v14, 5, v1
  s_lshl_b32 s46, s3, 3
  v_add_u32 v14, s46, v14
  v_bfe_u32 v12, v1, 3, 2
  v_mul_u32_u24 v12, 896, v12
  v_and_b32 v13, 7, v1
  v_lshl_add_u32 v12, v13, 4, v12
  v_mul_u32_u24 v13, 147, v14
  v_lshrrev_b32 v13, 10, v13
  v_mul_u32_u24 v13, 56448, v13
  v_lshl_add_u32 v13, v14, 7, v13
  v_add_u32 v4, v12, v13
  v_add_u32 v14, 2, v14
  v_mul_u32_u24 v13, 147, v14
  v_lshrrev_b32 v13, 10, v13
  v_mul_u32_u24 v13, 56448, v13
  v_lshl_add_u32 v13, v14, 7, v13
  v_add_u32 v5, v12, v13
  v_add_u32 v14, 2, v14
  v_mul_u32_u24 v13, 147, v14
  v_lshrrev_b32 v13, 10, v13
  v_mul_u32_u24 v13, 56448, v13
  v_lshl_add_u32 v13, v14, 7, v13
  v_add_u32 v6, v12, v13
  v_add_u32 v14, 2, v14
  v_mul_u32_u24 v13, 147, v14
  v_lshrrev_b32 v13, 10, v13
  v_mul_u32_u24 v13, 56448, v13
  v_lshl_add_u32 v13, v14, 7, v13
  v_add_u32 v7, v12, v13
  s_lshl_b32 s40, s32, 6
  s_add_u32 s40, s40, s33
  s_mul_i32 s40, s40, 7168
  s_add_u32 s40, s40, 8388608
  s_add_u32 s41, s40, 3584
  v_add_u32 v110, 157696, v107
  v_mov_b32 v12, 0
  v_mov_b32 v13, 0
  v_mov_b32 v14, 0
  ds_write_b128 v110, v[12:15]
  ds_write_b128 v110, v[12:15] offset:512
  v_lshrrev_b32 v111, 5, v1
  v_lshlrev_b32 v111, 9, v111
  v_sub_u32 v111, v107, v111
  s_barrier
  s_sleep 1
  s_lshl_b32 s34, s3, 12
  v_add_u32 v3, s34, v104
  s_add_u32 s38, s42, 7168
  s_mov_b32 s37, 262144
  s_add_u32 s8, s34, 32768
  s_add_u32 s11, s34, 16384
  s_cmp_eq_u32 s3, s33
  s_cselect_b32 s30, 0, s30
  s_cselect_b32 s34, 147456, s34
  s_cselect_b32 s37, 0, s37
  s_cselect_b32 s8, 147456, s8
  s_mov_b32 m0, s34
  s_nop 0
  buffer_load_dwordx4 v104, s[28:31], s38 offen offset:0 sc1 lds
  buffer_load_dwordx4 v104, s[28:31], s38 offen offset:1024 sc1 lds
  buffer_load_dwordx4 v104, s[28:31], s38 offen offset:2048 sc1 lds
  buffer_load_dwordx4 v104, s[28:31], s38 offen offset:3072 sc1 lds
  s_mov_b32 s30, 29360128
  s_add_u32 s9, s38, 4096
  s_sub_u32 s12, s9, 65536
  s_mov_b32 s10, 262144
  s_add_u32 s35, s33, 4
  s_cmp_eq_u32 s3, s35
  s_cselect_b32 s11, 147456, s11
  s_waitcnt vmcnt(2)
  s_mov_b32 m0, s11
  s_nop 0
  buffer_load_dwordx4 v104, s[28:31], s12 offen offset:0 sc1 lds
  buffer_load_dwordx4 v104, s[28:31], s12 offen offset:1024 sc1 lds
  buffer_load_dwordx4 v104, s[28:31], s12 offen offset:2048 sc1 lds
  buffer_load_dwordx4 v104, s[28:31], s12 offen offset:3072 sc1 lds
  s_mov_b32 m0, s8
  s_nop 0
  buffer_load_dwordx4 v104, s[28:31], s9 offen offset:0 sc1 lds
  buffer_load_dwordx4 v104, s[28:31], s9 offen offset:1024 sc1 lds
  buffer_load_dwordx4 v104, s[28:31], s9 offen offset:2048 sc1 lds
  buffer_load_dwordx4 v104, s[28:31], s9 offen offset:3072 sc1 lds
  s_waitcnt vmcnt(8)
L_pk_h1chk:
  ds_read_b128 v[48:51], v3 offset:0
  ds_read_b128 v[52:55], v3 offset:1024
  ds_read_b128 v[56:59], v3 offset:2048
  ds_read_b128 v[60:63], v3 offset:3072
  s_waitcnt lgkmcnt(3)
  v_max3_u32 v108, v48, v49, 0
  v_max3_u32 v108, v50, v51, v108
  s_waitcnt lgkmcnt(2)
  v_max3_u32 v108, v52, v53, v108
  v_max3_u32 v108, v54, v55, v108
  s_waitcnt lgkmcnt(1)
  v_max3_u32 v108, v56, v57, v108
  v_max3_u32 v108, v58, v59, v108
  s_waitcnt lgkmcnt(0)
  v_max3_u32 v108, v60, v61, v108
  v_max3_u32 v108, v62, v63, v108
  v_cmp_eq_u32 vcc, -1, v108
  s_cbranch_vccnz L_pk_h1again
L_pk_h1ok:
L_pk_x2:
L_wm_L_pk_x2:
  s_cbranch_execz L_wm_back0
  v_add_u32 v105, 65536, v104
  s_lshl_b32 s34, s3, 11
  v_add_u32 v2, s34, v105
  s_waitcnt lgkmcnt(0)
  s_barrier
  s_cmp_eq_u32 s3, 7
  s_cbranch_scc1 L_pk_idle7
  ds_read_b128 v[48:51], v111 offset:0
  ds_read_b128 v[52:55], v111 offset:1024
  ds_read_b128 v[56:59], v111 offset:2048
  ds_read_b128 v[60:63], v107 offset:3072
  s_cmp_ge_u32 s3, 4
  s_cbranch_scc1 L_pk_hb0
  s_setprio 3
  s_branch L_pk_he0
L_pk_hb0:
  s_setprio 2
L_pk_he0:
  s_waitcnt lgkmcnt(3)
  v_mfma_f32_32x32x16_bf16 v[16:31], v[112:115], v[48:51], 0
  ds_read_b128 v[48:51], v111 offset:4608
  s_waitcnt lgkmcnt(3)
  v_mfma_f32_32x32x16_bf16 v[16:31], v[116:119], v[52:55], v[16:31]
  ds_read_b128 v[52:55], v111 offset:5632
  s_waitcnt lgkmcnt(3)
  v_mfma_f32_32x32x16_bf16 v[16:31], v[120:123], v[56:59], v[16:31]
  ds_read_b128 v[56:59], v111 offset:6656
  s_waitcnt lgkmcnt(3)
  v_mfma_f32_32x32x16_bf16 v[16:31], v[124:127], v[60:63], v[16:31]
  ds_read_b128 v[60:63], v111 offset:8192
  s_waitcnt lgkmcnt(3)
  v_mfma_f32_32x32x16_bf16 v[16:31], v[128:131], v[48:51], v[16:31]
  ds_read_b128 v[48:51], v111 offset:9216
  s_waitcnt lgkmcnt(3)
  v_mfma_f32_32x32x16_bf16 v[16:31], v[132:135], v[52:55], v[16:31]
  s_cmp_ge_u32 s3, 4
  s_cbranch_scc1 L_pk_hb1
  s_branch L_pk_he1
L_pk_hb1:
  s_setprio 2
  s_waitcnt vmcnt(0)
L_pk_h2chk:
  ds_read_b128 v[32:35], v3 offset:16384
  ds_read_b128 v[36:39], v3 offset:17408
  ds_read_b128 v[40:43], v3 offset:18432
  ds_read_b128 v[44:47], v3 offset:19456
  ds_read_b128 v[64:67], v3 offset:32768
  ds_read_b128 v[68:71], v3 offset:33792
  ds_read_b128 v[72:75], v3 offset:34816
  ds_read_b128 v[76:79], v3 offset:35840
  s_waitcnt lgkmcnt(7)
  v_max3_u32 v80, v32, v33, 0
  v_max3_u32 v80, v34, v35, v80
  s_waitcnt lgkmcnt(6)
  v_max3_u32 v80, v36, v37, v80
  v_max3_u32 v80, v38, v39, v80
  s_waitcnt lgkmcnt(5)
  v_max3_u32 v80, v40, v41, v80
  v_max3_u32 v80, v42, v43, v80
  s_waitcnt lgkmcnt(4)
  v_max3_u32 v80, v44, v45, v80
  v_max3_u32 v80, v46, v47, v80
  s_waitcnt lgkmcnt(3)
  v_max3_u32 v80, v64, v65, v80
  v_max3_u32 v80, v66, v67, v80
  s_waitcnt lgkmcnt(2)
  v_max3_u32 v80, v68, v69, v80
  v_max3_u32 v80, v70, v71, v80
  s_waitcnt lgkmcnt(1)
  v_max3_u32 v80, v72, v73, v80
  v_max3_u32 v80, v74, v75, v80
  s_waitcnt lgkmcnt(0)
  v_max3_u32 v80, v76, v77, v80
  v_max3_u32 v80, v78, v79, v80
  v_cmp_eq_u32 vcc, -1, v80
  s_cbranch_vccnz L_pk_h2again
L_pk_h2ok:
  v_mov_b32 v80, 1
  s_mov_b64 exec, 1
  ds_add_u32 v106, v80 offset:4
  s_mov_b64 exec, -1
  s_setprio 2
L_pk_he1:
  ds_read_b128 v[52:55], v111 offset:10240
  s_waitcnt lgkmcnt(3)
  v_mfma_f32_32x32x16_bf16 v[16:31], v[136:139], v[56:59], v[16:31]
  s_cmp_ge_u32 s3, 4
  s_cbranch_scc1 L_pk_rs6
  buffer_load_dwordx4 v[96:99], v104, s[52:55], s47 offen offset:2048 sc1
L_pk_rs6:
  ds_read_b128 v[56:59], v107 offset:11264
  s_waitcnt lgkmcnt(3)
  v_mfma_f32_32x32x16_bf16 v[16:31], v[140:143], v[60:63], v[16:31]
  ds_read_b128 v[60:63], v111 offset:12800
  s_waitcnt lgkmcnt(3)
  v_mfma_f32_32x32x16_bf16 v[16:31], v[144:147], v[48:51], v[16:31]
  s_cmp_ge_u32 s3, 4
  s_cbranch_scc1 L_pk_rs8
  buffer_load_dwordx4 v[100:103], v104, s[52:55], s47 offen offset:3072 sc1
L_pk_rs8:
  ds_read_b128 v[48:51], v111 offset:13824
  s_waitcnt lgkmcnt(3)
  v_mfma_f32_32x32x16_bf16 v[16:31], v[148:151], v[52:55], v[16:31]
  ds_read_b128 v[52:55], v111 offset:14848
  s_waitcnt lgkmcnt(3)
  v_mfma_f32_32x32x16_bf16 v[16:31], v[152:155], v[56:59], v[16:31]
  s_cmp_ge_u32 s3, 4
  s_cbranch_scc1 L_pk_rs10
  s_add_u32 s47, s47, 4096
  buffer_load_dwordx4 v[224:227], v104, s[52:55], s47 offen offset:0 sc1
L_pk_rs10:
  ds_read_b128 v[56:59], v111 offset:16384
  s_waitcnt lgkmcnt(3)
  v_mfma_f32_32x32x16_bf16 v[16:31], v[156:159], v[60:63], v[16:31]
  ds_read_b128 v[60:63], v111 offset:17408
  s_waitcnt lgkmcnt(3)
  v_mfma_f32_32x32x16_bf16 v[16:31], v[160:163], v[48:51], v[16:31]
  s_cmp_ge_u32 s3, 4
  s_cbranch_scc1 L_pk_rs12
  buffer_load_dwordx4 v[228:231], v104, s[52:55], s47 offen offset:1024 sc1
L_pk_rs12:
  ds_read_b128 v[48:51], v111 offset:18432
  s_waitcnt lgkmcnt(3)
  v_mfma_f32_32x32x16_bf16 v[16:31], v[164:167], v[52:55], v[16:31]
  ds_read_b128 v[52:55], v107 offset:19456
  s_waitcnt lgkmcnt(3)
  v_mfma_f32_32x32x16_bf16 v[16:31], v[168:171], v[56:59], v[16:31]
  s_cmp_ge_u32 s3, 4
  s_cbranch_scc1 L_pk_rs14
  buffer_load_dwordx4 v[232:235], v104, s[52:55], s47 offen offset:2048 sc1
L_pk_rs14:
  ds_read_b128 v[56:59], v111 offset:20992
  s_waitcnt lgkmcnt(3)
  v_mfma_f32_32x32x16_bf16 v[16:31], v[172:175], v[60:63], v[16:31]
  ds_read_b128 v[60:63], v111 offset:22016
  s_waitcnt lgkmcnt(3)
  v_mfma_f32_32x32x16_bf16 v[16:31], v[176:179], v[48:51], v[16:31]
  s_cmp_ge_u32 s3, 4
  s_cbranch_scc1 L_pk_rs16
  buffer_load_dwordx4 v[236:239], v104, s[52:55], s47 offen offset:3072 sc1
L_pk_rs16:
  ds_read_b128 v[48:51], v111 offset:23040
  s_waitcnt lgkmcnt(3)
  v_mfma_f32_32x32x16_bf16 v[16:31], v[180:183], v[52:55], v[16:31]
  ds_read_b128 v[52:55], v111 offset:24576
  s_waitcnt lgkmcnt(3)
  v_mfma_f32_32x32x16_bf16 v[16:31], v[184:187], v[56:59], v[16:31]
  s_cmp_ge_u32 s3, 4
  s_cbranch_scc1 L_pk_rs18
  s_add_u32 s47, s47, 4096
  buffer_load_dwordx4 v[240:243], v104, s[52:55], s47 offen offset:0 sc1
L_pk_rs18:
  ds_read_b128 v[56:59], v111 offset:25600
  s_waitcnt lgkmcnt(3)
  v_mfma_f32_32x32x16_bf16 v[16:31], v[188:191], v[60:63], v[16:31]
  ds_read_b128 v[60:63], v111 offset:26624
  s_waitcnt lgkmcnt(3)
  v_mfma_f32_32x32x16_bf16 v[16:31], v[192:195], v[48:51], v[16:31]
  s_cmp_ge_u32 s3, 4
  s_cbranch_scc1 L_pk_rs20
  buffer_load_dwordx4 v[244:247], v104, s[52:55], s47 offen offset:1024 sc1
L_pk_rs20:
  ds_read_b128 v[48:51], v107 offset:27648
  s_waitcnt lgkmcnt(3)
  v_mfma_f32_32x32x16_bf16 v[16:31], v[196:199], v[52:55], v[16:31]
  ds_read_b128 v[52:55], v111 offset:29184
  s_waitcnt lgkmcnt(3)
  v_mfma_f32_32x32x16_bf16 v[16:31], v[200:203], v[56:59], v[16:31]
  s_cmp_ge_u32 s3, 4
  s_cbranch_scc1 L_pk_rs22
  buffer_load_dwordx4 v[248:251], v104, s[52:55], s47 offen offset:2048 sc1
L_pk_rs22:
  ds_read_b128 v[56:59], v111 offset:30208
  ds_read_b128 v[12:15], v110 offset:0
  s_waitcnt lgkmcnt(4)
  v_mfma_f32_32x32x16_bf16 v[16:31], v[204:207], v[60:63], v[16:31]
  ds_read_b128 v[60:63], v111 offset:31232
  s_waitcnt lgkmcnt(4)
  v_mfma_f32_32x32x16_bf16 v[16:31], v[208:211], v[48:51], v[16:31]
  s_cmp_ge_u32 s3, 4
  s_cbranch_scc1 L_pk_rs24
  buffer_load_dwordx4 v[252:255], v104, s[52:55], s47 offen offset:3072 sc1
L_pk_rs24:
  s_waitcnt lgkmcnt(3)
  v_mfma_f32_32x32x16_bf16 v[16:31], v[212:215], v[52:55], v[16:31]
  s_waitcnt lgkmcnt(2)
  v_mfma_f32_32x32x16_bf16 v[16:31], v[216:219], v[56:59], v[16:31]
  s_waitcnt lgkmcnt(1)
  v_cmp_eq_u32 vcc, 0, v15
  s_cbranch_vccnz L_pk_rec0
L_pk_recok0:
  s_waitcnt lgkmcnt(0)
  v_mfma_f32_32x32x16_bf16 v[16:31], v[220:223], v[60:63], v[16:31]
  ds_read_b32 v48, v106 offset:4
  v_mfma_f32_32x32x16_bf16 v[16:31], v[8:11], v[12:15], v[16:31]
  s_setprio 0
  s_nop 7
  s_nop 3
  v_mul_f32 v16, v16, v15
  v_mul_f32 v17, v17, v15
  v_mul_f32 v18, v18, v15
  v_mul_f32 v19, v19, v15
  v_mul_f32 v20, v20, v15
  v_mul_f32 v21, v21, v15
  v_mul_f32 v22, v22, v15
  v_mul_f32 v23, v23, v15
  v_exp_f32 v64, v16
  v_exp_f32 v65, v17
  v_exp_f32 v66, v18
  v_exp_f32 v67, v19
  v_exp_f32 v68, v20
  v_exp_f32 v69, v21
  v_exp_f32 v70, v22
  v_exp_f32 v71, v23
  v_fma_f32 v72, v64, 0.5, 1.0
  v_fma_f32 v73, v65, 0.5, 1.0
  v_fma_f32 v74, v66, 0.5, 1.0
  v_fma_f32 v75, v67, 0.5, 1.0
  v_fma_f32 v76, v68, 0.5, 1.0
  v_fma_f32 v77, v69, 0.5, 1.0
  v_fma_f32 v78, v70, 0.5, 1.0
  v_fma_f32 v79, v71, 0.5, 1.0
  v_fma_f32 v72, v64, v72, 1.0
  v_fma_f32 v73, v65, v73, 1.0
  v_fma_f32 v74, v66, v74, 1.0
  v_fma_f32 v75, v67, v75, 1.0
  v_fma_f32 v76, v68, v76, 1.0
  v_fma_f32 v77, v69, v77, 1.0
  v_fma_f32 v78, v70, v78, 1.0
  v_fma_f32 v79, v71, v79, 1.0
  v_rcp_f32 v72, v72
  v_rcp_f32 v73, v73
  v_rcp_f32 v74, v74
  v_rcp_f32 v75, v75
  v_rcp_f32 v76, v76
  v_rcp_f32 v77, v77
  v_rcp_f32 v78, v78
  v_rcp_f32 v79, v79
  v_fma_f32 v64, -v16, v72, v16
  v_fma_f32 v65, -v17, v73, v17
  v_fma_f32 v66, -v18, v74, v18
  v_fma_f32 v67, -v19, v75, v19
  v_fma_f32 v68, -v20, v76, v20
  v_fma_f32 v69, -v21, v77, v21
  v_fma_f32 v70, -v22, v78, v22
  v_fma_f32 v71, -v23, v79, v23
  v_cvt_pk_bf16_f32 v80, v64, v65
  v_cvt_pk_bf16_f32 v81, v66, v67
  v_cvt_pk_bf16_f32 v82, v68, v69
  v_cvt_pk_bf16_f32 v83, v70, v71
  s_nop 0
  ds_write_b128 v2, v[80:83] offset:0
  s_waitcnt lgkmcnt(1)
  v_cmp_ne_u32 vcc, 4, v48
  s_cbranch_vccnz L_pk_h3
L_pk_h3ok:
  ds_read_b128 v[48:51], v111 offset:32768
  ds_read_b128 v[52:55], v111 offset:33792
  ds_read_b128 v[56:59], v111 offset:34816
  ds_read_b128 v[60:63], v107 offset:35840
  v_mul_f32 v24, v24, v15
  v_mul_f32 v25, v25, v15
  v_mul_f32 v26, v26, v15
  v_mul_f32 v27, v27, v15
  v_mul_f32 v28, v28, v15
  v_mul_f32 v29, v29, v15
  v_mul_f32 v30, v30, v15
  v_mul_f32 v31, v31, v15
  v_exp_f32 v64, v24
  v_exp_f32 v65, v25
  v_exp_f32 v66, v26
  v_exp_f32 v67, v27
  v_exp_f32 v68, v28
  v_exp_f32 v69, v29
  v_exp_f32 v70, v30
  v_exp_f32 v71, v31
  v_fma_f32 v72, v64, 0.5, 1.0
  v_fma_f32 v73, v65, 0.5, 1.0
  v_fma_f32 v74, v66, 0.5, 1.0
  v_fma_f32 v75, v67, 0.5, 1.0
  v_fma_f32 v76, v68, 0.5, 1.0
  v_fma_f32 v77, v69, 0.5, 1.0
  v_fma_f32 v78, v70, 0.5, 1.0
  v_fma_f32 v79, v71, 0.5, 1.0
  v_fma_f32 v72, v64, v72, 1.0
  v_fma_f32 v73, v65, v73, 1.0
  v_fma_f32 v74, v66, v74, 1.0
  v_fma_f32 v75, v67, v75, 1.0
  v_fma_f32 v76, v68, v76, 1.0
  v_fma_f32 v77, v69, v77, 1.0
  v_fma_f32 v78, v70, v78, 1.0
  v_fma_f32 v79, v71, v79, 1.0
  v_rcp_f32 v72, v72
  v_rcp_f32 v73, v73
  v_rcp_f32 v74, v74
  v_rcp_f32 v75, v75
  v_rcp_f32 v76, v76
  v_rcp_f32 v77, v77
  v_rcp_f32 v78, v78
  v_rcp_f32 v79, v79
  v_fma_f32 v64, -v24, v72, v24
  v_fma_f32 v65, -v25, v73, v25
  v_fma_f32 v66, -v26, v74, v26
  v_fma_f32 v67, -v27, v75, v27
  v_fma_f32 v68, -v28, v76, v28
  v_fma_f32 v69, -v29, v77, v29
  v_fma_f32 v70, -v30, v78, v30
  v_fma_f32 v71, -v31, v79, v31
  v_cvt_pk_bf16_f32 v84, v64, v65
  v_cvt_pk_bf16_f32 v85, v66, v67
  v_cvt_pk_bf16_f32 v86, v68, v69
  v_cvt_pk_bf16_f32 v87, v70, v71
  s_nop 0
  ds_write_b128 v2, v[84:87] offset:1024
  s_cmp_ge_u32 s3, 4
  s_cbranch_scc1 L_pk_hb2
  s_setprio 1
  s_branch L_pk_he2
L_pk_hb2:
  s_waitcnt lgkmcnt(0)
  s_barrier
  s_setprio 2
L_pk_he2:
  s_waitcnt lgkmcnt(4)
  v_mfma_f32_32x32x16_bf16 v[32:47], v[112:115], v[48:51], 0
  ds_read_b128 v[48:51], v111 offset:37376
  s_waitcnt lgkmcnt(4)
  v_mfma_f32_32x32x16_bf16 v[32:47], v[116:119], v[52:55], v[32:47]
  ds_read_b128 v[52:55], v111 offset:38400
  s_add_u32 s47, s47, 4096
  buffer_load_dwordx4 v[112:115], v104, s[52:55], s47 offen offset:0 sc1
  s_waitcnt lgkmcnt(4)
  v_mfma_f32_32x32x16_bf16 v[32:47], v[120:123], v[56:59], v[32:47]
  ds_read_b128 v[56:59], v111 offset:39424
  s_waitcnt lgkmcnt(4)
  v_mfma_f32_32x32x16_bf16 v[32:47], v[124:127], v[60:63], v[32:47]
  ds_read_b128 v[60:63], v111 offset:40960
  buffer_load_dwordx4 v[116:119], v104, s[52:55], s47 offen offset:1024 sc1
  s_waitcnt lgkmcnt(3)
  v_mfma_f32_32x32x16_bf16 v[32:47], v[128:131], v[48:51], v[32:47]
  ds_read_b128 v[48:51], v111 offset:41984
  s_waitcnt lgkmcnt(3)
  v_mfma_f32_32x32x16_bf16 v[32:47], v[132:135], v[52:55], v[32:47]
  ds_read_b128 v[52:55], v111 offset:43008
  buffer_load_dwordx4 v[120:123], v104, s[52:55], s47 offen offset:2048 sc1
  s_waitcnt lgkmcnt(3)
  v_mfma_f32_32x32x16_bf16 v[32:47], v[136:139], v[56:59], v[32:47]
  ds_read_b128 v[56:59], v107 offset:44032
  buffer_load_dwordx4 v[124:127], v104, s[52:55], s47 offen offset:3072 sc1
  s_waitcnt lgkmcnt(3)
  v_mfma_f32_32x32x16_bf16 v[32:47], v[140:143], v[60:63], v[32:47]
  ds_read_b128 v[60:63], v111 offset:45568
  s_waitcnt lgkmcnt(3)
  s_nop 0
L_wm_P10:
  s_cbranch_execz L_wm_back0
  v_mfma_f32_32x32x16_bf16 v[32:47], v[144:147], v[48:51], v[32:47]
  ds_read_b128 v[48:51], v111 offset:46592
  s_add_u32 s47, s47, 4096
  buffer_load_dwordx4 v[128:131], v104, s[52:55], s47 offen offset:0 sc1
  s_waitcnt lgkmcnt(3)
  v_mfma_f32_32x32x16_bf16 v[32:47], v[148:151], v[52:55], v[32:47]
  ds_read_b128 v[52:55], v111 offset:47616
  s_waitcnt lgkmcnt(3)
  v_mfma_f32_32x32x16_bf16 v[32:47], v[152:155], v[56:59], v[32:47]
  ds_read_b128 v[56:59], v111 offset:49152
  buffer_load_dwordx4 v[132:135], v104, s[52:55], s47 offen offset:1024 sc1
  s_waitcnt lgkmcnt(3)
  v_mfma_f32_32x32x16_bf16 v[32:47], v[156:159], v[60:63], v[32:47]
  ds_read_b128 v[60:63], v111 offset:50176
  s_waitcnt lgkmcnt(3)
  v_mfma_f32_32x32x16_bf16 v[32:47], v[160:163], v[48:51], v[32:47]
  ds_read_b128 v[48:51], v111 offset:51200
  buffer_load_dwordx4 v[136:139], v104, s[52:55], s47 offen offset:2048 sc1
  s_waitcnt lgkmcnt(3)
  v_mfma_f32_32x32x16_bf16 v[32:47], v[164:167], v[52:55], v[32:47]
  ds_read_b128 v[52:55], v107 offset:52224
  buffer_load_dwordx4 v[140:143], v104, s[52:55], s47 offen offset:3072 sc1
  s_waitcnt lgkmcnt(3)
  v_mfma_f32_32x32x16_bf16 v[32:47], v[168:171], v[56:59], v[32:47]
  ds_read_b128 v[56:59], v111 offset:53760
  s_waitcnt lgkmcnt(3)
  v_mfma_f32_32x32x16_bf16 v[32:47], v[172:175], v[60:63], v[32:47]
  ds_read_b128 v[60:63], v111 offset:54784
  s_add_u32 s47, s47, 4096
  buffer_load_dwordx4 v[144:147], v104, s[52:55], s47 offen offset:0 sc1
  s_waitcnt lgkmcnt(3)
  v_mfma_f32_32x32x16_bf16 v[32:47], v[176:179], v[48:51], v[32:47]
  ds_read_b128 v[48:51], v111 offset:55808
  s_waitcnt lgkmcnt(3)
  v_mfma_f32_32x32x16_bf16 v[32:47], v[180:183], v[52:55], v[32:47]
  ds_read_b128 v[52:55], v111 offset:57344
  buffer_load_dwordx4 v[148:151], v104, s[52:55], s47 offen offset:1024 sc1
  s_waitcnt lgkmcnt(3)
  v_mfma_f32_32x32x16_bf16 v[32:47], v[184:187], v[56:59], v[32:47]
  ds_read_b128 v[56:59], v111 offset:58368
  s_waitcnt lgkmcnt(3)
  v_mfma_f32_32x32x16_bf16 v[32:47], v[188:191], v[60:63], v[32:47]
  ds_read_b128 v[60:63], v111 offset:59392
  buffer_load_dwordx4 v[152:155], v104, s[52:55], s47 offen offset:2048 sc1
  s_waitcnt lgkmcnt(3)
  v_mfma_f32_32x32x16_bf16 v[32:47], v[192:195], v[48:51], v[32:47]
  ds_read_b128 v[48:51], v107 offset:60416
  buffer_load_dwordx4 v[156:159], v104, s[52:55], s47 offen offset:3072 sc1
  s_waitcnt lgkmcnt(3)
  v_mfma_f32_32x32x16_bf16 v[32:47], v[196:199], v[52:55], v[32:47]
  ds_read_b128 v[52:55], v111 offset:61952
  s_waitcnt lgkmcnt(3)
  v_mfma_f32_32x32x16_bf16 v[32:47], v[200:203], v[56:59], v[32:47]
  ds_read_b128 v[56:59], v111 offset:62976
  ds_read_b128 v[12:15], v110 offset:512
  s_add_u32 s47, s47, 4096
  buffer_load_dwordx4 v[160:163], v104, s[52:55], s47 offen offset:0 sc1
  s_waitcnt lgkmcnt(4)
  v_mfma_f32_32x32x16_bf16 v[32:47], v[204:207], v[60:63], v[32:47]
  ds_read_b128 v[60:63], v111 offset:64000
  s_waitcnt lgkmcnt(4)
  v_mfma_f32_32x32x16_bf16 v[32:47], v[208:211], v[48:51], v[32:47]
  buffer_load_dwordx4 v[164:167], v104, s[52:55], s47 offen offset:1024 sc1
  s_waitcnt lgkmcnt(3)
  v_mfma_f32_32x32x16_bf16 v[32:47], v[212:215], v[52:55], v[32:47]
  s_waitcnt lgkmcnt(2)
  v_mfma_f32_32x32x16_bf16 v[32:47], v[216:219], v[56:59], v[32:47]
  buffer_load_dwordx4 v[168:171], v104, s[52:55], s47 offen offset:2048 sc1
  s_waitcnt lgkmcnt(1)
  v_cmp_eq_u32 vcc, 0, v15
  s_cbranch_vccnz L_pk_rec1
L_pk_recok1:
  s_waitcnt lgkmcnt(0)
  v_mfma_f32_32x32x16_bf16 v[32:47], v[220:223], v[60:63], v[32:47]
  buffer_load_dwordx4 v[172:175], v104, s[52:55], s47 offen offset:3072 sc1
  v_mfma_f32_32x32x16_bf16 v[32:47], v[8:11], v[12:15], v[32:47]
  s_cmp_ge_u32 s3, 4
  s_cbranch_scc1 L_pk_hb3
  s_waitcnt lgkmcnt(0)
  s_barrier
  s_branch L_pk_he3
L_pk_hb3:
L_pk_he3:
  ds_read_b128 v[48:51], v105 offset:0
  ds_read_b128 v[52:55], v105 offset:1024
  ds_read_b128 v[56:59], v105 offset:2048
  ds_read_b128 v[60:63], v105 offset:3072
  s_setprio 0
  s_nop 7
  s_nop 3
  v_mul_f32 v32, v32, v15
  v_mul_f32 v33, v33, v15
  v_mul_f32 v34, v34, v15
  v_mul_f32 v35, v35, v15
  v_mul_f32 v36, v36, v15
  v_mul_f32 v37, v37, v15
  v_mul_f32 v38, v38, v15
  v_mul_f32 v39, v39, v15
  v_exp_f32 v64, v32
  v_exp_f32 v65, v33
  v_exp_f32 v66, v34
  v_exp_f32 v67, v35
  v_exp_f32 v68, v36
  v_exp_f32 v69, v37
  v_exp_f32 v70, v38
  v_exp_f32 v71, v39
  v_fma_f32 v72, v64, 0.5, 1.0
  v_fma_f32 v73, v65, 0.5, 1.0
  v_fma_f32 v74, v66, 0.5, 1.0
  v_fma_f32 v75, v67, 0.5, 1.0
  v_fma_f32 v76, v68, 0.5, 1.0
  v_fma_f32 v77, v69, 0.5, 1.0
  v_fma_f32 v78, v70, 0.5, 1.0
  v_fma_f32 v79, v71, 0.5, 1.0
  v_fma_f32 v72, v64, v72, 1.0
  v_fma_f32 v73, v65, v73, 1.0
  v_fma_f32 v74, v66, v74, 1.0
  v_fma_f32 v75, v67, v75, 1.0
  v_fma_f32 v76, v68, v76, 1.0
  v_fma_f32 v77, v69, v77, 1.0
  v_fma_f32 v78, v70, v78, 1.0
  v_fma_f32 v79, v71, v79, 1.0
  v_rcp_f32 v72, v72
  v_rcp_f32 v73, v73
  v_rcp_f32 v74, v74
  v_rcp_f32 v75, v75
  v_rcp_f32 v76, v76
  v_rcp_f32 v77, v77
  v_rcp_f32 v78, v78
  v_rcp_f32 v79, v79
  v_fma_f32 v64, -v32, v72, v32
  v_fma_f32 v65, -v33, v73, v33
  v_fma_f32 v66, -v34, v74, v34
  v_fma_f32 v67, -v35, v75, v35
  v_fma_f32 v68, -v36, v76, v36
  v_fma_f32 v69, -v37, v77, v37
  v_fma_f32 v70, -v38, v78, v38
  v_fma_f32 v71, -v39, v79, v39
  v_cvt_pk_bf16_f32 v80, v64, v65
  v_cvt_pk_bf16_f32 v81, v66, v67
  v_cvt_pk_bf16_f32 v82, v68, v69
  v_cvt_pk_bf16_f32 v83, v70, v71
  s_nop 0
  ds_write_b128 v2, v[80:83] offset:14336
  v_mul_f32 v40, v40, v15
  v_mul_f32 v41, v41, v15
  v_mul_f32 v42, v42, v15
  v_mul_f32 v43, v43, v15
  v_mul_f32 v44, v44, v15
  v_mul_f32 v45, v45, v15
  v_mul_f32 v46, v46, v15
  v_mul_f32 v47, v47, v15
  v_exp_f32 v64, v40
  v_exp_f32 v65, v41
  v_exp_f32 v66, v42
  v_exp_f32 v67, v43
  v_exp_f32 v68, v44
  v_exp_f32 v69, v45
  v_exp_f32 v70, v46
  v_exp_f32 v71, v47
  v_fma_f32 v72, v64, 0.5, 1.0
  v_fma_f32 v73, v65, 0.5, 1.0
  v_fma_f32 v74, v66, 0.5, 1.0
  v_fma_f32 v75, v67, 0.5, 1.0
  v_fma_f32 v76, v68, 0.5, 1.0
  v_fma_f32 v77, v69, 0.5, 1.0
  v_fma_f32 v78, v70, 0.5, 1.0
  v_fma_f32 v79, v71, 0.5, 1.0
  v_fma_f32 v72, v64, v72, 1.0
  v_fma_f32 v73, v65, v73, 1.0
  v_fma_f32 v74, v66, v74, 1.0
  v_fma_f32 v75, v67, v75, 1.0
  v_fma_f32 v76, v68, v76, 1.0
  v_fma_f32 v77, v69, v77, 1.0
  v_fma_f32 v78, v70, v78, 1.0
  v_fma_f32 v79, v71, v79, 1.0
  v_rcp_f32 v72, v72
  v_rcp_f32 v73, v73
  v_rcp_f32 v74, v74
  v_rcp_f32 v75, v75
  v_rcp_f32 v76, v76
  v_rcp_f32 v77, v77
  v_rcp_f32 v78, v78
  v_rcp_f32 v79, v79
  v_fma_f32 v64, -v40, v72, v40
  v_fma_f32 v65, -v41, v73, v41
  v_fma_f32 v66, -v42, v74, v42
  v_fma_f32 v67, -v43, v75, v43
  v_fma_f32 v68, -v44, v76, v44
  v_fma_f32 v69, -v45, v77, v45
  v_fma_f32 v70, -v46, v78, v46
  v_fma_f32 v71, -v47, v79, v47
  v_cvt_pk_bf16_f32 v84, v64, v65
  v_cvt_pk_bf16_f32 v85, v66, v67
  v_cvt_pk_bf16_f32 v86, v68, v69
  v_cvt_pk_bf16_f32 v87, v70, v71
  s_nop 0
  ds_write_b128 v2, v[84:87] offset:15360
  s_cmp_ge_u32 s3, 4
  s_cbranch_scc1 L_pk_hb4
  s_setprio 3
  s_branch L_pk_he4
L_pk_hb4:
  s_waitcnt lgkmcnt(0)
  s_barrier
  s_setprio 2
L_pk_he4:
  s_lshl_b32 s50, s3, 3
  s_sub_u32 s50, 28, s50
  s_cmp_lg_u32 s49, 0
  s_cselect_b32 s50, 64, s50
  s_waitcnt lgkmcnt(5)
  s_waitcnt vmcnt(16)
  v_mfma_f32_32x32x16_bf16 v[16:31], v[88:91], v[48:51], 0
  v_mfma_f32_32x32x16_bf16 v[176:191], v[92:95], v[48:51], 0
  ds_read_b128 v[48:51], v105 offset:4096
  s_waitcnt lgkmcnt(5)
  v_mfma_f32_32x32x16_bf16 v[16:31], v[96:99], v[52:55], v[16:31]
  v_mfma_f32_32x32x16_bf16 v[176:191], v[100:103], v[52:55], v[176:191]
  ds_read_b128 v[52:55], v105 offset:5120
  s_waitcnt lgkmcnt(5)
  v_mfma_f32_32x32x16_bf16 v[16:31], v[224:227], v[56:59], v[16:31]
  v_mfma_f32_32x32x16_bf16 v[176:191], v[228:231], v[56:59], v[176:191]
  ds_read_b128 v[56:59], v105 offset:6144
  s_waitcnt lgkmcnt(5)
  v_mfma_f32_32x32x16_bf16 v[16:31], v[232:235], v[60:63], v[16:31]
  v_mfma_f32_32x32x16_bf16 v[176:191], v[236:239], v[60:63], v[176:191]
  ds_read_b128 v[60:63], v105 offset:7168
  s_waitcnt lgkmcnt(3)
  v_mfma_f32_32x32x16_bf16 v[16:31], v[240:243], v[48:51], v[16:31]
  v_mfma_f32_32x32x16_bf16 v[176:191], v[244:247], v[48:51], v[176:191]
  ds_read_b128 v[48:51], v105 offset:8192
  s_waitcnt lgkmcnt(3)
  v_mfma_f32_32x32x16_bf16 v[16:31], v[248:251], v[52:55], v[16:31]
  v_mfma_f32_32x32x16_bf16 v[176:191], v[252:255], v[52:55], v[176:191]
  ds_read_b128 v[52:55], v105 offset:9216
  s_waitcnt lgkmcnt(3)
  s_waitcnt vmcnt(15)
  v_mfma_f32_32x32x16_bf16 v[16:31], v[112:115], v[56:59], v[16:31]
  s_waitcnt vmcnt(14)
  v_mfma_f32_32x32x16_bf16 v[176:191], v[116:119], v[56:59], v[176:191]
  ds_read_b128 v[56:59], v105 offset:10240
  s_waitcnt lgkmcnt(3)
  s_waitcnt vmcnt(13)
  v_mfma_f32_32x32x16_bf16 v[16:31], v[120:123], v[60:63], v[16:31]
  s_waitcnt vmcnt(12)
  v_mfma_f32_32x32x16_bf16 v[176:191], v[124:127], v[60:63], v[176:191]
  ds_read_b128 v[60:63], v105 offset:11264
  s_waitcnt lgkmcnt(3)
  s_waitcnt vmcnt(11)
  v_mfma_f32_32x32x16_bf16 v[16:31], v[128:131], v[48:51], v[16:31]
  s_waitcnt vmcnt(10)
  v_mfma_f32_32x32x16_bf16 v[176:191], v[132:135], v[48:51], v[176:191]
  ds_read_b128 v[48:51], v105 offset:12288
  s_waitcnt lgkmcnt(3)
  s_waitcnt vmcnt(9)
  v_mfma_f32_32x32x16_bf16 v[16:31], v[136:139], v[52:55], v[16:31]
  s_waitcnt vmcnt(8)
  v_mfma_f32_32x32x16_bf16 v[176:191], v[140:143], v[52:55], v[176:191]
  ds_read_b128 v[52:55], v105 offset:13312
  s_cmp_ge_u32 s3, 4
  s_cbranch_scc1 L_pk_hb5
  s_barrier
  s_branch L_pk_he5
L_pk_hb5:
L_pk_he5:
  s_waitcnt lgkmcnt(3)
  s_waitcnt vmcnt(7)
  v_mfma_f32_32x32x16_bf16 v[16:31], v[144:147], v[56:59], v[16:31]
  s_waitcnt vmcnt(6)
  v_mfma_f32_32x32x16_bf16 v[176:191], v[148:151], v[56:59], v[176:191]
  ds_read_b128 v[56:59], v105 offset:14336
  s_waitcnt lgkmcnt(3)
  s_waitcnt vmcnt(5)
  v_mfma_f32_32x32x16_bf16 v[16:31], v[152:155], v[60:63], v[16:31]
  s_waitcnt vmcnt(4)
  v_mfma_f32_32x32x16_bf16 v[176:191], v[156:159], v[60:63], v[176:191]
  ds_read_b128 v[60:63], v105 offset:15360
  s_waitcnt lgkmcnt(3)
  s_waitcnt vmcnt(3)
  v_mfma_f32_32x32x16_bf16 v[16:31], v[160:163], v[48:51], v[16:31]
  s_waitcnt vmcnt(2)
  v_mfma_f32_32x32x16_bf16 v[176:191], v[164:167], v[48:51], v[176:191]
  ds_read_b128 v[48:51], v105 offset:16384
  s_waitcnt lgkmcnt(3)
  s_waitcnt vmcnt(1)
  v_mfma_f32_32x32x16_bf16 v[16:31], v[168:171], v[52:55], v[16:31]
  s_waitcnt vmcnt(0)
  v_mfma_f32_32x32x16_bf16 v[176:191], v[172:175], v[52:55], v[176:191]
  ds_read_b128 v[52:55], v105 offset:17408
  s_waitcnt lgkmcnt(3)
  v_mfma_f32_32x32x16_bf16 v[192:207], v[88:91], v[56:59], 0
  v_mfma_f32_32x32x16_bf16 v[208:223], v[92:95], v[56:59], 0
  ds_read_b128 v[56:59], v105 offset:18432
  s_waitcnt lgkmcnt(3)
  v_mfma_f32_32x32x16_bf16 v[192:207], v[96:99], v[60:63], v[192:207]
  v_cvt_pk_bf16_f32 v64, v16, v176
  v_mfma_f32_32x32x16_bf16 v[208:223], v[100:103], v[60:63], v[208:223]
  v_cvt_pk_bf16_f32 v65, v17, v177
  ds_read_b128 v[60:63], v105 offset:19456
  s_waitcnt lgkmcnt(3)
  v_mfma_f32_32x32x16_bf16 v[192:207], v[224:227], v[48:51], v[192:207]
  v_cvt_pk_bf16_f32 v66, v18, v178
  v_mfma_f32_32x32x16_bf16 v[208:223], v[228:231], v[48:51], v[208:223]
  v_cvt_pk_bf16_f32 v67, v19, v179
  ds_read_b128 v[48:51], v105 offset:20480
  s_waitcnt lgkmcnt(3)
  v_mfma_f32_32x32x16_bf16 v[192:207], v[232:235], v[52:55], v[192:207]
  s_cmp_gt_i32 s50, 0
  s_cbranch_scc1 L_pk_far27
  buffer_store_dwordx4 v[64:67], v4, s[28:31], s40 offen
L_pk_near27:
  v_mfma_f32_32x32x16_bf16 v[208:223], v[236:239], v[52:55], v[208:223]
  v_cvt_pk_bf16_f32 v68, v20, v180
  ds_read_b128 v[52:55], v105 offset:21504
  s_waitcnt lgkmcnt(3)
  v_mfma_f32_32x32x16_bf16 v[192:207], v[240:243], v[56:59], v[192:207]
  v_cvt_pk_bf16_f32 v69, v21, v181
  v_mfma_f32_32x32x16_bf16 v[208:223], v[244:247], v[56:59], v[208:223]
  v_cvt_pk_bf16_f32 v70, v22, v182
  ds_read_b128 v[56:59], v105 offset:22528
  s_waitcnt lgkmcnt(3)
  v_mfma_f32_32x32x16_bf16 v[192:207], v[248:251], v[60:63], v[192:207]
  v_cvt_pk_bf16_f32 v71, v23, v183
  v_mfma_f32_32x32x16_bf16 v[208:223], v[252:255], v[60:63], v[208:223]
  s_cmp_gt_i32 s50, 2
  s_cbranch_scc1 L_pk_far28
  buffer_store_dwordx4 v[68:71], v5, s[28:31], s40 offen
L_pk_near28:
  ds_read_b128 v[60:63], v105 offset:23552
  s_waitcnt lgkmcnt(3)
  v_mfma_f32_32x32x16_bf16 v[192:207], v[112:115], v[48:51], v[192:207]
  v_cvt_pk_bf16_f32 v72, v24, v184
  v_mfma_f32_32x32x16_bf16 v[208:223], v[116:119], v[48:51], v[208:223]
  v_cvt_pk_bf16_f32 v73, v25, v185
  ds_read_b128 v[48:51], v105 offset:24576
  s_waitcnt lgkmcnt(3)
  v_mfma_f32_32x32x16_bf16 v[192:207], v[120:123], v[52:55], v[192:207]
  v_cvt_pk_bf16_f32 v74, v26, v186
  v_mfma_f32_32x32x16_bf16 v[208:223], v[124:127], v[52:55], v[208:223]
  v_cvt_pk_bf16_f32 v75, v27, v187
  ds_read_b128 v[52:55], v105 offset:25600
  v_mov_b32 v2, 159744
  s_cmp_eq_u32 s3, 6
  s_cselect_b64 exec, 1, 0
  ds_write_b32 v2, v2
  s_mov_b64 exec, -1
  s_waitcnt lgkmcnt(4)
  v_mfma_f32_32x32x16_bf16 v[192:207], v[128:131], v[56:59], v[192:207]
  s_cmp_gt_i32 s50, 4
  s_cbranch_scc1 L_pk_far29
  buffer_store_dwordx4 v[72:75], v6, s[28:31], s40 offen
L_pk_near29:
  v_mfma_f32_32x32x16_bf16 v[208:223], v[132:135], v[56:59], v[208:223]
  v_cvt_pk_bf16_f32 v76, v28, v188
  ds_read_b128 v[56:59], v105 offset:26624
  s_waitcnt lgkmcnt(4)
  v_mfma_f32_32x32x16_bf16 v[192:207], v[136:139], v[60:63], v[192:207]
  v_cvt_pk_bf16_f32 v77, v29, v189
  v_mfma_f32_32x32x16_bf16 v[208:223], v[140:143], v[60:63], v[208:223]
  v_cvt_pk_bf16_f32 v78, v30, v190
  ds_read_b128 v[60:63], v105 offset:27648
  s_waitcnt lgkmcnt(4)
  v_mfma_f32_32x32x16_bf16 v[192:207], v[144:147], v[48:51], v[192:207]
  v_cvt_pk_bf16_f32 v79, v31, v191
  v_mfma_f32_32x32x16_bf16 v[208:223], v[148:151], v[48:51], v[208:223]
  s_cmp_gt_i32 s50, 6
  s_cbranch_scc1 L_pk_far30
  buffer_store_dwordx4 v[76:79], v7, s[28:31], s40 offen
L_pk_near30:
  s_waitcnt lgkmcnt(3)
  v_mfma_f32_32x32x16_bf16 v[192:207], v[152:155], v[52:55], v[192:207]
  v_mfma_f32_32x32x16_bf16 v[208:223], v[156:159], v[52:55], v[208:223]
  s_waitcnt lgkmcnt(1)
  v_mfma_f32_32x32x16_bf16 v[192:207], v[160:163], v[56:59], v[192:207]
  v_mfma_f32_32x32x16_bf16 v[208:223], v[164:167], v[56:59], v[208:223]
  s_waitcnt lgkmcnt(0)
  v_mfma_f32_32x32x16_bf16 v[192:207], v[168:171], v[60:63], v[192:207]
  v_mfma_f32_32x32x16_bf16 v[208:223], v[172:175], v[60:63], v[208:223]
  s_nop 7
  s_nop 3
  v_cvt_pk_bf16_f32 v64, v192, v208
  v_cvt_pk_bf16_f32 v65, v193, v209
  v_cvt_pk_bf16_f32 v66, v194, v210
  v_cvt_pk_bf16_f32 v67, v195, v211
  s_cmp_gt_i32 s50, 0
  s_cbranch_scc1 L_pk_far31
  buffer_store_dwordx4 v[64:67], v4, s[28:31], s41 offen
L_pk_near31:
  v_cvt_pk_bf16_f32 v68, v196, v212
  v_cvt_pk_bf16_f32 v69, v197, v213
  v_cvt_pk_bf16_f32 v70, v198, v214
  v_cvt_pk_bf16_f32 v71, v199, v215
  s_cmp_gt_i32 s50, 2
  s_cbranch_scc1 L_pk_far32
  buffer_store_dwordx4 v[68:71], v5, s[28:31], s41 offen
L_pk_near32:
  v_cvt_pk_bf16_f32 v72, v200, v216
  v_cvt_pk_bf16_f32 v73, v201, v217
  v_cvt_pk_bf16_f32 v74, v202, v218
  v_cvt_pk_bf16_f32 v75, v203, v219
  s_cmp_gt_i32 s50, 4
  s_cbranch_scc1 L_pk_far33
  buffer_store_dwordx4 v[72:75], v6, s[28:31], s41 offen
L_pk_near33:
  v_cvt_pk_bf16_f32 v76, v204, v220
  v_cvt_pk_bf16_f32 v77, v205, v221
  v_cvt_pk_bf16_f32 v78, v206, v222
  v_cvt_pk_bf16_f32 v79, v207, v223
  s_cmp_gt_i32 s50, 6
  s_cbranch_scc1 L_pk_far34
  buffer_store_dwordx4 v[76:79], v7, s[28:31], s41 offen
L_pk_near34:
  s_setprio 0
  s_mov_b32 s35, 0
  s_lshr_b32 s34, s33, 2
  s_lshr_b32 s36, s3, 2
  s_cmp_gt_u32 s34, s36
  s_cbranch_scc1 L_pk_await
  s_cmp_lg_u32 s3, 6
  s_cbranch_scc1 L_pk_not6
  v_mov_b32 v2, 159744
  v_mov_b32 v3, 1
  ds_write_b32 v2, v3
L_pk_not6:
  s_mov_b32 s35, 0
  s_cmp_eq_u32 s36, 0
  s_cbranch_scc1 L_pk_await
  s_cmp_eq_u32 s34, 0
  s_cbranch_scc1 L_pk_pub3
  s_sleep 5
  s_branch L_pk_pub3
L_pk_await:
L_wm_L_pk_await:
  s_cbranch_execz L_wm_L_pk_pub3
  v_mov_b32 v2, 159744
L_pk_w7:
  s_sleep 1
  ds_read_b32 v3, v2
  s_waitcnt lgkmcnt(0)
  v_add_u32 v3, -1, v3
  v_cmp_lt_u32 vcc, s35, v3
  s_cbranch_vccnz L_pk_w7
  s_cmp_lg_u32 s35, 0
  s_cbranch_scc1 L_pk_pub3
  s_sleep 2
L_pk_pub3:
L_wm_L_pk_pub3:
  s_cbranch_execz L_wm_back1
  s_mov_b32 s36, 262144
  s_add_u32 s5, s23, 28672
  v_lshrrev_b32 v2, 4, v1
  v_and_b32 v3, 15, v1
  v_mul_u32_u24 v4, 7168, v2
  v_lshl_add_u32 v4, v3, 4, v4
  v_cmp_gt_u32 vcc, 8, v3
L_pk_pl:
  buffer_load_dwordx4 v[32:35], v4, s[28:31], s23 offen offset:0 sc1
  buffer_load_dwordx4 v[36:39], v4, s[28:31], s5 offen offset:0 sc1
  buffer_load_dwordx4 v[40:43], v4, s[28:31], s23 offen offset:256 sc1
  buffer_load_dwordx4 v[44:47], v4, s[28:31], s5 offen offset:256 sc1
  v_mov_b32 v5, 0x40000000
  v_cndmask_b32 v5, v5, v4, vcc
  buffer_load_dwordx4 v[48:51], v4, s[28:31], s23 offen offset:512 sc1
  buffer_load_dwordx4 v[52:55], v4, s[28:31], s5 offen offset:512 sc1
  buffer_load_dwordx4 v[56:59], v5, s[28:31], s23 offen offset:768 sc1
  buffer_load_dwordx4 v[60:63], v5, s[28:31], s5 offen offset:768 sc1
  v_and_b32 v6, 1, v2
  v_lshrrev_b32 v2, 1, v2
  v_mul_u32_u24 v7, 7168, v6
  v_lshl_add_u32 v0, v2, 4, v3
  s_mul_i32 s35, s3, 896
  s_add_u32 s35, s35, 98304
  v_lshl_add_u32 v7, v0, 4, v7
  v_add_u32 v7, s35, v7
  ds_read_b128 v[24:27], v7
  ds_read_b128 v[28:31], v7 offset:512
  v_and_b32 v2, 1, v3
  v_lshlrev_b32 v2, 4, v2
  s_movk_i32 s34, 0x3f80
  v_lshlrev_b32 v2, v2, s34
  v_lshrrev_b32 v3, 1, v3
  v_cmp_eq_u32 vcc, 0, v3
  v_cndmask_b32 v8, 0, v2, vcc
  v_cmp_eq_u32 vcc, 1, v3
  v_cndmask_b32 v9, 0, v2, vcc
  v_cmp_eq_u32 vcc, 2, v3
  v_cndmask_b32 v10, 0, v2, vcc
  v_cmp_eq_u32 vcc, 3, v3
  v_cndmask_b32 v11, 0, v2, vcc
  v_cmp_eq_u32 vcc, 4, v3
  v_cndmask_b32 v12, 0, v2, vcc
  v_cmp_eq_u32 vcc, 5, v3
  v_cndmask_b32 v13, 0, v2, vcc
  v_cmp_eq_u32 vcc, 6, v3
  v_cndmask_b32 v14, 0, v2, vcc
  v_cmp_eq_u32 vcc, 7, v3
  v_cndmask_b32 v15, 0, v2, vcc
  v_and_b32 v2, 7, v0
  v_lshrrev_b32 v0, 3, v0
  v_mul_u32_u24 v2, 896, v2
  v_lshl_add_u32 v0, v0, 4, v2
  v_lshl_add_u32 v0, v6, 6, v0
  s_mov_b32 s34, 0x3f317218
L_pk_psum:
  s_waitcnt vmcnt(7)
  v_mfma_f32_16x16x32_bf16 v[16:19], v[8:11], v[32:35], 0
  s_waitcnt vmcnt(6)
  v_mfma_f32_16x16x32_bf16 v[16:19], v[8:11], v[36:39], v[16:19]
  s_waitcnt vmcnt(5)
  v_mfma_f32_16x16x32_bf16 v[16:19], v[12:15], v[40:43], v[16:19]
  s_waitcnt vmcnt(4)
  v_mfma_f32_16x16x32_bf16 v[16:19], v[12:15], v[44:47], v[16:19]
  s_waitcnt vmcnt(3)
  v_mfma_f32_16x16x32_bf16 v[20:23], v[8:11], v[48:51], 0
  s_waitcnt vmcnt(2)
  v_mfma_f32_16x16x32_bf16 v[20:23], v[8:11], v[52:55], v[20:23]
  s_waitcnt vmcnt(1)
  v_mfma_f32_16x16x32_bf16 v[20:23], v[12:15], v[56:59], v[20:23]
  s_waitcnt vmcnt(0)
  v_mfma_f32_16x16x32_bf16 v[20:23], v[12:15], v[60:63], v[20:23]
  s_waitcnt lgkmcnt(0)
  s_nop 6
  v_cmp_u_f32 vcc, v16, v20
  s_cbranch_vccnz L_pk_pfix
L_pk_pok:
  v_fmac_f32 v24, s34, v16
  v_fmac_f32 v25, s34, v17
  v_fmac_f32 v26, s34, v18
  v_fmac_f32 v27, s34, v19
  v_fmac_f32 v28, s34, v20
  v_fmac_f32 v29, s34, v21
  v_fmac_f32 v30, s34, v22
  v_fmac_f32 v31, s34, v23
  v_cvt_pk_bf16_f32 v32, v24, v25
  v_cvt_pk_bf16_f32 v34, v28, v29
  v_cvt_pk_bf16_f32 v33, v26, v27
  v_cvt_pk_bf16_f32 v35, v30, v31
  s_nop 0
  v_permlane16_swap_b32 v32, v34
  v_permlane16_swap_b32 v33, v35
  s_mov_b32 exec_hi, 0xffffff
  buffer_store_dwordx4 v[32:35], v0, s[24:27], s44 offen
  s_endpgm
L_pk_end:
  s_endpgm
.p2alignl 6, 0xbf800000
L_pk_fa:
L_wm_L_pk_fa:
  s_cbranch_execz L_wm_L_pk_fb5
L_pk_far27:
  buffer_store_dwordx4 v[64:67], v4, s[28:31], s40 offen sc1
  s_branch L_pk_near27
L_pk_far28:
  buffer_store_dwordx4 v[68:71], v5, s[28:31], s40 offen sc1
  s_branch L_pk_near28
L_pk_far29:
  buffer_store_dwordx4 v[72:75], v6, s[28:31], s40 offen sc1
  s_branch L_pk_near29
L_pk_far30:
  buffer_store_dwordx4 v[76:79], v7, s[28:31], s40 offen sc1
  s_branch L_pk_near30
L_pk_far31:
  buffer_store_dwordx4 v[64:67], v4, s[28:31], s41 offen sc1
  s_branch L_pk_near31
L_pk_fb5:
L_wm_L_pk_fb5:
  s_cbranch_execz L_wm_L_pk_await
L_pk_far32:
  buffer_store_dwordx4 v[68:71], v5, s[28:31], s41 offen sc1
  s_branch L_pk_near32
L_pk_far33:
  buffer_store_dwordx4 v[72:75], v6, s[28:31], s41 offen sc1
  s_branch L_pk_near33
L_pk_far34:
  buffer_store_dwordx4 v[76:79], v7, s[28:31], s41 offen sc1
  s_branch L_pk_near34
L_pk_pfix:
  s_mov_b32 s35, 0
  v_max3_u32 v2, v32, v33, v34
  v_max_u32 v2, v2, v35
  v_cmp_eq_u32 vcc, -1, v2
  s_cbranch_vccz L_pk_pf0
  buffer_load_dwordx4 v[32:35], v4, s[28:31], s23 offen offset:0 sc1
  s_mov_b32 s35, 1
L_pk_pf0:
  v_max3_u32 v2, v36, v37, v38
  v_max_u32 v2, v2, v39
  v_cmp_eq_u32 vcc, -1, v2
  s_cbranch_vccz L_pk_pf1
  buffer_load_dwordx4 v[36:39], v4, s[28:31], s5 offen offset:0 sc1
  s_mov_b32 s35, 1
L_pk_pf1:
  v_max3_u32 v2, v40, v41, v42
  v_max_u32 v2, v2, v43
  v_cmp_eq_u32 vcc, -1, v2
  s_cbranch_vccz L_pk_pf2
  buffer_load_dwordx4 v[40:43], v4, s[28:31], s23 offen offset:256 sc1
  s_mov_b32 s35, 1
L_pk_pf2:
  v_max3_u32 v2, v44, v45, v46
  v_max_u32 v2, v2, v47
  v_cmp_eq_u32 vcc, -1, v2
  s_cbranch_vccz L_pk_pf3
  buffer_load_dwordx4 v[44:47], v4, s[28:31], s5 offen offset:256 sc1
  s_mov_b32 s35, 1
L_pk_pf3:
  v_max3_u32 v2, v48, v49, v50
  v_max_u32 v2, v2, v51
  v_cmp_eq_u32 vcc, -1, v2
  s_cbranch_vccz L_pk_pf4
  buffer_load_dwordx4 v[48:51], v4, s[28:31], s23 offen offset:512 sc1
  s_mov_b32 s35, 1
L_pk_pf4:
  v_max3_u32 v2, v52, v53, v54
  v_max_u32 v2, v2, v55
  v_cmp_eq_u32 vcc, -1, v2
  s_cbranch_vccz L_pk_pf5
  buffer_load_dwordx4 v[52:55], v4, s[28:31], s5 offen offset:512 sc1
  s_mov_b32 s35, 1
L_pk_pf5:
  v_max3_u32 v2, v56, v57, v58
  v_max_u32 v2, v2, v59
  v_cmp_eq_u32 vcc, -1, v2
  s_cbranch_vccz L_pk_pf6
  buffer_load_dwordx4 v[56:59], v5, s[28:31], s23 offen offset:768 sc1
  s_mov_b32 s35, 1
L_pk_pf6:
  v_max3_u32 v2, v60, v61, v62
  v_max_u32 v2, v2, v63
  v_cmp_eq_u32 vcc, -1, v2
  s_cbranch_vccz L_pk_pf7
  buffer_load_dwordx4 v[60:63], v5, s[28:31], s5 offen offset:768 sc1
  s_mov_b32 s35, 1
L_pk_pf7:
  s_cmp_eq_u32 s35, 0
  s_cbranch_scc1 L_pk_pok
  s_waitcnt vmcnt(0)
  s_sub_u32 s36, s36, 1
  s_cbranch_scc0 L_pk_psum
  s_branch L_pk_pok
L_pk_rec0:
  ds_read_b128 v[12:15], v110 offset:0
  s_waitcnt lgkmcnt(0)
  v_cmp_eq_u32 vcc, 0, v15
  s_cbranch_vccnz L_pk_rec0
  s_branch L_pk_recok0
L_pk_h3:
  ds_read_b32 v48, v106 offset:4
  s_waitcnt lgkmcnt(0)
  v_cmp_ne_u32 vcc, 4, v48
  s_cbranch_vccnz L_pk_h3
  s_branch L_pk_h3ok
L_pk_rec1:
  ds_read_b128 v[12:15], v110 offset:512
  s_waitcnt lgkmcnt(0)
  v_cmp_eq_u32 vcc, 0, v15
  s_cbranch_vccnz L_pk_rec1
  s_branch L_pk_recok1
L_pk_idle7:
L_wm_L_pk_idle7:
  s_cbranch_execz L_wm_P11
  s_setprio 3
  s_mov_b32 exec_hi, 0
  ds_read_b128 v[32:35], v104 offset:3584
  ds_read_b128 v[36:39], v104 offset:7680
  ds_read_b128 v[40:43], v104 offset:11776
  ds_read_b128 v[44:47], v104 offset:15872
  ds_read_b128 v[48:51], v104 offset:19968
  ds_read_b128 v[52:55], v104 offset:24064
  ds_read_b128 v[56:59], v104 offset:28160
  ds_read_b128 v[60:63], v104 offset:32256
  v_add_u32 v2, 157696, v104
  s_waitcnt lgkmcnt(7)
  v_add_f32 v32, v32, v34
  v_add_f32 v33, v33, v35
  s_waitcnt lgkmcnt(6)
  v_add_f32 v36, v36, v38
  v_add_f32 v32, v32, v36
  v_add_f32 v37, v37, v39
  v_add_f32 v33, v33, v37
  s_waitcnt lgkmcnt(5)
  v_add_f32 v40, v40, v42
  v_add_f32 v32, v32, v40
  v_add_f32 v41, v41, v43
  v_add_f32 v33, v33, v41
  s_waitcnt lgkmcnt(4)
  v_add_f32 v44, v44, v46
  v_add_f32 v32, v32, v44
  v_add_f32 v45, v45, v47
  v_add_f32 v33, v33, v45
  s_waitcnt lgkmcnt(3)
  v_add_f32 v48, v48, v50
  v_add_f32 v32, v32, v48
  v_add_f32 v49, v49, v51
  v_add_f32 v33, v33, v49
  s_waitcnt lgkmcnt(2)
  v_add_f32 v52, v52, v54
  v_add_f32 v32, v32, v52
  v_add_f32 v53, v53, v55
  v_add_f32 v33, v33, v53
  s_waitcnt lgkmcnt(1)
  v_add_f32 v56, v56, v58
  v_add_f32 v32, v32, v56
  v_add_f32 v57, v57, v59
  v_add_f32 v33, v33, v57
  s_waitcnt lgkmcnt(0)
  v_add_f32 v60, v60, v62
  v_add_f32 v32, v32, v60
  v_add_f32 v61, v61, v63
  v_add_f32 v33, v33, v61
  v_mul_f32 v32, 0xbb124925, v32
  v_mul_f32 v33, 0x3b124925, v33
  v_fma_f32 v33, -v32, v32, v33
  v_max_f32 v33, 0, v33
  v_add_f32 v33, 0x3727c5ac, v33
  v_rsq_f32 v34, v33
  s_nop 0
  v_mul_f32 v33, v33, v34
  v_mul_f32 v15, 0x3fb8aa3b, v34
  v_cvt_pk_bf16_f32 v12, v32, v33
  v_and_b32 v15, 0xffffff7f, v15
  v_lshlrev_b32 v34, 16, v12
  v_and_b32 v35, 0xffff0000, v12
  v_or_b32 v15, 1, v15
  v_sub_f32 v32, v32, v34
  v_sub_f32 v33, v33, v35
  v_mov_b32 v14, v12
  v_cvt_pk_bf16_f32 v13, v32, v33
  s_nop 0
  ds_write_b128 v2, v[12:15]
  ds_write_b128 v2, v[12:15] offset:1024
  s_mov_b64 exec, -1
  s_waitcnt vmcnt(0)
L_pk_h7chk:
L_wm_P11:
  s_cbranch_execz L_wm_L_pk_o0again
  ds_read_b128 v[16:19], v3 offset:16384
  ds_read_b128 v[20:23], v3 offset:17408
  ds_read_b128 v[24:27], v3 offset:18432
  ds_read_b128 v[28:31], v3 offset:19456
  ds_read_b128 v[32:35], v3 offset:32768
  ds_read_b128 v[36:39], v3 offset:33792
  ds_read_b128 v[40:43], v3 offset:34816
  ds_read_b128 v[44:47], v3 offset:35840
  s_waitcnt lgkmcnt(7)
  v_max3_u32 v48, v16, v17, 0
  v_max3_u32 v48, v18, v19, v48
  s_waitcnt lgkmcnt(6)
  v_max3_u32 v48, v20, v21, v48
  v_max3_u32 v48, v22, v23, v48
  s_waitcnt lgkmcnt(5)
  v_max3_u32 v48, v24, v25, v48
  v_max3_u32 v48, v26, v27, v48
  s_waitcnt lgkmcnt(4)
  v_max3_u32 v48, v28, v29, v48
  v_max3_u32 v48, v30, v31, v48
  s_waitcnt lgkmcnt(3)
  v_max3_u32 v48, v32, v33, v48
  v_max3_u32 v48, v34, v35, v48
  s_waitcnt lgkmcnt(2)
  v_max3_u32 v48, v36, v37, v48
  v_max3_u32 v48, v38, v39, v48
  s_waitcnt lgkmcnt(1)
  v_max3_u32 v48, v40, v41, v48
  v_max3_u32 v48, v42, v43, v48
  s_waitcnt lgkmcnt(0)
  v_max3_u32 v48, v44, v45, v48
  v_max3_u32 v48, v46, v47, v48
  v_cmp_eq_u32 vcc, -1, v48
  s_cbranch_vccnz L_pk_h7again
L_pk_h7ok:
  v_mov_b32 v48, 1
  s_mov_b64 exec, 1
  ds_add_u32 v106, v48 offset:4
  s_mov_b64 exec, -1
L_pk_h8:
  ds_read_b32 v48, v106 offset:4
  s_waitcnt lgkmcnt(0)
  v_cmp_ne_u32 vcc, 4, v48
  s_cbranch_vccz L_pk_h9
  s_sleep 1
  s_branch L_pk_h8
L_pk_h9:
  s_setprio 3
  s_mov_b32 exec_lo, 0
  ds_read_b128 v[32:35], v104 offset:35840
  ds_read_b128 v[36:39], v104 offset:39936
  ds_read_b128 v[40:43], v104 offset:44032
  ds_read_b128 v[44:47], v104 offset:48128
  ds_read_b128 v[48:51], v104 offset:52224
  ds_read_b128 v[52:55], v104 offset:56320
  ds_read_b128 v[56:59], v104 offset:60416
  ds_read_b128 v[60:63], v104 offset:64512
  v_add_u32 v2, 157696, v104
  s_waitcnt lgkmcnt(7)
  v_add_f32 v32, v32, v34
  v_add_f32 v33, v33, v35
  s_waitcnt lgkmcnt(6)
  v_add_f32 v36, v36, v38
  v_add_f32 v32, v32, v36
  v_add_f32 v37, v37, v39
  v_add_f32 v33, v33, v37
  s_waitcnt lgkmcnt(5)
  v_add_f32 v40, v40, v42
  v_add_f32 v32, v32, v40
  v_add_f32 v41, v41, v43
  v_add_f32 v33, v33, v41
  s_waitcnt lgkmcnt(4)
  v_add_f32 v44, v44, v46
  v_add_f32 v32, v32, v44
  v_add_f32 v45, v45, v47
  v_add_f32 v33, v33, v45
  s_waitcnt lgkmcnt(3)
  v_add_f32 v48, v48, v50
  v_add_f32 v32, v32, v48
  v_add_f32 v49, v49, v51
  v_add_f32 v33, v33, v49
  s_waitcnt lgkmcnt(2)
  v_add_f32 v52, v52, v54
  v_add_f32 v32, v32, v52
  v_add_f32 v53, v53, v55
  v_add_f32 v33, v33, v53
  s_waitcnt lgkmcnt(1)
  v_add_f32 v56, v56, v58
  v_add_f32 v32, v32, v56
  v_add_f32 v57, v57, v59
  v_add_f32 v33, v33, v57
  s_waitcnt lgkmcnt(0)
  v_add_f32 v60, v60, v62
  v_add_f32 v32, v32, v60
  v_add_f32 v61, v61, v63
  v_add_f32 v33, v33, v61
  v_mul_f32 v32, 0xbb124925, v32
  v_mul_f32 v33, 0x3b124925, v33
  v_fma_f32 v33, -v32, v32, v33
  v_max_f32 v33, 0, v33
  v_add_f32 v33, 0x3727c5ac, v33
  v_rsq_f32 v34, v33
  s_nop 0
  v_mul_f32 v33, v33, v34
  v_mul_f32 v15, 0x3fb8aa3b, v34
  v_cvt_pk_bf16_f32 v12, v32, v33
  v_and_b32 v15, 0xffffff7f, v15
  v_lshlrev_b32 v34, 16, v12
  v_and_b32 v35, 0xffff0000, v12
  v_or_b32 v15, 1, v15
  v_sub_f32 v32, v32, v34
  v_sub_f32 v33, v33, v35
  v_mov_b32 v14, v12
  v_cvt_pk_bf16_f32 v13, v32, v33
  s_nop 0
  ds_write_b128 v2, v[12:15]
  ds_write_b128 v2, v[12:15] offset:1024
  s_mov_b64 exec, -1
  s_setprio 0
  s_cmp_lg_u32 s2, 0
  s_cbranch_scc1 L_pk_noep
  v_mov_b32 v2, s48
  v_mov_b32 v3, 0
  s_mov_b32 s34, 2457600
  s_mov_b64 exec, 1
  buffer_store_dword v2, v3, s[28:31], s34 offen sc1
  s_mov_b64 exec, -1
L_pk_noep:
  s_mov_b64 exec, 0
  s_cmp_eq_u32 s3, 7
  s_cbranch_scc1 L_wm_L_pk_fa
L_wm_back1:
  s_mov_b64 exec, -1
  v_and_b32 v2, 31, v1
  v_min_u32 v2, 27, v2
  v_lshlrev_b32 v2, 7, v2
  v_lshrrev_b32 v3, 5, v1
  v_mul_u32_u24 v3, 7168, v3
  v_add_u32 v2, v2, v3
  s_mov_b32 m0, 147456
  s_barrier
L_pk_tw:
  s_sleep 16
  s_cmp_lg_u32 s49, 0
  s_cbranch_scc1 L_pk_notch
  s_cmp_lt_u32 s33, 4
  s_cselect_b32 s35, 225792, 0
  s_add_u32 s35, s35, s23
  s_add_u32 s34, s35, -2688
  buffer_load_dword v2, s[28:31], s34 offen sc1 lds
  s_add_u32 s34, s35, 11648
  buffer_load_dword v2, s[28:31], s34 offen sc1 lds
  s_add_u32 s34, s35, 25984
  buffer_load_dword v2, s[28:31], s34 offen sc1 lds
  s_add_u32 s34, s35, 40320
  buffer_load_dword v2, s[28:31], s34 offen sc1 lds
L_pk_notch:
  s_barrier
  s_cmp_lt_u32 s33, 4
  s_cselect_b32 s35, -2, 0
  s_branch L_pk_await
L_pk_o0again:
L_wm_L_pk_o0again:
  s_cbranch_execz L_wm_L_pk_o1again
  s_sub_u32 s37, s37, 1
  s_cbranch_scc1 L_pk_o0ok
  s_mov_b32 m0, s34
  s_nop 0
  buffer_load_dwordx4 v104, s[28:31], s38 offen offset:0 sc1 lds
  buffer_load_dwordx4 v104, s[28:31], s38 offen offset:1024 sc1 lds
  buffer_load_dwordx4 v104, s[28:31], s38 offen offset:2048 sc1 lds
  buffer_load_dwordx4 v104, s[28:31], s38 offen offset:3072 sc1 lds
  s_mov_b32 m0, s35
  s_nop 0
  buffer_load_dwordx4 v104, s[28:31], s39 offen offset:0 sc1 lds
  buffer_load_dwordx4 v104, s[28:31], s39 offen offset:1024 sc1 lds
  buffer_load_dwordx4 v104, s[28:31], s39 offen offset:2048 sc1 lds
  s_waitcnt vmcnt(0)
  s_branch L_pk_o0chk
L_pk_h0again:
  s_sub_u32 s37, s37, 1
  s_cbranch_scc1 L_pk_h0ok
  s_mov_b32 m0, s34
  s_nop 0
  buffer_load_dwordx4 v104, s[28:31], s38 offen offset:0 sc1 lds
  buffer_load_dwordx4 v104, s[28:31], s38 offen offset:1024 sc1 lds
  buffer_load_dwordx4 v104, s[28:31], s38 offen offset:2048 sc1 lds
  buffer_load_dwordx4 v104, s[28:31], s38 offen offset:3072 sc1 lds
  s_waitcnt vmcnt(0)
  s_branch L_pk_h0chk
L_pk_o1again:
L_wm_L_pk_o1again:
  s_cbranch_execz L_wm_back0
  s_sub_u32 s37, s37, 1
  s_cbranch_scc1 L_pk_o1ok
  s_mov_b32 m0, s34
  s_nop 0
  buffer_load_dwordx4 v104, s[28:31], s38 offen offset:0 sc1 lds
  buffer_load_dwordx4 v104, s[28:31], s38 offen offset:1024 sc1 lds
  buffer_load_dwordx4 v104, s[28:31], s38 offen offset:2048 sc1 lds
  buffer_load_dwordx4 v104, s[28:31], s38 offen offset:3072 sc1 lds
  s_mov_b32 m0, s35
  s_nop 0
  buffer_load_dwordx4 v104, s[28:31], s39 offen offset:0 sc1 lds
  buffer_load_dwordx4 v104, s[28:31], s39 offen offset:1024 sc1 lds
  buffer_load_dwordx4 v104, s[28:31], s39 offen offset:2048 sc1 lds
  s_waitcnt vmcnt(0)
  s_branch L_pk_o1chk
L_pk_h1again:
  s_sub_u32 s37, s37, 1
  s_cbranch_scc1 L_pk_h1ok
  s_mov_b32 m0, s34
  s_nop 0
  buffer_load_dwordx4 v104, s[28:31], s38 offen offset:0 sc1 lds
  buffer_load_dwordx4 v104, s[28:31], s38 offen offset:1024 sc1 lds
  buffer_load_dwordx4 v104, s[28:31], s38 offen offset:2048 sc1 lds
  buffer_load_dwordx4 v104, s[28:31], s38 offen offset:3072 sc1 lds
  s_waitcnt vmcnt(0)
  s_branch L_pk_h1chk
L_pk_h2again:
  s_sub_u32 s10, s10, 1
  s_cbranch_scc1 L_pk_h2ok
  s_mov_b32 m0, s11
  s_nop 0
  buffer_load_dwordx4 v104, s[28:31], s12 offen offset:0 sc1 lds
  buffer_load_dwordx4 v104, s[28:31], s12 offen offset:1024 sc1 lds
  buffer_load_dwordx4 v104, s[28:31], s12 offen offset:2048 sc1 lds
  buffer_load_dwordx4 v104, s[28:31], s12 offen offset:3072 sc1 lds
  s_mov_b32 m0, s8
  s_nop 0
  buffer_load_dwordx4 v104, s[28:31], s9 offen offset:0 sc1 lds
  buffer_load_dwordx4 v104, s[28:31], s9 offen offset:1024 sc1 lds
  buffer_load_dwordx4 v104, s[28:31], s9 offen offset:2048 sc1 lds
  buffer_load_dwordx4 v104, s[28:31], s9 offen offset:3072 sc1 lds
  s_waitcnt vmcnt(0)
  s_branch L_pk_h2chk
L_pk_h7again:
  s_sub_u32 s10, s10, 1
  s_cbranch_scc1 L_pk_h7ok
  s_mov_b32 m0, s11
  s_nop 0
  buffer_load_dwordx4 v104, s[28:31], s12 offen offset:0 sc1 lds
  buffer_load_dwordx4 v104, s[28:31], s12 offen offset:1024 sc1 lds
  buffer_load_dwordx4 v104, s[28:31], s12 offen offset:2048 sc1 lds
  buffer_load_dwordx4 v104, s[28:31], s12 offen offset:3072 sc1 lds
  s_mov_b32 m0, s8
  s_nop 0
  buffer_load_dwordx4 v104, s[28:31], s9 offen offset:0 sc1 lds
  buffer_load_dwordx4 v104, s[28:31], s9 offen offset:1024 sc1 lds
  buffer_load_dwordx4 v104, s[28:31], s9 offen offset:2048 sc1 lds
  buffer_load_dwordx4 v104, s[28:31], s9 offen offset:3072 sc1 lds
  s_waitcnt vmcnt(0)
  s_branch L_pk_h7chk
L_pk_slow:
  buffer_load_dwordx4 v104, s[28:31], s40 offen offset:2048 sc1 lds
  buffer_load_dwordx4 v104, s[28:31], s40 offen offset:3072 sc1 lds
  s_add_u32 s40, s40, 16384
  s_and_b32 s40, s40, 0x1ffff
  s_or_b32 s40, s40, s12
  s_add_u32 s39, s40, 0x20000
  buffer_store_dwordx4 v[240:243], v236, s[28:31], 0 offen sc1
  buffer_store_dwordx4 v[244:247], v237, s[28:31], 0 offen sc1
  buffer_store_dwordx4 v[248:251], v238, s[28:31], 0 offen sc1
  buffer_store_dwordx4 v[252:255], v239, s[28:31], 0 offen sc1
  s_cmp_ge_u32 s3, 4
  s_cbranch_scc1 L_pk_sr1
  v_and_b32 v2, 31, v1
  s_lshr_b32 s34, s46, 2
  s_lshl_b32 s34, s34, 8
  s_and_b32 s35, s46, 3
  s_lshl_b32 s35, s35, 1
  s_add_u32 s34, s34, s35
  v_lshl_add_u32 v234, v2, 3, s34
  s_lshl_b32 s35, s32, 1
  s_lshr_b32 s36, s3, 1
  s_add_u32 s35, s35, s36
  s_mul_i32 s35, s35, 28672
  s_mul_i32 s36, s33, 112
  s_add_u32 s35, s35, s36
  s_and_b32 s36, s3, 1
  s_lshl_b32 s36, s36, 6
  s_add_u32 s35, s35, s36
  v_and_b32 v2, 15, v1
  v_mul_u32_u24 v2, 896, v2
  v_bfe_u32 v3, v1, 4, 1
  v_lshl_add_u32 v2, v3, 5, v2
  v_lshrrev_b32 v3, 5, v1
  v_lshl_add_u32 v2, v3, 4, v2
  v_add_u32 v232, s35, v2
  v_add_u32 v233, 14336, v232
  buffer_load_ushort v4, v234, s[4:7], 0 offen
  buffer_load_dwordx4 v[224:227], v232, s[16:19], 0 offen
  buffer_load_dwordx4 v[228:231], v233, s[16:19], 0 offen
  s_branch L_pk_sgo
L_pk_sr1:
  v_and_b32 v2, 31, v1
  s_lshr_b32 s34, s46, 2
  s_lshl_b32 s34, s34, 8
  s_and_b32 s35, s46, 3
  s_lshl_b32 s35, s35, 1
  s_add_u32 s34, s34, s35
  v_lshl_add_u32 v234, v2, 3, s34
  buffer_load_ushort v4, v234, s[4:7], 0 offen
  s_lshl_b32 s39, s43, 2
  s_add_u32 s39, s39, s20
  s_lshl_b32 s39, s39, 12
  s_add_u32 s39, s39, 23068672
  s_add_u32 s40, s39, 0x10000
  s_cmp_lt_u32 s33, 4
  s_cselect_b32 s34, 0, 0x40000000
  v_or_b32 v7, s34, v104
  v_mov_b32 v108, -1
  v_mov_b32 v109, -1
  v_mov_b32 v110, -1
  v_mov_b32 v111, -1
  s_cmp_lg_u32 s49, 0
  s_cbranch_scc1 L_pk_far37
  buffer_store_dwordx4 v[108:111], v7, s[28:31], s39 offen offset:0
  buffer_store_dwordx4 v[108:111], v7, s[28:31], s39 offen offset:1024
L_pk_near37:
  s_cmp_lg_u32 s49, 0
  s_cbranch_scc1 L_pk_far38
  buffer_store_dwordx4 v[108:111], v7, s[28:31], s39 offen offset:2048
  buffer_store_dwordx4 v[108:111], v7, s[28:31], s39 offen offset:3072
L_pk_near38:
  s_cmp_lg_u32 s49, 0
  s_cbranch_scc1 L_pk_far39
  buffer_store_dwordx4 v[108:111], v7, s[28:31], s40 offen offset:0
  buffer_store_dwordx4 v[108:111], v7, s[28:31], s40 offen offset:1024
L_pk_near39:
  s_cmp_lg_u32 s49, 0
  s_cbranch_scc1 L_pk_far40
  buffer_store_dwordx4 v[108:111], v7, s[28:31], s40 offen offset:2048
  buffer_store_dwordx4 v[108:111], v7, s[28:31], s40 offen offset:3072
L_pk_near40:
  s_cmp_lg_u32 s49, 0
  s_cbranch_scc1 L_pk_far41
  buffer_store_dwordx4 v[108:111], v5, s[28:31], s51 offen offset:0
  buffer_store_dwordx4 v[108:111], v5, s[28:31], s51 offen offset:3584
L_pk_near41:
  s_add_u32 s51, s51, 7168
  s_cmp_lg_u32 s49, 0
  s_cbranch_scc1 L_pk_far42
  buffer_store_dwordx4 v[108:111], v5, s[28:31], s51 offen offset:0
  buffer_store_dwordx4 v[108:111], v5, s[28:31], s51 offen offset:3584
L_pk_near42:
  s_add_u32 s51, s51, 7168
  s_cmp_lg_u32 s49, 0
  s_cbranch_scc1 L_pk_far43
  buffer_store_dwordx4 v[108:111], v5, s[28:31], s51 offen offset:0
  buffer_store_dwordx4 v[108:111], v5, s[28:31], s51 offen offset:3584
L_pk_near43:
  s_add_u32 s51, s51, 7168
  s_cmp_lg_u32 s49, 0
  s_cbranch_scc1 L_pk_far44
  buffer_store_dwordx4 v[108:111], v5, s[28:31], s51 offen offset:0
  buffer_store_dwordx4 v[108:111], v5, s[28:31], s51 offen offset:3584
L_pk_near44:
  s_add_u32 s51, s51, 7168
  s_cmp_lg_u32 s49, 0
  s_cbranch_scc1 L_pk_far45
  buffer_store_dwordx4 v[108:111], v5, s[28:31], s51 offen offset:0
  buffer_store_dwordx4 v[108:111], v5, s[28:31], s51 offen offset:3584
L_pk_near45:
  s_add_u32 s51, s51, 7168
  s_cmp_lg_u32 s49, 0
  s_cbranch_scc1 L_pk_far46
  buffer_store_dwordx4 v[108:111], v5, s[28:31], s51 offen offset:0
  buffer_store_dwordx4 v[108:111], v5, s[28:31], s51 offen offset:3584
L_pk_near46:
  s_add_u32 s51, s51, 7168
  s_cmp_lg_u32 s49, 0
  s_cbranch_scc1 L_pk_far47
  buffer_store_dwordx4 v[108:111], v5, s[28:31], s51 offen offset:0
  buffer_store_dwordx4 v[108:111], v5, s[28:31], s51 offen offset:3584
L_pk_near47:
  s_add_u32 s51, s51, 7168
  s_cmp_lg_u32 s49, 0
  s_cbranch_scc1 L_pk_far48
  buffer_store_dwordx4 v[108:111], v5, s[28:31], s51 offen offset:0
  buffer_store_dwordx4 v[108:111], v5, s[28:31], s51 offen offset:3584
L_pk_near48:
  s_add_u32 s51, s51, 7168
L_pk_sgo:
  v_mov_b32 v16, 0
  v_mov_b32 v17, 0
  v_mov_b32 v18, 0
  v_mov_b32 v19, 0
  v_mov_b32 v20, 0
  v_mov_b32 v21, 0
  v_mov_b32 v22, 0
  v_mov_b32 v23, 0
  v_mov_b32 v24, 0
  v_mov_b32 v25, 0
  v_mov_b32 v26, 0
  v_mov_b32 v27, 0
  v_mov_b32 v28, 0
  v_mov_b32 v29, 0
  v_mov_b32 v30, 0
  v_mov_b32 v31, 0
  v_mov_b32 v107, 0xff61b1e6
  s_mov_b32 s37, 0
L_pk_sloop:
  s_waitcnt vmcnt(0)
  s_barrier
L_pk_sfirst:
  s_cmp_ge_u32 s3, 4
  s_cbranch_scc1 L_pk_swork
  s_cmp_lg_u32 s37, 2
  s_cbranch_scc1 L_pk_snofs
  s_lshl_b32 s34, s2, 2
  s_add_u32 s34, s34, 2392064
  s_cmp_eq_u32 s3, 0
  v_mov_b32 v2, 0
  v_mov_b32 v3, s48
  s_cselect_b64 exec, 1, 0
  buffer_store_dword v3, v2, s[28:31], s34 offen sc1
  s_mov_b64 exec, -1
L_pk_snofs:
  s_cmp_lg_u32 s37, 3
  s_cbranch_scc1 L_pk_snofb
  s_mov_b32 s38, 1048576
L_pk_fbt:
  s_sleep 8
  v_lshlrev_b32 v2, 4, v1
  s_cmp_eq_u32 s3, 0
  s_cselect_b64 exec, -1, 0
  s_mov_b32 s34, 2392064
  buffer_load_dwordx4 v[108:111], v2, s[28:31], s34 offen sc1
  s_mov_b64 exec, -1
  s_waitcnt vmcnt(0)
  s_cmp_eq_u32 s3, 0
  s_cselect_b64 exec, -1, 0
  v_xor_b32 v108, s48, v108
  v_xor_b32 v109, s48, v109
  v_xor_b32 v110, s48, v110
  v_xor_b32 v111, s48, v111
  v_or3_b32 v108, v108, v109, v110
  v_or_b32 v108, v108, v111
  v_cmp_ne_u32 vcc, 0, v108
  s_mov_b64 exec, -1
  s_sub_u32 s38, s38, 1
  s_cbranch_scc1 L_pk_fbtx
  s_cbranch_vccnz L_pk_fbt
L_pk_fbtx:
L_pk_snofb:
  s_cmp_ge_u32 s37, 6
  s_cbranch_scc1 L_pk_swo
  s_add_u32 s34, s37, 2
  s_and_b32 s34, s34, 3
  s_lshl_b32 s34, s34, 15
  s_add_u32 s34, s34, s41
  s_add_u32 m0, s34, 0
  s_nop 0
  buffer_load_dwordx4 v104, s[28:31], s40 offen offset:0 sc1 lds
  buffer_load_dwordx4 v104, s[28:31], s40 offen offset:1024 sc1 lds
  buffer_load_dwordx4 v104, s[28:31], s40 offen offset:2048 sc1 lds
  buffer_load_dwordx4 v104, s[28:31], s40 offen offset:3072 sc1 lds
  s_add_u32 m0, s34, 16384
  s_nop 0
  buffer_load_dwordx4 v104, s[28:31], s39 offen offset:0 sc1 lds
  buffer_load_dwordx4 v104, s[28:31], s39 offen offset:1024 sc1 lds
  buffer_load_dwordx4 v104, s[28:31], s39 offen offset:2048 sc1 lds
  buffer_load_dwordx4 v104, s[28:31], s39 offen offset:3072 sc1 lds
  s_add_u32 s40, s40, 16384
  s_and_b32 s40, s40, 0x1ffff
  s_or_b32 s40, s40, s12
  s_add_u32 s39, s40, 0x20000
  s_branch L_pk_swork
L_pk_swo:
  s_add_u32 m0, s13, 0
  s_add_u32 s34, s22, 0
  buffer_load_dwordx4 v104, s[28:31], s34 offen offset:0 sc1 lds
  s_add_u32 m0, s13, 0
  s_add_u32 s34, s22, 0
  buffer_load_dwordx4 v104, s[28:31], s34 offen offset:1024 sc1 lds
  s_add_u32 m0, s13, 0
  s_add_u32 s34, s22, 0
  buffer_load_dwordx4 v104, s[28:31], s34 offen offset:2048 sc1 lds
  s_add_u32 m0, s13, 0
  s_add_u32 s34, s22, 0
  buffer_load_dwordx4 v104, s[28:31], s34 offen offset:3072 sc1 lds
  s_add_u32 m0, s13, 4096
  s_add_u32 s34, s22, 4096
  buffer_load_dwordx4 v104, s[28:31], s34 offen offset:0 sc1 lds
  s_add_u32 m0, s13, 4096
  s_add_u32 s34, s22, 4096
  buffer_load_dwordx4 v104, s[28:31], s34 offen offset:1024 sc1 lds
  s_add_u32 m0, s13, 4096
  s_add_u32 s34, s22, 4096
  buffer_load_dwordx4 v104, s[28:31], s34 offen offset:2048 sc1 lds
  s_add_u32 s13, s13, 28672
  s_add_u32 s22, s22, 28672
L_pk_swork:
  s_and_b32 s34, s37, 3
  s_lshl_b32 s34, s34, 15
  v_add_u32 v2, s34, v105
  s_mov_b32 s36, 0
L_pk_stile:
  ds_read_b128 v[72:75], v2
  ds_read_b128 v[76:79], v2 offset:1024
  ds_read_b128 v[88:91], v2 offset:2048
  ds_read_b128 v[92:95], v2 offset:3072
  v_add_u32 v2, 4096, v2
  s_waitcnt lgkmcnt(0)
  v_mfma_f32_32x32x16_bf16 v[32:47], v[72:75], v[8:11], 0
  v_mfma_f32_32x32x16_bf16 v[32:47], v[76:79], v[12:15], v[32:47]
  s_nop 15
  v_max3_f32 v108, v32, v33, v107
  v_max3_f32 v108, v34, v35, v108
  v_max3_f32 v108, v36, v37, v108
  v_max3_f32 v108, v38, v39, v108
  v_max3_f32 v108, v40, v41, v108
  v_max3_f32 v108, v42, v43, v108
  v_max3_f32 v108, v44, v45, v108
  v_max3_f32 v108, v46, v47, v108
  v_mov_b32 v109, v108
  s_nop 1
  v_permlane32_swap_b32 v108, v109
  s_nop 1
  v_max_f32 v108, v108, v109
  v_sub_f32 v110, v107, v108
  v_exp_f32 v110, v110
  v_mov_b32 v107, v108
  v_sub_f32 v32, v32, v108
  v_mul_f32 v16, v16, v110
  v_sub_f32 v33, v33, v108
  v_mul_f32 v17, v17, v110
  v_sub_f32 v34, v34, v108
  v_mul_f32 v18, v18, v110
  v_sub_f32 v35, v35, v108
  v_mul_f32 v19, v19, v110
  v_sub_f32 v36, v36, v108
  v_mul_f32 v20, v20, v110
  v_sub_f32 v37, v37, v108
  v_mul_f32 v21, v21, v110
  v_sub_f32 v38, v38, v108
  v_mul_f32 v22, v22, v110
  v_sub_f32 v39, v39, v108
  v_mul_f32 v23, v23, v110
  v_sub_f32 v40, v40, v108
  v_mul_f32 v24, v24, v110
  v_sub_f32 v41, v41, v108
  v_mul_f32 v25, v25, v110
  v_sub_f32 v42, v42, v108
  v_mul_f32 v26, v26, v110
  v_sub_f32 v43, v43, v108
  v_mul_f32 v27, v27, v110
  v_sub_f32 v44, v44, v108
  v_mul_f32 v28, v28, v110
  v_sub_f32 v45, v45, v108
  v_mul_f32 v29, v29, v110
  v_sub_f32 v46, v46, v108
  v_mul_f32 v30, v30, v110
  v_sub_f32 v47, v47, v108
  v_mul_f32 v31, v31, v110
  v_exp_f32 v32, v32
  v_exp_f32 v33, v33
  v_exp_f32 v34, v34
  v_exp_f32 v35, v35
  v_exp_f32 v36, v36
  v_exp_f32 v37, v37
  v_exp_f32 v38, v38
  v_exp_f32 v39, v39
  v_exp_f32 v40, v40
  v_exp_f32 v41, v41
  v_exp_f32 v42, v42
  v_exp_f32 v43, v43
  v_exp_f32 v44, v44
  v_exp_f32 v45, v45
  v_exp_f32 v46, v46
  v_exp_f32 v47, v47
  s_nop 0
  v_cvt_pk_bf16_f32 v64, v32, v33
  v_cvt_pk_bf16_f32 v65, v34, v35
  v_cvt_pk_bf16_f32 v66, v36, v37
  v_cvt_pk_bf16_f32 v67, v38, v39
  v_cvt_pk_bf16_f32 v68, v40, v41
  v_cvt_pk_bf16_f32 v69, v42, v43
  v_cvt_pk_bf16_f32 v70, v44, v45
  v_cvt_pk_bf16_f32 v71, v46, v47
  s_nop 1
  v_mfma_f32_32x32x16_bf16 v[16:31], v[88:91], v[64:67], v[16:31]
  v_mfma_f32_32x32x16_bf16 v[16:31], v[92:95], v[68:71], v[16:31]
  s_nop 15
  s_add_u32 s36, s36, 1
  s_cmp_lt_u32 s36, 4
  s_cbranch_scc1 L_pk_stile
  s_add_u32 s37, s37, 1
  s_cmp_lt_u32 s37, 8
  s_cbranch_scc1 L_pk_sloop
  buffer_load_dwordx4 v[112:115], v104, s[52:55], s45 offen offset:0 sc1
  buffer_load_dwordx4 v[116:119], v104, s[52:55], s45 offen offset:1024 sc1
  buffer_load_dwordx4 v[120:123], v104, s[52:55], s45 offen offset:2048 sc1
  buffer_load_dwordx4 v[124:127], v104, s[52:55], s45 offen offset:3072 sc1
  s_add_u32 s45, s45, 4096
  buffer_load_dwordx4 v[128:131], v104, s[52:55], s45 offen offset:0 sc1
  buffer_load_dwordx4 v[132:135], v104, s[52:55], s45 offen offset:1024 sc1
  buffer_load_dwordx4 v[136:139], v104, s[52:55], s45 offen offset:2048 sc1
  buffer_load_dwordx4 v[140:143], v104, s[52:55], s45 offen offset:3072 sc1
  s_add_u32 s45, s45, 4096
  buffer_load_dwordx4 v[144:147], v104, s[52:55], s45 offen offset:0 sc1
  buffer_load_dwordx4 v[148:151], v104, s[52:55], s45 offen offset:1024 sc1
  buffer_load_dwordx4 v[152:155], v104, s[52:55], s45 offen offset:2048 sc1
  buffer_load_dwordx4 v[156:159], v104, s[52:55], s45 offen offset:3072 sc1
  s_add_u32 s45, s45, 4096
  buffer_load_dwordx4 v[160:163], v104, s[52:55], s45 offen offset:0 sc1
  buffer_load_dwordx4 v[164:167], v104, s[52:55], s45 offen offset:1024 sc1
  buffer_load_dwordx4 v[168:171], v104, s[52:55], s45 offen offset:2048 sc1
  buffer_load_dwordx4 v[172:175], v104, s[52:55], s45 offen offset:3072 sc1
  s_add_u32 s45, s45, 4096
  buffer_load_dwordx4 v[176:179], v104, s[52:55], s45 offen offset:0 sc1
  buffer_load_dwordx4 v[180:183], v104, s[52:55], s45 offen offset:1024 sc1
  buffer_load_dwordx4 v[184:187], v104, s[52:55], s45 offen offset:2048 sc1
  buffer_load_dwordx4 v[188:191], v104, s[52:55], s45 offen offset:3072 sc1
  s_add_u32 s45, s45, 4096
  buffer_load_dwordx4 v[192:195], v104, s[52:55], s45 offen offset:0 sc1
  buffer_load_dwordx4 v[196:199], v104, s[52:55], s45 offen offset:1024 sc1
  buffer_load_dwordx4 v[200:203], v104, s[52:55], s45 offen offset:2048 sc1
  buffer_load_dwordx4 v[204:207], v104, s[52:55], s45 offen offset:3072 sc1
  s_add_u32 s45, s45, 4096
  buffer_load_dwordx4 v[208:211], v104, s[52:55], s45 offen offset:0 sc1
  buffer_load_dwordx4 v[212:215], v104, s[52:55], s45 offen offset:1024 sc1
  buffer_load_dwordx4 v[216:219], v104, s[52:55], s45 offen offset:2048 sc1
  buffer_load_dwordx4 v[220:223], v104, s[52:55], s45 offen offset:3072 sc1
  s_waitcnt vmcnt(0)
  s_cmp_ge_u32 s3, 4
  s_cbranch_scc1 L_pk_join1
  s_branch L_pk_join0
L_pk_fbwait:
  s_mov_b32 s38, 1048576
L_pk_fbs:
  s_sleep 8
  v_lshlrev_b32 v2, 4, v1
  s_cmp_eq_u32 s3, 0
  s_cselect_b64 exec, -1, 0
  s_mov_b32 s34, 2392064
  buffer_load_dwordx4 v[108:111], v2, s[28:31], s34 offen sc1
  s_mov_b64 exec, -1
  s_waitcnt vmcnt(0)
  s_cmp_eq_u32 s3, 0
  s_cselect_b64 exec, -1, 0
  v_xor_b32 v108, s48, v108
  v_xor_b32 v109, s48, v109
  v_xor_b32 v110, s48, v110
  v_xor_b32 v111, s48, v111
  v_or3_b32 v108, v108, v109, v110
  v_or_b32 v108, v108, v111
  v_cmp_ne_u32 vcc, 0, v108
  s_mov_b64 exec, -1
  s_sub_u32 s38, s38, 1
  s_cbranch_scc1 L_pk_fbsx
  s_cbranch_vccnz L_pk_fbs
L_pk_fbsx:
  s_branch L_pk_fbok
L_pk_far1:
  buffer_store_dwordx4 v[8:11], v105, s[28:31], s36 offen sc1
  s_branch L_pk_near1
L_pk_far3:
  buffer_store_dwordx4 v[32:35], v111, s[28:31], s35 offen sc1
  s_branch L_pk_near3
L_pk_far4:
  buffer_store_dwordx4 v[36:39], v111, s[28:31], s35 offen offset:1024 sc1
  s_branch L_pk_near4
L_pk_far5:
  buffer_store_dword v40, v3, s[28:31], s36 offen sc1
  s_branch L_pk_near5
L_pk_far7:
  buffer_store_dwordx4 v[108:111], v7, s[28:31], s39 offen offset:0 sc1
  buffer_store_dwordx4 v[108:111], v7, s[28:31], s39 offen offset:1024 sc1
  s_branch L_pk_near7
L_pk_far8:
  buffer_store_dwordx4 v[108:111], v7, s[28:31], s39 offen offset:2048 sc1
  buffer_store_dwordx4 v[108:111], v7, s[28:31], s39 offen offset:3072 sc1
  s_branch L_pk_near8
L_pk_far9:
  buffer_store_dwordx4 v[108:111], v7, s[28:31], s40 offen offset:0 sc1
  buffer_store_dwordx4 v[108:111], v7, s[28:31], s40 offen offset:1024 sc1
  s_branch L_pk_near9
L_pk_far10:
  buffer_store_dwordx4 v[108:111], v7, s[28:31], s40 offen offset:2048 sc1
  buffer_store_dwordx4 v[108:111], v7, s[28:31], s40 offen offset:3072 sc1
  s_branch L_pk_near10
L_pk_far11:
  buffer_store_dwordx4 v[108:111], v5, s[28:31], s51 offen offset:0 sc1
  buffer_store_dwordx4 v[108:111], v5, s[28:31], s51 offen offset:3584 sc1
  s_branch L_pk_near11
L_pk_far12:
  buffer_store_dwordx4 v[108:111], v5, s[28:31], s51 offen offset:0 sc1
  buffer_store_dwordx4 v[108:111], v5, s[28:31], s51 offen offset:3584 sc1
  s_branch L_pk_near12
L_pk_far13:
  buffer_store_dwordx4 v[108:111], v5, s[28:31], s51 offen offset:0 sc1
  buffer_store_dwordx4 v[108:111], v5, s[28:31], s51 offen offset:3584 sc1
  s_branch L_pk_near13
L_pk_far14:
  buffer_store_dwordx4 v[108:111], v5, s[28:31], s51 offen offset:0 sc1
  buffer_store_dwordx4 v[108:111], v5, s[28:31], s51 offen offset:3584 sc1
  s_branch L_pk_near14
L_pk_far15:
  buffer_store_dwordx4 v[108:111], v5, s[28:31], s51 offen offset:0 sc1
  buffer_store_dwordx4 v[108:111], v5, s[28:31], s51 offen offset:3584 sc1
  s_branch L_pk_near15
L_pk_far16:
  buffer_store_dwordx4 v[108:111], v5, s[28:31], s51 offen offset:0 sc1
  buffer_store_dwordx4 v[108:111], v5, s[28:31], s51 offen offset:3584 sc1
  s_branch L_pk_near16
L_pk_far17:
  buffer_store_dwordx4 v[108:111], v5, s[28:31], s51 offen offset:0 sc1
  buffer_store_dwordx4 v[108:111], v5, s[28:31], s51 offen offset:3584 sc1
  s_branch L_pk_near17
L_pk_far18:
  buffer_store_dwordx4 v[108:111], v5, s[28:31], s51 offen offset:0 sc1
  buffer_store_dwordx4 v[108:111], v5, s[28:31], s51 offen offset:3584 sc1
  s_branch L_pk_near18
L_pk_far19:
  buffer_store_dwordx4 v[8:11], v105, s[28:31], s36 offen sc1
  s_branch L_pk_near19
L_pk_far20:
  buffer_store_dwordx2 v[8:9], v105, s[28:31], s36 offen sc1
  s_branch L_pk_near20
L_pk_far37:
  buffer_store_dwordx4 v[108:111], v7, s[28:31], s39 offen offset:0 sc1
  buffer_store_dwordx4 v[108:111], v7, s[28:31], s39 offen offset:1024 sc1
  s_branch L_pk_near37
L_pk_far38:
  buffer_store_dwordx4 v[108:111], v7, s[28:31], s39 offen offset:2048 sc1
  buffer_store_dwordx4 v[108:111], v7, s[28:31], s39 offen offset:3072 sc1
  s_branch L_pk_near38
L_pk_far39:
  buffer_store_dwordx4 v[108:111], v7, s[28:31], s40 offen offset:0 sc1
  buffer_store_dwordx4 v[108:111], v7, s[28:31], s40 offen offset:1024 sc1
  s_branch L_pk_near39
L_pk_far40:
  buffer_store_dwordx4 v[108:111], v7, s[28:31], s40 offen offset:2048 sc1
  buffer_store_dwordx4 v[108:111], v7, s[28:31], s40 offen offset:3072 sc1
  s_branch L_pk_near40
L_pk_far41:
  buffer_store_dwordx4 v[108:111], v5, s[28:31], s51 offen offset:0 sc1
  buffer_store_dwordx4 v[108:111], v5, s[28:31], s51 offen offset:3584 sc1
  s_branch L_pk_near41
L_pk_far42:
  buffer_store_dwordx4 v[108:111], v5, s[28:31], s51 offen offset:0 sc1
  buffer_store_dwordx4 v[108:111], v5, s[28:31], s51 offen offset:3584 sc1
  s_branch L_pk_near42
L_pk_far43:
  buffer_store_dwordx4 v[108:111], v5, s[28:31], s51 offen offset:0 sc1
  buffer_store_dwordx4 v[108:111], v5, s[28:31], s51 offen offset:3584 sc1
  s_branch L_pk_near43
L_pk_far44:
  buffer_store_dwordx4 v[108:111], v5, s[28:31], s51 offen offset:0 sc1
  buffer_store_dwordx4 v[108:111], v5, s[28:31], s51 offen offset:3584 sc1
  s_branch L_pk_near44
L_pk_far45:
  buffer_store_dwordx4 v[108:111], v5, s[28:31], s51 offen offset:0 sc1
  buffer_store_dwordx4 v[108:111], v5, s[28:31], s51 offen offset:3584 sc1
  s_branch L_pk_near45
L_pk_far46:
  buffer_store_dwordx4 v[108:111], v5, s[28:31], s51 offen offset:0 sc1
  buffer_store_dwordx4 v[108:111], v5, s[28:31], s51 offen offset:3584 sc1
  s_branch L_pk_near46
L_pk_far47:
  buffer_store_dwordx4 v[108:111], v5, s[28:31], s51 offen offset:0 sc1
  buffer_store_dwordx4 v[108:111], v5, s[28:31], s51 offen offset:3584 sc1
  s_branch L_pk_near47
L_pk_far48:
  buffer_store_dwordx4 v[108:111], v5, s[28:31], s51 offen offset:0 sc1
  buffer_store_dwordx4 v[108:111], v5, s[28:31], s51 offen offset:3584 sc1
  s_branch L_pk_near48
L_pk_last:

.section .rodata,"a"
.p2align 6
.amdhsa_kernel sequential_preLN__grouped_kv_mqa__dense_activation_mish__prompt_kernel
  .amdhsa_next_free_vgpr 256
  .amdhsa_next_free_sgpr 64
  .amdhsa_accum_offset 256
  .amdhsa_group_segment_fixed_size 0
  .amdhsa_kernarg_size 96
  .amdhsa_user_sgpr_count 2
  .amdhsa_user_sgpr_kernarg_segment_ptr 1
  .amdhsa_system_sgpr_workgroup_id_x 1
.end_amdhsa_kernel
```
